```python
import torch

def _softmax(x, axis=-1):
    return torch.softmax(x, dim=axis)

def _gelu(x):
    return torch.nn.functional.gelu(x, approximate='tanh')

def _silu(x):
    return torch.nn.functional.silu(x)

def _sigmoid(x):
    return torch.sigmoid(x)

def _layernorm(x, axis=-1, eps=1e-05):
    m = x.mean(dim=axis, keepdim=True)
    v = x.var(dim=axis, keepdim=True, unbiased=False)
    return (x - m) / torch.sqrt(v + eps)

def _scatter_add(tgt, idx, src, axis=0):
    return tgt.clone().index_add_(axis, idx, src)

def _segment_sum(src, seg, n):
    out = torch.zeros((n,) + src.shape[1:], dtype=src.dtype)
    return out.index_add_(0, seg, src)

def _pad(x, pw):
    flat = tuple((v for pair in reversed(pw) for v in pair))
    return torch.nn.functional.pad(x, flat)
kernel_name = 'parallel_sum__memory_aug_recurrent_mem_tr__dense_activation_silu__prompt'

def setup_inputs():

    _w = lambda a: (lambda t: t.to(torch.bfloat16) if t.is_floating_point() else t)(torch.as_tensor(a))

    def _A_setup():
        B, S, Dm = (1, 2048, 640)
        H, Dh = (32, 192)
        M, seg = (8, 32)
        seg = min(seg, S)
        S = S // seg * seg
        return {'x': _w((lambda *s: torch.randn(*s, dtype=torch.bfloat16) * 0.05)(B, S, Dm)), 'mem0': _w((lambda *s: torch.randn(*s, dtype=torch.bfloat16) * 0.2)(B, M, Dm)), 'Wq': _w((lambda *s: torch.randn(*s, dtype=torch.bfloat16) * 1.6)(Dm, H, Dh) * Dm ** (-0.5)), 'Wk': _w((lambda *s: torch.randn(*s, dtype=torch.bfloat16) * 1.6)(Dm, H, Dh) * Dm ** (-0.5)), 'Wv': _w((lambda *s: torch.randn(*s, dtype=torch.bfloat16) * 0.2)(Dm, H, Dh) * Dm ** (-0.5)), 'Wo': _w((lambda *s: torch.randn(*s, dtype=torch.bfloat16) * 0.2)(H, Dh, Dm) * (H * Dh) ** (-0.5)), 'seg_len': seg}
    _A_in = _A_setup()

    def _B_setup():
        B, S, D, F = (1, 2048, 640, 1536)
        return {'x': _w((lambda *s: torch.randn(*s, dtype=torch.bfloat16) * 0.05)(B, S, D)), 'w1': _w((lambda *s: torch.randn(*s, dtype=torch.bfloat16) * 0.8)(D, F) * D ** (-0.5)), 'w2': _w((lambda *s: torch.randn(*s, dtype=torch.bfloat16) * 0.1)(F, D) * F ** (-0.5))}
    _B_in = _B_setup()
    return {'A_x': _A_in['x'], 'A_mem0': _A_in['mem0'], 'A_Wq': _A_in['Wq'], 'A_Wk': _A_in['Wk'], 'A_Wv': _A_in['Wv'], 'A_Wo': _A_in['Wo'], 'A_seg_len': _A_in['seg_len'], 'B_x': _B_in['x'], 'B_w1': _B_in['w1'], 'B_w2': _B_in['w2']}

def reference(A_x, A_mem0, A_Wq, A_Wk, A_Wv, A_Wo, A_seg_len, B_x, B_w1, B_w2):

    def _A_ref(x, mem0, Wq, Wk, Wv, Wo, seg_len):
        B, S, Dm = x.shape
        H, Dh = (Wq.shape[1], Wq.shape[2])
        M = mem0.shape[1]
        scale = Dh ** (-0.5)
        n_seg = S // seg_len
        L = M + seg_len
        idx = torch.arange(L)
        mask = (idx[:, None] < M) | (idx[:, None] >= idx[None, :])
        mem = mem0
        outs = []
        for s in range(n_seg):
            xs = x[:, s * seg_len:(s + 1) * seg_len, :].clone()
            h = torch.concatenate([mem, xs], axis=1)
            q = torch.einsum('btd,dhe->bhte', h, Wq)
            k = torch.einsum('btd,dhe->bhte', h, Wk)
            v = torch.einsum('btd,dhe->bhte', h, Wv)
            scores = torch.einsum('bhqe,bhke->bhqk', q, k) * scale
            scores = torch.where(mask[None, None], scores, -1000000000.0)
            p = _softmax(scores, axis=-1)
            o = torch.einsum('bhqk,bhke->bhqe', p, v)
            o = torch.einsum('bhte,hed->btd', o, Wo)
            mem = o[:, :M, :].clone()
            outs.append(o[:, M:, :])
        return torch.concatenate(outs, axis=1)

    def _B_ref(x, w1, w2):
        h = torch.einsum('bsd,df->bsf', x, w1)
        h = _silu(h)
        out = torch.einsum('bsf,fd->bsd', h, w2)
        return out
    x = A_x
    xn = _layernorm(x, axis=-1)
    return x + _A_ref(xn, A_mem0, A_Wq, A_Wk, A_Wv, A_Wo, A_seg_len) + _B_ref(xn, B_w1, B_w2)
```

```asm
; @launch grid=(256,1,1) block=(256,1,1) lds=163840
.amdgcn_target "amdgcn-amd-amdhsa--gfx950"
.text
.globl parallel_sum__memory_aug_recurrent_mem_tr__dense_activation_silu__prompt_kernel
.p2align 8
.type parallel_sum__memory_aug_recurrent_mem_tr__dense_activation_silu__prompt_kernel,@function
parallel_sum__memory_aug_recurrent_mem_tr__dense_activation_silu__prompt_kernel:
    s_cmp_ge_u32 s2, 256
    s_cbranch_scc1 L_end
    s_add_u32 s3, s2, 0
    s_and_b32 s3, s3, 7
    s_and_b32 s2, s2, 0xf8
    s_or_b32 s26, s2, s3
    s_getreg_b32 s3, hwreg(HW_REG_XCC_ID, 0, 3)
    s_or_b32 s2, s2, s3
    s_load_dwordx2 s[4:5], s[0:1], 96
    s_load_dwordx2 s[16:17], s[0:1], 88
    v_and_b32 v1, 63, v0
    v_lshrrev_b32 v2, 6, v0
    s_mov_b32 s28, 0
    v_readfirstlane_b32 s23, v2
    s_lshr_b32 s21, s2, 3
    s_mov_b32 s27, 0
    s_mov_b32 s18, 256
    s_mov_b32 s19, 0x20000
    s_mov_b32 s6, 264241152
    s_mov_b32 s7, 0x20000
L_dispatch:
    s_cmp_lt_u32 s21, 28
    s_cselect_b32 s3, 64, 0
    s_cmp_lt_u32 s21, 26
    s_cselect_b32 s3, 0, s3
    s_cmp_lt_u32 s21, 16
    s_cselect_b32 s3, 32, s3
    s_cmp_lt_u32 s21, 8
    s_cselect_b32 s3, 16, s3
    s_load_dwordx4 s[12:15], s[0:1], s3
    s_and_b32 s20, s2, 3
    s_bfe_u32 s22, s2, 0x10002
    s_cmp_ge_u32 s21, 8
    s_cbranch_scc1 L_other
L_QK:
    s_lshl_b32 s25, s20, 3
    s_add_u32 s25, s25, s21
    s_mov_b32 s30, 12288
    s_mul_i32 s31, s25, 384
    s_lshl_b32 s32, s30, 5
    s_mul_i32 s48, s22, 2
    s_xor_b32 s36, s20, s48
    v_lshlrev_b32 v2, 4, v1
    s_mul_i32 s40, s23, 26624
    s_add_u32 s40, s40, 57344
    v_add_u32 v3, s40, v2
    v_add_u32 v10, 0, v1
    v_mul_u32_u24 v11, 2731, v10
    v_lshrrev_b32 v11, 16, v11
    v_mul_u32_u24 v12, 24, v11
    v_sub_u32 v10, v10, v12
    s_lshl_b32 s40, s23, 3
    v_add_u32 v11, s40, v11
    v_mul_lo_u32 v11, v11, s30
    v_lshl_add_u32 v16, v10, 4, v11
    v_add_u32 v10, 64, v1
    v_mul_u32_u24 v11, 2731, v10
    v_lshrrev_b32 v11, 16, v11
    v_mul_u32_u24 v12, 24, v11
    v_sub_u32 v10, v10, v12
    s_lshl_b32 s40, s23, 3
    v_add_u32 v11, s40, v11
    v_mul_lo_u32 v11, v11, s30
    v_lshl_add_u32 v17, v10, 4, v11
    v_add_u32 v10, 128, v1
    v_mul_u32_u24 v11, 2731, v10
    v_lshrrev_b32 v11, 16, v11
    v_mul_u32_u24 v12, 24, v11
    v_sub_u32 v10, v10, v12
    s_lshl_b32 s40, s23, 3
    v_add_u32 v11, s40, v11
    v_mul_lo_u32 v11, v11, s30
    v_lshl_add_u32 v18, v10, 4, v11
    v_lshrrev_b32 v10, 4, v1
    v_lshlrev_b32 v10, 3, v10
    v_bfe_u32 v11, v1, 2, 2
    v_add_u32 v10, v10, v11
    v_mul_u32_u24 v10, 384, v10
    v_and_b32 v11, 3, v1
    v_lshl_add_u32 v10, v11, 3, v10
    s_xor_b32 s40, s23, s48
    s_mul_i32 s40, s40, 96
    v_add_u32 v19, s40, v10
    s_mul_i32 s44, s23, 3072
    s_waitcnt lgkmcnt(0)
    s_mov_b32 s8, s12
    s_mov_b32 s9, s13
    s_mov_b32 s10, 7864320
    s_mov_b32 s11, 0x20000
    s_mov_b32 s12, s14
    s_mov_b32 s13, s15
    s_mov_b32 s14, 7864320
    s_mov_b32 s15, 0x20000
    s_add_u32 s4, s4, 0x3fffff
    s_addc_u32 s5, s5, 0
    s_and_b32 s4, s4, 0xffc00000
    s_lshl_b32 s45, s36, 2
    s_add_u32 s45, s45, 0
    s_cmp_ge_u32 s45, 20
    s_cselect_b32 s43, 20, 0
    s_sub_u32 s45, s45, s43
    s_mul_i32 s45, s32, s45
    s_add_u32 s45, s45, s31
    s_add_u32 m0, s44, 0
    s_nop 0
    buffer_load_dwordx4 v16, s[8:11], s45 offen  lds
    s_add_u32 m0, s44, 1024
    s_nop 0
    buffer_load_dwordx4 v17, s[8:11], s45 offen  lds
    s_add_u32 m0, s44, 2048
    s_nop 0
    buffer_load_dwordx4 v18, s[8:11], s45 offen  lds
    s_lshl_b32 s45, s36, 2
    s_add_u32 s45, s45, 0
    s_cmp_ge_u32 s45, 20
    s_cselect_b32 s43, 20, 0
    s_sub_u32 s45, s45, s43
    s_mul_i32 s45, s32, s45
    s_add_u32 s45, s45, s31
    s_add_u32 m0, s44, 12288
    s_nop 0
    buffer_load_dwordx4 v16, s[12:15], s45 offen  lds
    s_add_u32 m0, s44, 13312
    s_nop 0
    buffer_load_dwordx4 v17, s[12:15], s45 offen  lds
    s_add_u32 m0, s44, 14336
    s_nop 0
    buffer_load_dwordx4 v18, s[12:15], s45 offen  lds
    s_lshl_b32 s45, s36, 2
    s_add_u32 s45, s45, 1
    s_cmp_ge_u32 s45, 20
    s_cselect_b32 s43, 20, 0
    s_sub_u32 s45, s45, s43
    s_mul_i32 s45, s32, s45
    s_add_u32 s45, s45, s31
    s_add_u32 m0, s44, 24576
    s_nop 0
    buffer_load_dwordx4 v16, s[8:11], s45 offen  lds
    s_add_u32 m0, s44, 25600
    s_nop 0
    buffer_load_dwordx4 v17, s[8:11], s45 offen  lds
    s_add_u32 m0, s44, 26624
    s_nop 0
    buffer_load_dwordx4 v18, s[8:11], s45 offen  lds
    s_mov_b32 s56, 0x00ff00ff
    s_mov_b32 s57, 0x00ff00ff
    s_mov_b32 s58, 0
    s_mov_b32 s59, 0x00ff00ff
    s_mov_b32 s60, 0x03ff03ff
    s_mov_b32 s61, 0x03ff03ff
    s_mov_b32 s54, 1037384597
    s_mov_b32 s55, 1037384597
    s_lshl_b32 s40, s21, 2
    s_add_u32 s40, s40, s23
    s_cmp_eq_u32 s40, 3
    s_cselect_b32 s53, 1, 0
    s_cmp_lt_u32 s23, 2
    s_cselect_b64 s[42:43], s[60:61], 0
    s_mov_b32 s24, s42
    s_add_u32 s40, s23, 1
    s_bitcmp1_b32 s40, 1
    s_cselect_b64 s[64:65], -1, 0
    v_and_b32 v20, 15, v1
    v_lshrrev_b32 v21, 4, v1
    v_and_b32 v22, 1, v21
    v_lshrrev_b32 v23, 1, v21
    v_and_b32 v4, 1, v1
    v_mul_u32_u24 v4, 0xaaaa, v4
    v_add_u32 v4, 0x4444, v4
    s_mul_i32 s40, s23, 1536
    s_add_u32 s40, s40, 47120
    v_lshrrev_b32 v24, 2, v20
    v_mul_u32_u24 v5, 176, v24
    v_and_b32 v24, 1, v20
    v_mul_u32_u24 v24, 768, v24
    v_add3_u32 v5, v5, v24, s40
    v_bfe_u32 v25, v20, 1, 1
    v_mul_u32_u24 v24, 6160, v25
    v_sub_u32 v5, v5, v24
    v_add_u32 v25, v25, v21
    v_lshl_add_u32 v8, v25, 3, v5
    v_lshl_add_u32 v5, v23, 6, v5
    v_lshl_add_u32 v5, v22, 4, v5
    s_and_b32 s43, s23, 1
    s_lshl_b32 s43, s43, 2
    v_add_u32 v24, s43, v21
    v_lshrrev_b32 v0, 1, v24
    v_mul_u32_u24 v0, 176, v0
    v_mul_u32_u24 v25, 768, v22
    v_add_u32 v0, v0, v25
    v_lshl_add_u32 v0, v20, 4, v0
    v_mov_b32 v6, 0
    s_lshl_b32 s40, s23, 10
    v_add_u32 v7, s40, v2
    s_lshr_b32 s41, s23, 1
    s_lshl_b32 s40, s41, 4
    v_add_u32 v10, s40, v20
    v_lshlrev_b32 v11, 2, v21
    v_sub_u32 v10, v10, v11
    v_lshlrev_b32 v11, 4, v20
    v_lshl_add_u32 v11, v22, 3, v11
    v_lshl_add_u32 v11, v23, 2, v11
    s_mul_i32 s41, s41, 40
    s_add_u32 s40, s41, s25
    s_lshr_b32 s42, s40, 3
    s_lshl_b32 s42, s42, 14
    s_and_b32 s40, s40, 7
    s_lshl_b32 s40, s40, 10
    s_add_u32 s52, s42, s40
    s_lshr_b32 s40, s25, 2
    s_add_u32 s40, s40, s41
    s_add_u32 s40, s40, 32
    s_lshr_b32 s42, s40, 3
    s_lshl_b32 s42, s42, 14
    s_and_b32 s40, s40, 7
    s_lshl_b32 s40, s40, 10
    s_add_u32 s42, s42, s40
    s_and_b32 s40, s25, 3
    s_lshl_b32 s40, s40, 8
    s_add_u32 s42, s42, s40
    s_sub_u32 s42, s42, s52
    v_add_u32 v11, s42, v11
    s_add_u32 s52, s52, 1638400
    v_lshlrev_b32 v25, 5, v24
    v_and_b32 v26, 1, v20
    v_lshl_add_u32 v27, v26, 4, v25
    v_and_b32 v26, 3, v20
    v_lshl_add_u32 v25, v26, 3, v25
    s_lshr_b32 s40, s25, 1
    s_lshl_b32 s40, s40, 8
    s_and_b32 s41, s25, 1
    s_lshl_b32 s41, s41, 3
    s_add_u32 s40, s40, s41
    s_add_u32 s40, s40, 163840
    v_add_u32 v27, s40, v27
    s_lshr_b32 s41, s25, 3
    s_lshl_b32 s41, s41, 15
    s_and_b32 s40, s25, 7
    s_lshl_b32 s40, s40, 9
    s_add_u32 s40, s40, s41
    s_add_u32 s40, s40, 196608
    v_bfe_u32 v26, v20, 2, 1
    v_lshl_add_u32 v25, v26, 8, v25
    v_add_u32 v9, s40, v25
    v_cmp_gt_u32 vcc, 8, v20
    s_nop 1
    v_cndmask_b32 v9, v27, v9, vcc
    v_lshlrev_b32 v25, 2, v21
    v_sub_u32 v25, v20, v25
    v_mov_b32 v26, 0x3f803f80
    v_cmp_eq_u32 vcc, 2, v25
    s_nop 1
    v_cndmask_b32 v12, 0, v26, vcc
    v_cmp_eq_u32 vcc, 3, v25
    s_nop 1
    v_cndmask_b32 v13, 0, v26, vcc
    v_cmp_eq_u32 vcc, 0, v25
    s_nop 1
    v_cndmask_b32 v14, 0, v26, vcc
    v_cmp_eq_u32 vcc, 1, v25
    s_nop 1
    v_cndmask_b32 v15, 0, v26, vcc
    s_mul_i32 s44, s23, 3072
    s_sub_u32 s40, s2, s26
    s_and_b32 s42, s40, 1
    s_bfe_u32 s41, s40, 0x10001
    s_lshl_b32 s41, s41, 9
    s_or_b32 s42, s42, s41
    s_bfe_u32 s41, s40, 0x10002
    s_lshl_b32 s41, s41, 18
    s_or_b32 s42, s42, s41
    v_mov_b32 v32, 128
    v_mov_b32 v33, s42
    v_mov_b32 v34, 0
    s_and_b32 s46, s21, 7
    s_lshl_b32 s47, s23, 3
    s_or_b32 s46, s46, s47
    s_waitcnt vmcnt(6)
    s_barrier
    s_lshl_b32 s45, s36, 2
    s_add_u32 s45, s45, 1
    s_cmp_ge_u32 s45, 20
    s_cselect_b32 s43, 20, 0
    s_sub_u32 s45, s45, s43
    s_mul_i32 s45, s32, s45
    s_add_u32 s45, s45, s31
    s_add_u32 m0, s44, 36864
    s_nop 0
    buffer_load_dwordx4 v16, s[12:15], s45 offen  lds
    s_add_u32 m0, s44, 37888
    s_nop 0
    buffer_load_dwordx4 v17, s[12:15], s45 offen  lds
    s_add_u32 m0, s44, 38912
    s_nop 0
    buffer_load_dwordx4 v18, s[12:15], s45 offen  lds
    ds_read_b64_tr_b16 a[0:1], v19 offset:0
    ds_read_b64_tr_b16 a[2:3], v19 offset:1536
    ds_read_b64_tr_b16 a[80:81], v19 offset:32
    ds_read_b64_tr_b16 a[82:83], v19 offset:1568
    ds_read_b64_tr_b16 v[40:41], v19 offset:64
    ds_read_b64_tr_b16 v[42:43], v19 offset:1600
    s_waitcnt lgkmcnt(0)
    ds_write_b128 v3, v[40:43] offset:0
    s_waitcnt vmcnt(6)
    s_barrier
    s_cmp_eq_u32 s46, 0
    s_cselect_b64 exec, 1, 0
    buffer_atomic_add_x2 v[32:33], v34, s[16:19], s28 offen sc1
    s_mov_b64 exec, -1
    s_lshl_b32 s45, s36, 2
    s_add_u32 s45, s45, 2
    s_cmp_ge_u32 s45, 20
    s_cselect_b32 s43, 20, 0
    s_sub_u32 s45, s45, s43
    s_mul_i32 s45, s32, s45
    s_add_u32 s45, s45, s31
    s_add_u32 m0, s44, 0
    s_nop 0
    buffer_load_dwordx4 v16, s[8:11], s45 offen  lds
    s_add_u32 m0, s44, 1024
    s_nop 0
    buffer_load_dwordx4 v17, s[8:11], s45 offen  lds
    s_add_u32 m0, s44, 2048
    s_nop 0
    buffer_load_dwordx4 v18, s[8:11], s45 offen  lds
    ds_read_b64_tr_b16 a[160:161], v19 offset:12288
    ds_read_b64_tr_b16 a[162:163], v19 offset:13824
    ds_read_b64_tr_b16 a[240:241], v19 offset:12320
    ds_read_b64_tr_b16 a[242:243], v19 offset:13856
    ds_read_b64_tr_b16 v[176:177], v19 offset:12352
    ds_read_b64_tr_b16 v[178:179], v19 offset:13888
    s_waitcnt lgkmcnt(0)
    s_waitcnt vmcnt(6)
    s_barrier
    s_cmp_eq_u32 s46, 1
    s_cselect_b64 exec, 1, 0
    buffer_atomic_add_x2 v[32:33], v34, s[16:19], s28 offen sc1
    s_mov_b64 exec, -1
    s_lshl_b32 s45, s36, 2
    s_add_u32 s45, s45, 2
    s_cmp_ge_u32 s45, 20
    s_cselect_b32 s43, 20, 0
    s_sub_u32 s45, s45, s43
    s_mul_i32 s45, s32, s45
    s_add_u32 s45, s45, s31
    s_add_u32 m0, s44, 12288
    s_nop 0
    buffer_load_dwordx4 v16, s[12:15], s45 offen  lds
    s_add_u32 m0, s44, 13312
    s_nop 0
    buffer_load_dwordx4 v17, s[12:15], s45 offen  lds
    s_add_u32 m0, s44, 14336
    s_nop 0
    buffer_load_dwordx4 v18, s[12:15], s45 offen  lds
    ds_read_b64_tr_b16 a[4:5], v19 offset:24576
    ds_read_b64_tr_b16 a[6:7], v19 offset:26112
    ds_read_b64_tr_b16 a[84:85], v19 offset:24608
    ds_read_b64_tr_b16 a[86:87], v19 offset:26144
    ds_read_b64_tr_b16 v[40:41], v19 offset:24640
    ds_read_b64_tr_b16 v[42:43], v19 offset:26176
    s_waitcnt lgkmcnt(0)
    ds_write_b128 v3, v[40:43] offset:1024
    s_waitcnt vmcnt(6)
    s_barrier
    s_cmp_eq_u32 s46, 2
    s_cselect_b64 exec, 1, 0
    buffer_atomic_add_x2 v[32:33], v34, s[16:19], s28 offen sc1
    s_mov_b64 exec, -1
    s_lshl_b32 s45, s36, 2
    s_add_u32 s45, s45, 3
    s_cmp_ge_u32 s45, 20
    s_cselect_b32 s43, 20, 0
    s_sub_u32 s45, s45, s43
    s_mul_i32 s45, s32, s45
    s_add_u32 s45, s45, s31
    s_add_u32 m0, s44, 24576
    s_nop 0
    buffer_load_dwordx4 v16, s[8:11], s45 offen  lds
    s_add_u32 m0, s44, 25600
    s_nop 0
    buffer_load_dwordx4 v17, s[8:11], s45 offen  lds
    s_add_u32 m0, s44, 26624
    s_nop 0
    buffer_load_dwordx4 v18, s[8:11], s45 offen  lds
    ds_read_b64_tr_b16 a[164:165], v19 offset:36864
    ds_read_b64_tr_b16 a[166:167], v19 offset:38400
    ds_read_b64_tr_b16 a[244:245], v19 offset:36896
    ds_read_b64_tr_b16 a[246:247], v19 offset:38432
    ds_read_b64_tr_b16 v[180:181], v19 offset:36928
    ds_read_b64_tr_b16 v[182:183], v19 offset:38464
    s_waitcnt lgkmcnt(0)
    s_waitcnt vmcnt(6)
    s_barrier
    s_cmp_eq_u32 s46, 3
    s_cselect_b64 exec, 1, 0
    buffer_atomic_add_x2 v[32:33], v34, s[16:19], s28 offen sc1
    s_mov_b64 exec, -1
    s_lshl_b32 s45, s36, 2
    s_add_u32 s45, s45, 3
    s_cmp_ge_u32 s45, 20
    s_cselect_b32 s43, 20, 0
    s_sub_u32 s45, s45, s43
    s_mul_i32 s45, s32, s45
    s_add_u32 s45, s45, s31
    s_add_u32 m0, s44, 36864
    s_nop 0
    buffer_load_dwordx4 v16, s[12:15], s45 offen  lds
    s_add_u32 m0, s44, 37888
    s_nop 0
    buffer_load_dwordx4 v17, s[12:15], s45 offen  lds
    s_add_u32 m0, s44, 38912
    s_nop 0
    buffer_load_dwordx4 v18, s[12:15], s45 offen  lds
    ds_read_b64_tr_b16 a[8:9], v19 offset:0
    ds_read_b64_tr_b16 a[10:11], v19 offset:1536
    ds_read_b64_tr_b16 a[88:89], v19 offset:32
    ds_read_b64_tr_b16 a[90:91], v19 offset:1568
    ds_read_b64_tr_b16 v[40:41], v19 offset:64
    ds_read_b64_tr_b16 v[42:43], v19 offset:1600
    s_waitcnt lgkmcnt(0)
    ds_write_b128 v3, v[40:43] offset:2048
    s_waitcnt vmcnt(6)
    s_barrier
    s_cmp_eq_u32 s46, 4
    s_cselect_b64 exec, 1, 0
    buffer_atomic_add_x2 v[32:33], v34, s[16:19], s28 offen sc1
    s_mov_b64 exec, -1
    s_lshl_b32 s45, s36, 2
    s_add_u32 s45, s45, 4
    s_cmp_ge_u32 s45, 20
    s_cselect_b32 s43, 20, 0
    s_sub_u32 s45, s45, s43
    s_mul_i32 s45, s32, s45
    s_add_u32 s45, s45, s31
    s_add_u32 m0, s44, 0
    s_nop 0
    buffer_load_dwordx4 v16, s[8:11], s45 offen  lds
    s_add_u32 m0, s44, 1024
    s_nop 0
    buffer_load_dwordx4 v17, s[8:11], s45 offen  lds
    s_add_u32 m0, s44, 2048
    s_nop 0
    buffer_load_dwordx4 v18, s[8:11], s45 offen  lds
    ds_read_b64_tr_b16 a[168:169], v19 offset:12288
    ds_read_b64_tr_b16 a[170:171], v19 offset:13824
    ds_read_b64_tr_b16 a[248:249], v19 offset:12320
    ds_read_b64_tr_b16 a[250:251], v19 offset:13856
    ds_read_b64_tr_b16 v[184:185], v19 offset:12352
    ds_read_b64_tr_b16 v[186:187], v19 offset:13888
    s_waitcnt lgkmcnt(0)
    s_waitcnt vmcnt(6)
    s_barrier
    s_cmp_eq_u32 s46, 5
    s_cselect_b64 exec, 1, 0
    buffer_atomic_add_x2 v[32:33], v34, s[16:19], s28 offen sc1
    s_mov_b64 exec, -1
    s_lshl_b32 s45, s36, 2
    s_add_u32 s45, s45, 4
    s_cmp_ge_u32 s45, 20
    s_cselect_b32 s43, 20, 0
    s_sub_u32 s45, s45, s43
    s_mul_i32 s45, s32, s45
    s_add_u32 s45, s45, s31
    s_add_u32 m0, s44, 12288
    s_nop 0
    buffer_load_dwordx4 v16, s[12:15], s45 offen  lds
    s_add_u32 m0, s44, 13312
    s_nop 0
    buffer_load_dwordx4 v17, s[12:15], s45 offen  lds
    s_add_u32 m0, s44, 14336
    s_nop 0
    buffer_load_dwordx4 v18, s[12:15], s45 offen  lds
    ds_read_b64_tr_b16 a[12:13], v19 offset:24576
    ds_read_b64_tr_b16 a[14:15], v19 offset:26112
    ds_read_b64_tr_b16 a[92:93], v19 offset:24608
    ds_read_b64_tr_b16 a[94:95], v19 offset:26144
    ds_read_b64_tr_b16 v[40:41], v19 offset:24640
    ds_read_b64_tr_b16 v[42:43], v19 offset:26176
    s_waitcnt lgkmcnt(0)
    ds_write_b128 v3, v[40:43] offset:3072
    s_waitcnt vmcnt(6)
    s_barrier
    s_cmp_eq_u32 s46, 6
    s_cselect_b64 exec, 1, 0
    buffer_atomic_add_x2 v[32:33], v34, s[16:19], s28 offen sc1
    s_mov_b64 exec, -1
    s_lshl_b32 s45, s36, 2
    s_add_u32 s45, s45, 5
    s_cmp_ge_u32 s45, 20
    s_cselect_b32 s43, 20, 0
    s_sub_u32 s45, s45, s43
    s_mul_i32 s45, s32, s45
    s_add_u32 s45, s45, s31
    s_add_u32 m0, s44, 24576
    s_nop 0
    buffer_load_dwordx4 v16, s[8:11], s45 offen  lds
    s_add_u32 m0, s44, 25600
    s_nop 0
    buffer_load_dwordx4 v17, s[8:11], s45 offen  lds
    s_add_u32 m0, s44, 26624
    s_nop 0
    buffer_load_dwordx4 v18, s[8:11], s45 offen  lds
    ds_read_b64_tr_b16 a[172:173], v19 offset:36864
    ds_read_b64_tr_b16 a[174:175], v19 offset:38400
    ds_read_b64_tr_b16 a[252:253], v19 offset:36896
    ds_read_b64_tr_b16 a[254:255], v19 offset:38432
    ds_read_b64_tr_b16 v[188:189], v19 offset:36928
    ds_read_b64_tr_b16 v[190:191], v19 offset:38464
    s_waitcnt lgkmcnt(0)
    s_waitcnt vmcnt(6)
    s_barrier
    s_cmp_eq_u32 s46, 7
    s_cselect_b64 exec, 1, 0
    buffer_atomic_add_x2 v[32:33], v34, s[16:19], s28 offen sc1
    s_mov_b64 exec, -1
    s_lshl_b32 s45, s36, 2
    s_add_u32 s45, s45, 5
    s_cmp_ge_u32 s45, 20
    s_cselect_b32 s43, 20, 0
    s_sub_u32 s45, s45, s43
    s_mul_i32 s45, s32, s45
    s_add_u32 s45, s45, s31
    s_add_u32 m0, s44, 36864
    s_nop 0
    buffer_load_dwordx4 v16, s[12:15], s45 offen  lds
    s_add_u32 m0, s44, 37888
    s_nop 0
    buffer_load_dwordx4 v17, s[12:15], s45 offen  lds
    s_add_u32 m0, s44, 38912
    s_nop 0
    buffer_load_dwordx4 v18, s[12:15], s45 offen  lds
    ds_read_b64_tr_b16 a[16:17], v19 offset:0
    ds_read_b64_tr_b16 a[18:19], v19 offset:1536
    ds_read_b64_tr_b16 a[96:97], v19 offset:32
    ds_read_b64_tr_b16 a[98:99], v19 offset:1568
    ds_read_b64_tr_b16 v[40:41], v19 offset:64
    ds_read_b64_tr_b16 v[42:43], v19 offset:1600
    s_waitcnt lgkmcnt(0)
    ds_write_b128 v3, v[40:43] offset:4096
    s_waitcnt vmcnt(6)
    s_barrier
    s_lshl_b32 s45, s36, 2
    s_add_u32 s45, s45, 6
    s_cmp_ge_u32 s45, 20
    s_cselect_b32 s43, 20, 0
    s_sub_u32 s45, s45, s43
    s_mul_i32 s45, s32, s45
    s_add_u32 s45, s45, s31
    s_add_u32 m0, s44, 0
    s_nop 0
    buffer_load_dwordx4 v16, s[8:11], s45 offen  lds
    s_add_u32 m0, s44, 1024
    s_nop 0
    buffer_load_dwordx4 v17, s[8:11], s45 offen  lds
    s_add_u32 m0, s44, 2048
    s_nop 0
    buffer_load_dwordx4 v18, s[8:11], s45 offen  lds
    ds_read_b64_tr_b16 a[176:177], v19 offset:12288
    ds_read_b64_tr_b16 a[178:179], v19 offset:13824
    ds_read_b64_tr_b16 v[136:137], v19 offset:12320
    ds_read_b64_tr_b16 v[138:139], v19 offset:13856
    ds_read_b64_tr_b16 v[192:193], v19 offset:12352
    ds_read_b64_tr_b16 v[194:195], v19 offset:13888
    s_waitcnt lgkmcnt(0)
    s_waitcnt vmcnt(6)
    s_barrier
    s_lshl_b32 s45, s36, 2
    s_add_u32 s45, s45, 6
    s_cmp_ge_u32 s45, 20
    s_cselect_b32 s43, 20, 0
    s_sub_u32 s45, s45, s43
    s_mul_i32 s45, s32, s45
    s_add_u32 s45, s45, s31
    s_add_u32 m0, s44, 12288
    s_nop 0
    buffer_load_dwordx4 v16, s[12:15], s45 offen  lds
    s_add_u32 m0, s44, 13312
    s_nop 0
    buffer_load_dwordx4 v17, s[12:15], s45 offen  lds
    s_add_u32 m0, s44, 14336
    s_nop 0
    buffer_load_dwordx4 v18, s[12:15], s45 offen  lds
    ds_read_b64_tr_b16 a[20:21], v19 offset:24576
    ds_read_b64_tr_b16 a[22:23], v19 offset:26112
    ds_read_b64_tr_b16 a[100:101], v19 offset:24608
    ds_read_b64_tr_b16 a[102:103], v19 offset:26144
    ds_read_b64_tr_b16 v[40:41], v19 offset:24640
    ds_read_b64_tr_b16 v[42:43], v19 offset:26176
    s_waitcnt lgkmcnt(0)
    ds_write_b128 v3, v[40:43] offset:5120
    s_waitcnt vmcnt(6)
    s_barrier
    s_lshl_b32 s45, s36, 2
    s_add_u32 s45, s45, 7
    s_cmp_ge_u32 s45, 20
    s_cselect_b32 s43, 20, 0
    s_sub_u32 s45, s45, s43
    s_mul_i32 s45, s32, s45
    s_add_u32 s45, s45, s31
    s_add_u32 m0, s44, 24576
    s_nop 0
    buffer_load_dwordx4 v16, s[8:11], s45 offen  lds
    s_add_u32 m0, s44, 25600
    s_nop 0
    buffer_load_dwordx4 v17, s[8:11], s45 offen  lds
    s_add_u32 m0, s44, 26624
    s_nop 0
    buffer_load_dwordx4 v18, s[8:11], s45 offen  lds
    ds_read_b64_tr_b16 a[180:181], v19 offset:36864
    ds_read_b64_tr_b16 a[182:183], v19 offset:38400
    ds_read_b64_tr_b16 v[140:141], v19 offset:36896
    ds_read_b64_tr_b16 v[142:143], v19 offset:38432
    ds_read_b64_tr_b16 v[196:197], v19 offset:36928
    ds_read_b64_tr_b16 v[198:199], v19 offset:38464
    s_waitcnt lgkmcnt(0)
    s_waitcnt vmcnt(6)
    s_barrier
    s_lshl_b32 s45, s36, 2
    s_add_u32 s45, s45, 7
    s_cmp_ge_u32 s45, 20
    s_cselect_b32 s43, 20, 0
    s_sub_u32 s45, s45, s43
    s_mul_i32 s45, s32, s45
    s_add_u32 s45, s45, s31
    s_add_u32 m0, s44, 36864
    s_nop 0
    buffer_load_dwordx4 v16, s[12:15], s45 offen  lds
    s_add_u32 m0, s44, 37888
    s_nop 0
    buffer_load_dwordx4 v17, s[12:15], s45 offen  lds
    s_add_u32 m0, s44, 38912
    s_nop 0
    buffer_load_dwordx4 v18, s[12:15], s45 offen  lds
    ds_read_b64_tr_b16 a[24:25], v19 offset:0
    ds_read_b64_tr_b16 a[26:27], v19 offset:1536
    ds_read_b64_tr_b16 a[104:105], v19 offset:32
    ds_read_b64_tr_b16 a[106:107], v19 offset:1568
    ds_read_b64_tr_b16 v[40:41], v19 offset:64
    ds_read_b64_tr_b16 v[42:43], v19 offset:1600
    s_waitcnt lgkmcnt(0)
    ds_write_b128 v3, v[40:43] offset:6144
    s_waitcnt vmcnt(6)
    s_barrier
    s_lshl_b32 s45, s36, 2
    s_add_u32 s45, s45, 8
    s_cmp_ge_u32 s45, 20
    s_cselect_b32 s43, 20, 0
    s_sub_u32 s45, s45, s43
    s_mul_i32 s45, s32, s45
    s_add_u32 s45, s45, s31
    s_add_u32 m0, s44, 0
    s_nop 0
    buffer_load_dwordx4 v16, s[8:11], s45 offen  lds
    s_add_u32 m0, s44, 1024
    s_nop 0
    buffer_load_dwordx4 v17, s[8:11], s45 offen  lds
    s_add_u32 m0, s44, 2048
    s_nop 0
    buffer_load_dwordx4 v18, s[8:11], s45 offen  lds
    ds_read_b64_tr_b16 a[184:185], v19 offset:12288
    ds_read_b64_tr_b16 a[186:187], v19 offset:13824
    ds_read_b64_tr_b16 v[144:145], v19 offset:12320
    ds_read_b64_tr_b16 v[146:147], v19 offset:13856
    ds_read_b64_tr_b16 v[200:201], v19 offset:12352
    ds_read_b64_tr_b16 v[202:203], v19 offset:13888
    s_waitcnt lgkmcnt(0)
    s_waitcnt vmcnt(6)
    s_barrier
    s_lshl_b32 s45, s36, 2
    s_add_u32 s45, s45, 8
    s_cmp_ge_u32 s45, 20
    s_cselect_b32 s43, 20, 0
    s_sub_u32 s45, s45, s43
    s_mul_i32 s45, s32, s45
    s_add_u32 s45, s45, s31
    s_add_u32 m0, s44, 12288
    s_nop 0
    buffer_load_dwordx4 v16, s[12:15], s45 offen  lds
    s_add_u32 m0, s44, 13312
    s_nop 0
    buffer_load_dwordx4 v17, s[12:15], s45 offen  lds
    s_add_u32 m0, s44, 14336
    s_nop 0
    buffer_load_dwordx4 v18, s[12:15], s45 offen  lds
    ds_read_b64_tr_b16 a[28:29], v19 offset:24576
    ds_read_b64_tr_b16 a[30:31], v19 offset:26112
    ds_read_b64_tr_b16 a[108:109], v19 offset:24608
    ds_read_b64_tr_b16 a[110:111], v19 offset:26144
    ds_read_b64_tr_b16 v[40:41], v19 offset:24640
    ds_read_b64_tr_b16 v[42:43], v19 offset:26176
    s_waitcnt lgkmcnt(0)
    ds_write_b128 v3, v[40:43] offset:7168
    s_waitcnt vmcnt(6)
    s_barrier
    s_lshl_b32 s45, s36, 2
    s_add_u32 s45, s45, 9
    s_cmp_ge_u32 s45, 20
    s_cselect_b32 s43, 20, 0
    s_sub_u32 s45, s45, s43
    s_mul_i32 s45, s32, s45
    s_add_u32 s45, s45, s31
    s_add_u32 m0, s44, 24576
    s_nop 0
    buffer_load_dwordx4 v16, s[8:11], s45 offen  lds
    s_add_u32 m0, s44, 25600
    s_nop 0
    buffer_load_dwordx4 v17, s[8:11], s45 offen  lds
    s_add_u32 m0, s44, 26624
    s_nop 0
    buffer_load_dwordx4 v18, s[8:11], s45 offen  lds
    ds_read_b64_tr_b16 a[188:189], v19 offset:36864
    ds_read_b64_tr_b16 a[190:191], v19 offset:38400
    ds_read_b64_tr_b16 v[148:149], v19 offset:36896
    ds_read_b64_tr_b16 v[150:151], v19 offset:38432
    ds_read_b64_tr_b16 v[204:205], v19 offset:36928
    ds_read_b64_tr_b16 v[206:207], v19 offset:38464
    s_waitcnt lgkmcnt(0)
    s_waitcnt vmcnt(6)
    s_barrier
    s_lshl_b32 s45, s36, 2
    s_add_u32 s45, s45, 9
    s_cmp_ge_u32 s45, 20
    s_cselect_b32 s43, 20, 0
    s_sub_u32 s45, s45, s43
    s_mul_i32 s45, s32, s45
    s_add_u32 s45, s45, s31
    s_add_u32 m0, s44, 36864
    s_nop 0
    buffer_load_dwordx4 v16, s[12:15], s45 offen  lds
    s_add_u32 m0, s44, 37888
    s_nop 0
    buffer_load_dwordx4 v17, s[12:15], s45 offen  lds
    s_add_u32 m0, s44, 38912
    s_nop 0
    buffer_load_dwordx4 v18, s[12:15], s45 offen  lds
    ds_read_b64_tr_b16 a[32:33], v19 offset:0
    ds_read_b64_tr_b16 a[34:35], v19 offset:1536
    ds_read_b64_tr_b16 a[112:113], v19 offset:32
    ds_read_b64_tr_b16 a[114:115], v19 offset:1568
    ds_read_b64_tr_b16 v[40:41], v19 offset:64
    ds_read_b64_tr_b16 v[42:43], v19 offset:1600
    s_waitcnt lgkmcnt(0)
    ds_write_b128 v3, v[40:43] offset:8192
    s_waitcnt vmcnt(6)
    s_barrier
    s_lshl_b32 s45, s36, 2
    s_add_u32 s45, s45, 10
    s_cmp_ge_u32 s45, 20
    s_cselect_b32 s43, 20, 0
    s_sub_u32 s45, s45, s43
    s_mul_i32 s45, s32, s45
    s_add_u32 s45, s45, s31
    s_add_u32 m0, s44, 0
    s_nop 0
    buffer_load_dwordx4 v16, s[8:11], s45 offen  lds
    s_add_u32 m0, s44, 1024
    s_nop 0
    buffer_load_dwordx4 v17, s[8:11], s45 offen  lds
    s_add_u32 m0, s44, 2048
    s_nop 0
    buffer_load_dwordx4 v18, s[8:11], s45 offen  lds
    ds_read_b64_tr_b16 a[192:193], v19 offset:12288
    ds_read_b64_tr_b16 a[194:195], v19 offset:13824
    ds_read_b64_tr_b16 v[152:153], v19 offset:12320
    ds_read_b64_tr_b16 v[154:155], v19 offset:13856
    ds_read_b64_tr_b16 v[208:209], v19 offset:12352
    ds_read_b64_tr_b16 v[210:211], v19 offset:13888
    s_waitcnt lgkmcnt(0)
    s_waitcnt vmcnt(6)
    s_barrier
    s_lshl_b32 s45, s36, 2
    s_add_u32 s45, s45, 10
    s_cmp_ge_u32 s45, 20
    s_cselect_b32 s43, 20, 0
    s_sub_u32 s45, s45, s43
    s_mul_i32 s45, s32, s45
    s_add_u32 s45, s45, s31
    s_add_u32 m0, s44, 12288
    s_nop 0
    buffer_load_dwordx4 v16, s[12:15], s45 offen  lds
    s_add_u32 m0, s44, 13312
    s_nop 0
    buffer_load_dwordx4 v17, s[12:15], s45 offen  lds
    s_add_u32 m0, s44, 14336
    s_nop 0
    buffer_load_dwordx4 v18, s[12:15], s45 offen  lds
    ds_read_b64_tr_b16 a[36:37], v19 offset:24576
    ds_read_b64_tr_b16 a[38:39], v19 offset:26112
    ds_read_b64_tr_b16 a[116:117], v19 offset:24608
    ds_read_b64_tr_b16 a[118:119], v19 offset:26144
    ds_read_b64_tr_b16 v[40:41], v19 offset:24640
    ds_read_b64_tr_b16 v[42:43], v19 offset:26176
    s_waitcnt lgkmcnt(0)
    ds_write_b128 v3, v[40:43] offset:9216
    s_waitcnt vmcnt(6)
    s_barrier
    s_lshl_b32 s45, s36, 2
    s_add_u32 s45, s45, 11
    s_cmp_ge_u32 s45, 20
    s_cselect_b32 s43, 20, 0
    s_sub_u32 s45, s45, s43
    s_mul_i32 s45, s32, s45
    s_add_u32 s45, s45, s31
    s_add_u32 m0, s44, 24576
    s_nop 0
    buffer_load_dwordx4 v16, s[8:11], s45 offen  lds
    s_add_u32 m0, s44, 25600
    s_nop 0
    buffer_load_dwordx4 v17, s[8:11], s45 offen  lds
    s_add_u32 m0, s44, 26624
    s_nop 0
    buffer_load_dwordx4 v18, s[8:11], s45 offen  lds
    ds_read_b64_tr_b16 a[196:197], v19 offset:36864
    ds_read_b64_tr_b16 a[198:199], v19 offset:38400
    ds_read_b64_tr_b16 v[156:157], v19 offset:36896
    ds_read_b64_tr_b16 v[158:159], v19 offset:38432
    ds_read_b64_tr_b16 v[212:213], v19 offset:36928
    ds_read_b64_tr_b16 v[214:215], v19 offset:38464
    s_waitcnt lgkmcnt(0)
    s_waitcnt vmcnt(6)
    s_barrier
    s_lshl_b32 s45, s36, 2
    s_add_u32 s45, s45, 11
    s_cmp_ge_u32 s45, 20
    s_cselect_b32 s43, 20, 0
    s_sub_u32 s45, s45, s43
    s_mul_i32 s45, s32, s45
    s_add_u32 s45, s45, s31
    s_add_u32 m0, s44, 36864
    s_nop 0
    buffer_load_dwordx4 v16, s[12:15], s45 offen  lds
    s_add_u32 m0, s44, 37888
    s_nop 0
    buffer_load_dwordx4 v17, s[12:15], s45 offen  lds
    s_add_u32 m0, s44, 38912
    s_nop 0
    buffer_load_dwordx4 v18, s[12:15], s45 offen  lds
    ds_read_b64_tr_b16 a[40:41], v19 offset:0
    ds_read_b64_tr_b16 a[42:43], v19 offset:1536
    ds_read_b64_tr_b16 a[120:121], v19 offset:32
    ds_read_b64_tr_b16 a[122:123], v19 offset:1568
    ds_read_b64_tr_b16 v[40:41], v19 offset:64
    ds_read_b64_tr_b16 v[42:43], v19 offset:1600
    s_waitcnt lgkmcnt(0)
    ds_write_b128 v3, v[40:43] offset:10240
    s_waitcnt vmcnt(6)
    s_barrier
    s_lshl_b32 s45, s36, 2
    s_add_u32 s45, s45, 12
    s_cmp_ge_u32 s45, 20
    s_cselect_b32 s43, 20, 0
    s_sub_u32 s45, s45, s43
    s_mul_i32 s45, s32, s45
    s_add_u32 s45, s45, s31
    s_add_u32 m0, s44, 0
    s_nop 0
    buffer_load_dwordx4 v16, s[8:11], s45 offen  lds
    s_add_u32 m0, s44, 1024
    s_nop 0
    buffer_load_dwordx4 v17, s[8:11], s45 offen  lds
    s_add_u32 m0, s44, 2048
    s_nop 0
    buffer_load_dwordx4 v18, s[8:11], s45 offen  lds
    ds_read_b64_tr_b16 a[200:201], v19 offset:12288
    ds_read_b64_tr_b16 a[202:203], v19 offset:13824
    ds_read_b64_tr_b16 v[40:41], v19 offset:12320
    ds_read_b64_tr_b16 v[42:43], v19 offset:13856
    ds_read_b64_tr_b16 v[216:217], v19 offset:12352
    ds_read_b64_tr_b16 v[218:219], v19 offset:13888
    s_waitcnt lgkmcnt(0)
    ds_write_b128 v3, v[40:43] offset:20480
    s_waitcnt vmcnt(6)
    s_barrier
    s_lshl_b32 s45, s36, 2
    s_add_u32 s45, s45, 12
    s_cmp_ge_u32 s45, 20
    s_cselect_b32 s43, 20, 0
    s_sub_u32 s45, s45, s43
    s_mul_i32 s45, s32, s45
    s_add_u32 s45, s45, s31
    s_add_u32 m0, s44, 12288
    s_nop 0
    buffer_load_dwordx4 v16, s[12:15], s45 offen  lds
    s_add_u32 m0, s44, 13312
    s_nop 0
    buffer_load_dwordx4 v17, s[12:15], s45 offen  lds
    s_add_u32 m0, s44, 14336
    s_nop 0
    buffer_load_dwordx4 v18, s[12:15], s45 offen  lds
    ds_read_b64_tr_b16 a[44:45], v19 offset:24576
    ds_read_b64_tr_b16 a[46:47], v19 offset:26112
    ds_read_b64_tr_b16 a[124:125], v19 offset:24608
    ds_read_b64_tr_b16 a[126:127], v19 offset:26144
    ds_read_b64_tr_b16 v[40:41], v19 offset:24640
    ds_read_b64_tr_b16 v[42:43], v19 offset:26176
    s_waitcnt lgkmcnt(0)
    ds_write_b128 v3, v[40:43] offset:11264
    s_waitcnt vmcnt(6)
    s_barrier
    s_lshl_b32 s45, s36, 2
    s_add_u32 s45, s45, 13
    s_cmp_ge_u32 s45, 20
    s_cselect_b32 s43, 20, 0
    s_sub_u32 s45, s45, s43
    s_mul_i32 s45, s32, s45
    s_add_u32 s45, s45, s31
    s_add_u32 m0, s44, 24576
    s_nop 0
    buffer_load_dwordx4 v16, s[8:11], s45 offen  lds
    s_add_u32 m0, s44, 25600
    s_nop 0
    buffer_load_dwordx4 v17, s[8:11], s45 offen  lds
    s_add_u32 m0, s44, 26624
    s_nop 0
    buffer_load_dwordx4 v18, s[8:11], s45 offen  lds
    ds_read_b64_tr_b16 a[204:205], v19 offset:36864
    ds_read_b64_tr_b16 a[206:207], v19 offset:38400
    ds_read_b64_tr_b16 v[40:41], v19 offset:36896
    ds_read_b64_tr_b16 v[42:43], v19 offset:38432
    ds_read_b64_tr_b16 v[220:221], v19 offset:36928
    ds_read_b64_tr_b16 v[222:223], v19 offset:38464
    s_waitcnt lgkmcnt(0)
    ds_write_b128 v3, v[40:43] offset:21504
    s_waitcnt vmcnt(6)
    s_barrier
    s_lshl_b32 s45, s36, 2
    s_add_u32 s45, s45, 13
    s_cmp_ge_u32 s45, 20
    s_cselect_b32 s43, 20, 0
    s_sub_u32 s45, s45, s43
    s_mul_i32 s45, s32, s45
    s_add_u32 s45, s45, s31
    s_add_u32 m0, s44, 36864
    s_nop 0
    buffer_load_dwordx4 v16, s[12:15], s45 offen  lds
    s_add_u32 m0, s44, 37888
    s_nop 0
    buffer_load_dwordx4 v17, s[12:15], s45 offen  lds
    s_add_u32 m0, s44, 38912
    s_nop 0
    buffer_load_dwordx4 v18, s[12:15], s45 offen  lds
    ds_read_b64_tr_b16 a[48:49], v19 offset:0
    ds_read_b64_tr_b16 a[50:51], v19 offset:1536
    ds_read_b64_tr_b16 a[128:129], v19 offset:32
    ds_read_b64_tr_b16 a[130:131], v19 offset:1568
    ds_read_b64_tr_b16 v[40:41], v19 offset:64
    ds_read_b64_tr_b16 v[42:43], v19 offset:1600
    s_waitcnt lgkmcnt(0)
    ds_write_b128 v3, v[40:43] offset:12288
    s_waitcnt vmcnt(6)
    s_barrier
    s_lshl_b32 s45, s36, 2
    s_add_u32 s45, s45, 14
    s_cmp_ge_u32 s45, 20
    s_cselect_b32 s43, 20, 0
    s_sub_u32 s45, s45, s43
    s_mul_i32 s45, s32, s45
    s_add_u32 s45, s45, s31
    s_add_u32 m0, s44, 0
    s_nop 0
    buffer_load_dwordx4 v16, s[8:11], s45 offen  lds
    s_add_u32 m0, s44, 1024
    s_nop 0
    buffer_load_dwordx4 v17, s[8:11], s45 offen  lds
    s_add_u32 m0, s44, 2048
    s_nop 0
    buffer_load_dwordx4 v18, s[8:11], s45 offen  lds
    ds_read_b64_tr_b16 a[208:209], v19 offset:12288
    ds_read_b64_tr_b16 a[210:211], v19 offset:13824
    ds_read_b64_tr_b16 v[160:161], v19 offset:12320
    ds_read_b64_tr_b16 v[162:163], v19 offset:13856
    ds_read_b64_tr_b16 v[224:225], v19 offset:12352
    ds_read_b64_tr_b16 v[226:227], v19 offset:13888
    s_waitcnt lgkmcnt(0)
    s_waitcnt vmcnt(6)
    s_barrier
    s_lshl_b32 s45, s36, 2
    s_add_u32 s45, s45, 14
    s_cmp_ge_u32 s45, 20
    s_cselect_b32 s43, 20, 0
    s_sub_u32 s45, s45, s43
    s_mul_i32 s45, s32, s45
    s_add_u32 s45, s45, s31
    s_add_u32 m0, s44, 12288
    s_nop 0
    buffer_load_dwordx4 v16, s[12:15], s45 offen  lds
    s_add_u32 m0, s44, 13312
    s_nop 0
    buffer_load_dwordx4 v17, s[12:15], s45 offen  lds
    s_add_u32 m0, s44, 14336
    s_nop 0
    buffer_load_dwordx4 v18, s[12:15], s45 offen  lds
    ds_read_b64_tr_b16 a[52:53], v19 offset:24576
    ds_read_b64_tr_b16 a[54:55], v19 offset:26112
    ds_read_b64_tr_b16 a[132:133], v19 offset:24608
    ds_read_b64_tr_b16 a[134:135], v19 offset:26144
    ds_read_b64_tr_b16 v[40:41], v19 offset:24640
    ds_read_b64_tr_b16 v[42:43], v19 offset:26176
    s_waitcnt lgkmcnt(0)
    ds_write_b128 v3, v[40:43] offset:13312
    s_waitcnt vmcnt(6)
    s_barrier
    s_lshl_b32 s45, s36, 2
    s_add_u32 s45, s45, 15
    s_cmp_ge_u32 s45, 20
    s_cselect_b32 s43, 20, 0
    s_sub_u32 s45, s45, s43
    s_mul_i32 s45, s32, s45
    s_add_u32 s45, s45, s31
    s_add_u32 m0, s44, 24576
    s_nop 0
    buffer_load_dwordx4 v16, s[8:11], s45 offen  lds
    s_add_u32 m0, s44, 25600
    s_nop 0
    buffer_load_dwordx4 v17, s[8:11], s45 offen  lds
    s_add_u32 m0, s44, 26624
    s_nop 0
    buffer_load_dwordx4 v18, s[8:11], s45 offen  lds
    ds_read_b64_tr_b16 a[212:213], v19 offset:36864
    ds_read_b64_tr_b16 a[214:215], v19 offset:38400
    ds_read_b64_tr_b16 v[164:165], v19 offset:36896
    ds_read_b64_tr_b16 v[166:167], v19 offset:38432
    ds_read_b64_tr_b16 v[228:229], v19 offset:36928
    ds_read_b64_tr_b16 v[230:231], v19 offset:38464
    s_waitcnt lgkmcnt(0)
    s_waitcnt vmcnt(6)
    s_barrier
    s_lshl_b32 s45, s36, 2
    s_add_u32 s45, s45, 15
    s_cmp_ge_u32 s45, 20
    s_cselect_b32 s43, 20, 0
    s_sub_u32 s45, s45, s43
    s_mul_i32 s45, s32, s45
    s_add_u32 s45, s45, s31
    s_add_u32 m0, s44, 36864
    s_nop 0
    buffer_load_dwordx4 v16, s[12:15], s45 offen  lds
    s_add_u32 m0, s44, 37888
    s_nop 0
    buffer_load_dwordx4 v17, s[12:15], s45 offen  lds
    s_add_u32 m0, s44, 38912
    s_nop 0
    buffer_load_dwordx4 v18, s[12:15], s45 offen  lds
    ds_read_b64_tr_b16 a[56:57], v19 offset:0
    ds_read_b64_tr_b16 a[58:59], v19 offset:1536
    ds_read_b64_tr_b16 a[136:137], v19 offset:32
    ds_read_b64_tr_b16 a[138:139], v19 offset:1568
    ds_read_b64_tr_b16 v[40:41], v19 offset:64
    ds_read_b64_tr_b16 v[42:43], v19 offset:1600
    s_waitcnt lgkmcnt(0)
    ds_write_b128 v3, v[40:43] offset:14336
    s_waitcnt vmcnt(6)
    s_barrier
    s_lshl_b32 s45, s36, 2
    s_add_u32 s45, s45, 16
    s_cmp_ge_u32 s45, 20
    s_cselect_b32 s43, 20, 0
    s_sub_u32 s45, s45, s43
    s_mul_i32 s45, s32, s45
    s_add_u32 s45, s45, s31
    s_add_u32 m0, s44, 0
    s_nop 0
    buffer_load_dwordx4 v16, s[8:11], s45 offen  lds
    s_add_u32 m0, s44, 1024
    s_nop 0
    buffer_load_dwordx4 v17, s[8:11], s45 offen  lds
    s_add_u32 m0, s44, 2048
    s_nop 0
    buffer_load_dwordx4 v18, s[8:11], s45 offen  lds
    ds_read_b64_tr_b16 a[216:217], v19 offset:12288
    ds_read_b64_tr_b16 a[218:219], v19 offset:13824
    ds_read_b64_tr_b16 v[40:41], v19 offset:12320
    ds_read_b64_tr_b16 v[42:43], v19 offset:13856
    ds_read_b64_tr_b16 v[232:233], v19 offset:12352
    ds_read_b64_tr_b16 v[234:235], v19 offset:13888
    s_waitcnt lgkmcnt(0)
    ds_write_b128 v3, v[40:43] offset:22528
    s_waitcnt vmcnt(6)
    s_barrier
    s_lshl_b32 s45, s36, 2
    s_add_u32 s45, s45, 16
    s_cmp_ge_u32 s45, 20
    s_cselect_b32 s43, 20, 0
    s_sub_u32 s45, s45, s43
    s_mul_i32 s45, s32, s45
    s_add_u32 s45, s45, s31
    s_add_u32 m0, s44, 12288
    s_nop 0
    buffer_load_dwordx4 v16, s[12:15], s45 offen  lds
    s_add_u32 m0, s44, 13312
    s_nop 0
    buffer_load_dwordx4 v17, s[12:15], s45 offen  lds
    s_add_u32 m0, s44, 14336
    s_nop 0
    buffer_load_dwordx4 v18, s[12:15], s45 offen  lds
    ds_read_b64_tr_b16 a[60:61], v19 offset:24576
    ds_read_b64_tr_b16 a[62:63], v19 offset:26112
    ds_read_b64_tr_b16 a[140:141], v19 offset:24608
    ds_read_b64_tr_b16 a[142:143], v19 offset:26144
    ds_read_b64_tr_b16 v[40:41], v19 offset:24640
    ds_read_b64_tr_b16 v[42:43], v19 offset:26176
    s_waitcnt lgkmcnt(0)
    ds_write_b128 v3, v[40:43] offset:15360
    s_waitcnt vmcnt(6)
    s_barrier
    s_lshl_b32 s45, s36, 2
    s_add_u32 s45, s45, 17
    s_cmp_ge_u32 s45, 20
    s_cselect_b32 s43, 20, 0
    s_sub_u32 s45, s45, s43
    s_mul_i32 s45, s32, s45
    s_add_u32 s45, s45, s31
    s_add_u32 m0, s44, 24576
    s_nop 0
    buffer_load_dwordx4 v16, s[8:11], s45 offen  lds
    s_add_u32 m0, s44, 25600
    s_nop 0
    buffer_load_dwordx4 v17, s[8:11], s45 offen  lds
    s_add_u32 m0, s44, 26624
    s_nop 0
    buffer_load_dwordx4 v18, s[8:11], s45 offen  lds
    ds_read_b64_tr_b16 a[220:221], v19 offset:36864
    ds_read_b64_tr_b16 a[222:223], v19 offset:38400
    ds_read_b64_tr_b16 v[40:41], v19 offset:36896
    ds_read_b64_tr_b16 v[42:43], v19 offset:38432
    ds_read_b64_tr_b16 v[236:237], v19 offset:36928
    ds_read_b64_tr_b16 v[238:239], v19 offset:38464
    s_waitcnt lgkmcnt(0)
    ds_write_b128 v3, v[40:43] offset:23552
    s_waitcnt vmcnt(6)
    s_barrier
    s_lshl_b32 s45, s36, 2
    s_add_u32 s45, s45, 17
    s_cmp_ge_u32 s45, 20
    s_cselect_b32 s43, 20, 0
    s_sub_u32 s45, s45, s43
    s_mul_i32 s45, s32, s45
    s_add_u32 s45, s45, s31
    s_add_u32 m0, s44, 36864
    s_nop 0
    buffer_load_dwordx4 v16, s[12:15], s45 offen  lds
    s_add_u32 m0, s44, 37888
    s_nop 0
    buffer_load_dwordx4 v17, s[12:15], s45 offen  lds
    s_add_u32 m0, s44, 38912
    s_nop 0
    buffer_load_dwordx4 v18, s[12:15], s45 offen  lds
    ds_read_b64_tr_b16 a[64:65], v19 offset:0
    ds_read_b64_tr_b16 a[66:67], v19 offset:1536
    ds_read_b64_tr_b16 a[144:145], v19 offset:32
    ds_read_b64_tr_b16 a[146:147], v19 offset:1568
    ds_read_b64_tr_b16 v[40:41], v19 offset:64
    ds_read_b64_tr_b16 v[42:43], v19 offset:1600
    s_waitcnt lgkmcnt(0)
    ds_write_b128 v3, v[40:43] offset:16384
    s_waitcnt vmcnt(6)
    s_barrier
    v_mov_b32 v30, 0
    buffer_load_dword v31, v30, s[16:19], s28 offen offset:128 sc1
    s_lshl_b32 s45, s36, 2
    s_add_u32 s45, s45, 18
    s_cmp_ge_u32 s45, 20
    s_cselect_b32 s43, 20, 0
    s_sub_u32 s45, s45, s43
    s_mul_i32 s45, s32, s45
    s_add_u32 s45, s45, s31
    s_add_u32 m0, s44, 0
    s_nop 0
    buffer_load_dwordx4 v16, s[8:11], s45 offen  lds
    s_add_u32 m0, s44, 1024
    s_nop 0
    buffer_load_dwordx4 v17, s[8:11], s45 offen  lds
    s_add_u32 m0, s44, 2048
    s_nop 0
    buffer_load_dwordx4 v18, s[8:11], s45 offen  lds
    ds_read_b64_tr_b16 a[224:225], v19 offset:12288
    ds_read_b64_tr_b16 a[226:227], v19 offset:13824
    ds_read_b64_tr_b16 v[168:169], v19 offset:12320
    ds_read_b64_tr_b16 v[170:171], v19 offset:13856
    ds_read_b64_tr_b16 v[240:241], v19 offset:12352
    ds_read_b64_tr_b16 v[242:243], v19 offset:13888
    s_waitcnt lgkmcnt(0)
    s_waitcnt vmcnt(7)
    s_barrier
    s_lshl_b32 s45, s36, 2
    s_add_u32 s45, s45, 18
    s_cmp_ge_u32 s45, 20
    s_cselect_b32 s43, 20, 0
    s_sub_u32 s45, s45, s43
    s_mul_i32 s45, s32, s45
    s_add_u32 s45, s45, s31
    s_add_u32 m0, s44, 12288
    s_nop 0
    buffer_load_dwordx4 v16, s[12:15], s45 offen  lds
    s_add_u32 m0, s44, 13312
    s_nop 0
    buffer_load_dwordx4 v17, s[12:15], s45 offen  lds
    s_add_u32 m0, s44, 14336
    s_nop 0
    buffer_load_dwordx4 v18, s[12:15], s45 offen  lds
    ds_read_b64_tr_b16 a[68:69], v19 offset:24576
    ds_read_b64_tr_b16 a[70:71], v19 offset:26112
    ds_read_b64_tr_b16 a[148:149], v19 offset:24608
    ds_read_b64_tr_b16 a[150:151], v19 offset:26144
    ds_read_b64_tr_b16 v[40:41], v19 offset:24640
    ds_read_b64_tr_b16 v[42:43], v19 offset:26176
    s_waitcnt lgkmcnt(0)
    ds_write_b128 v3, v[40:43] offset:17408
    s_waitcnt vmcnt(7)
    s_barrier
    s_lshl_b32 s45, s36, 2
    s_add_u32 s45, s45, 19
    s_cmp_ge_u32 s45, 20
    s_cselect_b32 s43, 20, 0
    s_sub_u32 s45, s45, s43
    s_mul_i32 s45, s32, s45
    s_add_u32 s45, s45, s31
    s_add_u32 m0, s44, 24576
    s_nop 0
    buffer_load_dwordx4 v16, s[8:11], s45 offen  lds
    s_add_u32 m0, s44, 25600
    s_nop 0
    buffer_load_dwordx4 v17, s[8:11], s45 offen  lds
    s_add_u32 m0, s44, 26624
    s_nop 0
    buffer_load_dwordx4 v18, s[8:11], s45 offen  lds
    ds_read_b64_tr_b16 a[228:229], v19 offset:36864
    ds_read_b64_tr_b16 a[230:231], v19 offset:38400
    ds_read_b64_tr_b16 v[172:173], v19 offset:36896
    ds_read_b64_tr_b16 v[174:175], v19 offset:38432
    ds_read_b64_tr_b16 v[244:245], v19 offset:36928
    ds_read_b64_tr_b16 v[246:247], v19 offset:38464
    s_waitcnt lgkmcnt(0)
    s_waitcnt vmcnt(6)
    s_barrier
    s_lshl_b32 s45, s36, 2
    s_add_u32 s45, s45, 19
    s_cmp_ge_u32 s45, 20
    s_cselect_b32 s43, 20, 0
    s_sub_u32 s45, s45, s43
    s_mul_i32 s45, s32, s45
    s_add_u32 s45, s45, s31
    s_add_u32 m0, s44, 36864
    s_nop 0
    buffer_load_dwordx4 v16, s[12:15], s45 offen  lds
    s_add_u32 m0, s44, 37888
    s_nop 0
    buffer_load_dwordx4 v17, s[12:15], s45 offen  lds
    s_add_u32 m0, s44, 38912
    s_nop 0
    buffer_load_dwordx4 v18, s[12:15], s45 offen  lds
    ds_read_b64_tr_b16 a[72:73], v19 offset:0
    ds_read_b64_tr_b16 a[74:75], v19 offset:1536
    ds_read_b64_tr_b16 a[152:153], v19 offset:32
    ds_read_b64_tr_b16 a[154:155], v19 offset:1568
    ds_read_b64_tr_b16 v[40:41], v19 offset:64
    ds_read_b64_tr_b16 v[42:43], v19 offset:1600
    s_waitcnt lgkmcnt(0)
    ds_write_b128 v3, v[40:43] offset:18432
    s_waitcnt vmcnt(6)
    s_barrier
    v_cmp_le_i32 s[8:9], 0, v10
    v_cmp_le_i32 s[10:11], 1, v10
    v_cmp_le_i32 s[12:13], 2, v10
    v_cmp_le_i32 s[14:15], 3, v10
    v_cmp_le_i32 s[94:95], 16, v10
    v_cmp_le_i32 s[96:97], 17, v10
    v_cmp_le_i32 s[98:99], 18, v10
    v_cmp_le_i32 s[100:101], 19, v10
    s_branch wsc_4
ws_2:
    v_mov_b32 v30, 0
    buffer_load_dword v31, v30, s[16:19], s28 offen offset:128 sc1
    s_waitcnt vmcnt(0)
wsc_4:
    v_readfirstlane_b32 s40, v31
    s_nop 0
    s_cmp_lt_i32 s40, 0
    s_cbranch_scc1 L_restart
    s_cmp_lg_u32 s40, 0
    s_cbranch_scc1 wsd_3
    s_sleep 4
    s_add_u32 s27, s27, 1
    s_cmp_lt_u32 s27, 131072
    s_cbranch_scc1 ws_2
    s_branch L_abort
wsd_3:
    s_bfe_u32 s41, s40, 0x40010
    s_cmp_ge_u32 s41, 5
    s_cselect_b32 s28, 1, 0
    s_bfe_u32 s41, s40, 0x40018
    s_cmp_ge_u32 s41, 5
    s_cselect_b32 s41, 1, 0
    s_xor_b32 s3, s20, s41
    s_and_b32 s3, s3, 1
    s_lshl_b32 s3, s3, 14
    s_lshl_b32 s40, s23, 8
    s_add_u32 s3, s3, s40
    s_lshr_b32 s40, s20, 1
    s_lshl_b32 s40, s40, 7
    s_add_u32 s3, s3, s40
    s_add_u32 s3, s3, 327680
    v_bfe_u32 v10, v1, 4, 1
    v_xor_b32 v10, s41, v10
    v_lshlrev_b32 v10, 14, v10
    v_lshrrev_b32 v30, 5, v1
    v_lshl_add_u32 v10, v30, 7, v10
    s_mul_i32 s68, s53, 0x10001
    s_mov_b32 s69, s68
    v_mov_b32 v30, 0x40000000
    v_cndmask_b32 v10, v30, v10, s[68:69]
    s_lshl_b32 s39, s22, 3
    s_add_u32 s39, s39, s36
    s_lshl_b32 s39, s39, 13
    s_add_u32 s39, s39, 180355072
    s_mul_i32 s44, s23, 3072
    s_add_u32 m0, s44, 0
    s_add_u32 s45, m0, s39
    buffer_load_dwordx4 v2, s[4:7], s45 offen offset:0 sc1 lds
    buffer_load_dwordx4 v2, s[4:7], s45 offen offset:1024 sc1 lds
    buffer_load_dwordx4 v2, s[4:7], s45 offen offset:2048 sc1 lds
    ds_read_b64_tr_b16 a[232:233], v19 offset:12288
    ds_read_b64_tr_b16 a[234:235], v19 offset:13824
    ds_read_b64_tr_b16 v[40:41], v19 offset:12320
    ds_read_b64_tr_b16 v[42:43], v19 offset:13856
    ds_read_b64_tr_b16 v[248:249], v19 offset:12352
    ds_read_b64_tr_b16 v[250:251], v19 offset:13888
    s_waitcnt lgkmcnt(0)
    ds_write_b128 v3, v[40:43] offset:24576
    s_waitcnt vmcnt(6)
    s_barrier
    s_mul_i32 s44, s23, 3072
    s_add_u32 m0, s44, 12288
    s_add_u32 s45, m0, s39
    buffer_load_dwordx4 v2, s[4:7], s45 offen offset:0 sc1 lds
    buffer_load_dwordx4 v2, s[4:7], s45 offen offset:1024 sc1 lds
    buffer_load_dwordx4 v2, s[4:7], s45 offen offset:2048 sc1 lds
    ds_read_b64_tr_b16 a[76:77], v19 offset:24576
    ds_read_b64_tr_b16 a[78:79], v19 offset:26112
    ds_read_b64_tr_b16 a[156:157], v19 offset:24608
    ds_read_b64_tr_b16 a[158:159], v19 offset:26144
    ds_read_b64_tr_b16 v[40:41], v19 offset:24640
    ds_read_b64_tr_b16 v[42:43], v19 offset:26176
    s_waitcnt lgkmcnt(0)
    ds_write_b128 v3, v[40:43] offset:19456
    s_waitcnt vmcnt(6)
    s_barrier
    s_mul_i32 s44, s23, 3072
    s_add_u32 m0, s44, 24576
    s_add_u32 s45, m0, s39
    buffer_load_dwordx4 v2, s[4:7], s45 offen offset:0 sc1 lds
    buffer_load_dwordx4 v2, s[4:7], s45 offen offset:1024 sc1 lds
    buffer_load_dwordx4 v2, s[4:7], s45 offen offset:2048 sc1 lds
    ds_read_b64_tr_b16 a[236:237], v19 offset:36864
    ds_read_b64_tr_b16 a[238:239], v19 offset:38400
    ds_read_b64_tr_b16 v[40:41], v19 offset:36896
    ds_read_b64_tr_b16 v[42:43], v19 offset:38432
    ds_read_b64_tr_b16 v[252:253], v19 offset:36928
    ds_read_b64_tr_b16 v[254:255], v19 offset:38464
    s_waitcnt lgkmcnt(0)
    ds_write_b128 v3, v[40:43] offset:25600
    s_waitcnt vmcnt(0)
    s_waitcnt lgkmcnt(0)
    s_barrier
    s_mov_b32 s26, s22
    s_mov_b64 s[66:67], 0
    s_mov_b32 s51, 0
    s_mov_b32 s32, 0x40000000
    s_mov_b32 s69, s32
    s_mov_b32 s42, s24
    s_mov_b32 s43, s24
.p2align 6
L_QK_loop:
    ds_read_b128 v[88:91], v2 offset:0
    ds_read_b128 v[92:95], v2 offset:1024
    ds_read_b128 v[112:115], v3 offset:0
    ds_read_b128 v[96:99], v2 offset:2048
    ds_read_b128 v[100:103], v2 offset:3072
    ds_read_b128 v[120:123], v3 offset:1024
    s_mov_b32 s33, s51
    s_waitcnt lgkmcnt(3)
    v_mfma_f32_16x16x32_bf16 v[40:43], a[0:3], v[88:91], 0
    ds_read_b128 v[104:107], v2 offset:4096
    v_mfma_f32_16x16x32_bf16 v[44:47], a[0:3], v[92:95], 0
    ds_read_b128 v[108:111], v2 offset:5120
    v_mfma_f32_16x16x32_bf16 v[48:51], a[80:83], v[88:91], 0
    ds_read_b128 v[128:131], v3 offset:2048
    v_mfma_f32_16x16x32_bf16 v[52:55], a[80:83], v[92:95], 0
    ds_write_b64 v7, v[28:29] offset:53248
    v_mfma_f32_16x16x32_bf16 v[56:59], v[112:115], v[88:91], 0
    ds_write_b64 v7, v[32:33] offset:53256
    v_mfma_f32_16x16x32_bf16 v[60:63], v[112:115], v[92:95], 0
    ds_write_b128 v7, v[116:119] offset:40960
    v_mfma_f32_16x16x32_bf16 v[64:67], a[160:163], v[88:91], 0
    s_lshr_b32 s40, s23, 1
    s_lshl_b32 s41, s40, 3
    s_lshl_b32 s40, s40, 12
    v_mfma_f32_16x16x32_bf16 v[68:71], a[160:163], v[92:95], 0
    ds_write_b128 v7, v[124:127] offset:45056
    v_mfma_f32_16x16x32_bf16 v[72:75], a[240:243], v[88:91], 0
    v_add_u32 v38, s40, v2
    v_add_u32 v39, s40, v38
    v_mfma_f32_16x16x32_bf16 v[76:79], a[240:243], v[92:95], 0
    ds_write_b128 v7, v[132:135] offset:49152
    v_mfma_f32_16x16x32_bf16 v[80:83], v[176:179], v[88:91], 0
    v_mov_b32 v37, 3494803967
    v_add_u32 v36, s41, v2
    v_mfma_f32_16x16x32_bf16 v[84:87], v[176:179], v[92:95], 0
    s_waitcnt lgkmcnt(8)
    v_mfma_f32_16x16x32_bf16 v[40:43], a[4:7], v[96:99], v[40:43]
    ds_read_b128 v[88:91], v2 offset:6144
    v_mfma_f32_16x16x32_bf16 v[44:47], a[4:7], v[100:103], v[44:47]
    ds_read_b128 v[92:95], v2 offset:7168
    v_mfma_f32_16x16x32_bf16 v[48:51], a[84:87], v[96:99], v[48:51]
    ds_read_b128 v[112:115], v3 offset:3072
    v_mfma_f32_16x16x32_bf16 v[52:55], a[84:87], v[100:103], v[52:55]
    s_waitcnt lgkmcnt(3)
    s_barrier
    v_mfma_f32_16x16x32_bf16 v[56:59], v[120:123], v[96:99], v[56:59]
    ds_read_b128 v[16:19], v38 offset:40960
    v_mfma_f32_16x16x32_bf16 v[60:63], v[120:123], v[100:103], v[60:63]
    ds_read_b128 v[20:23], v39 offset:40960
    v_mfma_f32_16x16x32_bf16 v[64:67], a[164:167], v[96:99], v[64:67]
    ds_read_b64 v[24:25], v36 offset:53248
    v_mfma_f32_16x16x32_bf16 v[68:71], a[164:167], v[100:103], v[68:71]
    ds_read_b128 v[26:29], v38 offset:41984
    v_mfma_f32_16x16x32_bf16 v[72:75], a[244:247], v[96:99], v[72:75]
    ds_read_b128 v[30:33], v39 offset:41984
    v_mfma_f32_16x16x32_bf16 v[76:79], a[244:247], v[100:103], v[76:79]
    ds_read_b64 v[34:35], v36 offset:54272
    v_mfma_f32_16x16x32_bf16 v[80:83], v[180:183], v[96:99], v[80:83]
    ds_read_b128 v[116:119], v38 offset:43008
    v_mfma_f32_16x16x32_bf16 v[84:87], v[180:183], v[100:103], v[84:87]
    s_waitcnt lgkmcnt(15)
    ds_read_b128 v[124:127], v39 offset:43008
    v_mfma_f32_16x16x32_bf16 v[40:43], a[8:11], v[104:107], v[40:43]
    ds_read_b128 v[96:99], v2 offset:8192
    v_mfma_f32_16x16x32_bf16 v[44:47], a[8:11], v[108:111], v[44:47]
    ds_read_b128 v[100:103], v2 offset:9216
    v_mfma_f32_16x16x32_bf16 v[48:51], a[88:91], v[104:107], v[48:51]
    ds_read_b128 v[120:123], v3 offset:4096
    v_mfma_f32_16x16x32_bf16 v[52:55], a[88:91], v[108:111], v[52:55]
    ds_read_b64 v[132:133], v36 offset:55296
    v_mfma_f32_16x16x32_bf16 v[56:59], v[128:131], v[104:107], v[56:59]
    v_mfma_f32_16x16x32_bf16 v[60:63], v[128:131], v[108:111], v[60:63]
    s_waitcnt lgkmcnt(6)
    v_add_f32 v16, v16, v26
    v_add_f32 v17, v17, v27
    v_mfma_f32_16x16x32_bf16 v[64:67], a[168:171], v[104:107], v[64:67]
    v_add_f32 v18, v18, v28
    v_add_f32 v19, v19, v29
    v_mfma_f32_16x16x32_bf16 v[68:71], a[168:171], v[108:111], v[68:71]
    v_add_f32 v20, v20, v30
    v_add_f32 v21, v21, v31
    v_mfma_f32_16x16x32_bf16 v[72:75], a[248:251], v[104:107], v[72:75]
    v_add_f32 v22, v22, v32
    v_add_f32 v23, v23, v33
    v_mfma_f32_16x16x32_bf16 v[76:79], a[248:251], v[108:111], v[76:79]
    v_add_f32 v24, v24, v34
    v_add_f32 v25, v25, v35
    v_mfma_f32_16x16x32_bf16 v[80:83], v[184:187], v[104:107], v[80:83]
    ds_read_b128 v[26:29], v38 offset:44032
    v_mfma_f32_16x16x32_bf16 v[84:87], v[184:187], v[108:111], v[84:87]
    s_waitcnt lgkmcnt(13)
    ds_read_b128 v[30:33], v39 offset:44032
    v_mfma_f32_16x16x32_bf16 v[40:43], a[12:15], v[88:91], v[40:43]
    ds_read_b128 v[104:107], v2 offset:10240
    v_mfma_f32_16x16x32_bf16 v[44:47], a[12:15], v[92:95], v[44:47]
    ds_read_b128 v[108:111], v2 offset:11264
    v_mfma_f32_16x16x32_bf16 v[48:51], a[92:95], v[88:91], v[48:51]
    ds_read_b128 v[128:131], v3 offset:5120
    v_mfma_f32_16x16x32_bf16 v[52:55], a[92:95], v[92:95], v[52:55]
    ds_read_b64 v[34:35], v36 offset:56320
    v_mfma_f32_16x16x32_bf16 v[56:59], v[112:115], v[88:91], v[56:59]
    s_waitcnt lgkmcnt(6)
    v_add_f32 v16, v16, v116
    v_add_f32 v17, v17, v117
    v_mfma_f32_16x16x32_bf16 v[60:63], v[112:115], v[92:95], v[60:63]
    v_add_f32 v18, v18, v118
    v_add_f32 v19, v19, v119
    v_mfma_f32_16x16x32_bf16 v[64:67], a[172:175], v[88:91], v[64:67]
    v_add_f32 v20, v20, v124
    v_add_f32 v21, v21, v125
    v_mfma_f32_16x16x32_bf16 v[68:71], a[172:175], v[92:95], v[68:71]
    v_add_f32 v22, v22, v126
    v_add_f32 v23, v23, v127
    v_mfma_f32_16x16x32_bf16 v[72:75], a[252:255], v[88:91], v[72:75]
    v_add_f32 v24, v24, v132
    v_add_f32 v25, v25, v133
    v_mfma_f32_16x16x32_bf16 v[76:79], a[252:255], v[92:95], v[76:79]
    s_waitcnt lgkmcnt(0)
    v_add_f32 v16, v16, v26
    v_add_f32 v17, v17, v27
    v_mfma_f32_16x16x32_bf16 v[80:83], v[188:191], v[88:91], v[80:83]
    v_add_f32 v18, v18, v28
    v_add_f32 v19, v19, v29
    v_mfma_f32_16x16x32_bf16 v[84:87], v[188:191], v[92:95], v[84:87]
    s_waitcnt lgkmcnt(7)
    v_add_f32 v20, v20, v30
    v_add_f32 v21, v21, v31
    v_mfma_f32_16x16x32_bf16 v[40:43], a[16:19], v[96:99], v[40:43]
    ds_read_b128 v[88:91], v2 offset:12288
    v_add_f32 v22, v22, v32
    v_mfma_f32_16x16x32_bf16 v[44:47], a[16:19], v[100:103], v[44:47]
    ds_read_b128 v[92:95], v2 offset:13312
    v_add_f32 v23, v23, v33
    v_mfma_f32_16x16x32_bf16 v[48:51], a[96:99], v[96:99], v[48:51]
    ds_read_b128 v[112:115], v3 offset:6144
    v_add_f32 v24, v24, v34
    v_mfma_f32_16x16x32_bf16 v[52:55], a[96:99], v[100:103], v[52:55]
    v_add_f32 v25, v25, v35
    v_cndmask_b32 v16, v37, v16, s[8:9]
    v_mfma_f32_16x16x32_bf16 v[56:59], v[120:123], v[96:99], v[56:59]
    v_cndmask_b32 v17, v37, v17, s[10:11]
    v_cndmask_b32 v18, v37, v18, s[12:13]
    v_mfma_f32_16x16x32_bf16 v[60:63], v[120:123], v[100:103], v[60:63]
    v_cndmask_b32 v19, v37, v19, s[14:15]
    v_cndmask_b32 v20, v37, v20, s[94:95]
    v_mfma_f32_16x16x32_bf16 v[64:67], a[176:179], v[96:99], v[64:67]
    v_cndmask_b32 v21, v37, v21, s[96:97]
    v_cndmask_b32 v22, v37, v22, s[98:99]
    v_mfma_f32_16x16x32_bf16 v[68:71], a[176:179], v[100:103], v[68:71]
    v_cndmask_b32 v23, v37, v23, s[100:101]
    v_max3_f32 v34, v16, v17, v18
    v_mfma_f32_16x16x32_bf16 v[72:75], v[136:139], v[96:99], v[72:75]
    v_max3_f32 v34, v34, v19, v20
    v_max3_f32 v34, v34, v21, v22
    v_mfma_f32_16x16x32_bf16 v[76:79], v[136:139], v[100:103], v[76:79]
    v_max3_f32 v34, v34, v23, v24
    v_max_f32 v34, v34, v25
    v_mfma_f32_16x16x32_bf16 v[80:83], v[192:195], v[96:99], v[80:83]
    v_mov_b32 v36, v34
    v_mfma_f32_16x16x32_bf16 v[84:87], v[192:195], v[100:103], v[84:87]
    s_waitcnt lgkmcnt(4)
    v_permlane16_swap_b32 v34, v36
    v_mfma_f32_16x16x32_bf16 v[40:43], a[20:23], v[104:107], v[40:43]
    ds_read_b128 v[96:99], v2 offset:14336
    v_max_f32 v34, v34, v36
    v_mfma_f32_16x16x32_bf16 v[44:47], a[20:23], v[108:111], v[44:47]
    ds_read_b128 v[100:103], v2 offset:15360
    v_mov_b32 v36, v34
    v_mfma_f32_16x16x32_bf16 v[48:51], a[100:103], v[104:107], v[48:51]
    ds_read_b128 v[120:123], v3 offset:7168
    v_mfma_f32_16x16x32_bf16 v[52:55], a[100:103], v[108:111], v[52:55]
    v_permlane32_swap_b32 v34, v36
    v_mfma_f32_16x16x32_bf16 v[56:59], v[128:131], v[104:107], v[56:59]
    v_max_f32 v34, v34, v36
    v_mul_f32 v34, s54, v34
    v_mfma_f32_16x16x32_bf16 v[60:63], v[128:131], v[108:111], v[60:63]
    v_fma_f32 v16, v16, s54, -v34
    v_fma_f32 v17, v17, s54, -v34
    v_mfma_f32_16x16x32_bf16 v[64:67], a[180:183], v[104:107], v[64:67]
    v_fma_f32 v18, v18, s54, -v34
    v_fma_f32 v19, v19, s54, -v34
    v_mfma_f32_16x16x32_bf16 v[68:71], a[180:183], v[108:111], v[68:71]
    v_fma_f32 v20, v20, s54, -v34
    v_fma_f32 v21, v21, s54, -v34
    v_mfma_f32_16x16x32_bf16 v[72:75], v[140:143], v[104:107], v[72:75]
    v_fma_f32 v22, v22, s54, -v34
    v_fma_f32 v23, v23, s54, -v34
    v_mfma_f32_16x16x32_bf16 v[76:79], v[140:143], v[108:111], v[76:79]
    v_fma_f32 v24, v24, s54, -v34
    v_fma_f32 v25, v25, s54, -v34
    v_mfma_f32_16x16x32_bf16 v[80:83], v[196:199], v[104:107], v[80:83]
    v_exp_f32 v16, v16
    v_mfma_f32_16x16x32_bf16 v[84:87], v[196:199], v[108:111], v[84:87]
    s_waitcnt lgkmcnt(3)
    v_exp_f32 v17, v17
    v_mfma_f32_16x16x32_bf16 v[40:43], a[24:27], v[88:91], v[40:43]
    ds_read_b128 v[104:107], v2 offset:16384
    v_mfma_f32_16x16x32_bf16 v[44:47], a[24:27], v[92:95], v[44:47]
    ds_read_b128 v[108:111], v2 offset:17408
    v_mfma_f32_16x16x32_bf16 v[48:51], a[104:107], v[88:91], v[48:51]
    ds_read_b128 v[128:131], v3 offset:8192
    v_mfma_f32_16x16x32_bf16 v[52:55], a[104:107], v[92:95], v[52:55]
    v_exp_f32 v18, v18
    v_mfma_f32_16x16x32_bf16 v[56:59], v[112:115], v[88:91], v[56:59]
    v_exp_f32 v19, v19
    v_mfma_f32_16x16x32_bf16 v[60:63], v[112:115], v[92:95], v[60:63]
    v_exp_f32 v20, v20
    v_mfma_f32_16x16x32_bf16 v[64:67], a[184:187], v[88:91], v[64:67]
    v_exp_f32 v21, v21
    v_mfma_f32_16x16x32_bf16 v[68:71], a[184:187], v[92:95], v[68:71]
    v_exp_f32 v22, v22
    v_mfma_f32_16x16x32_bf16 v[72:75], v[144:147], v[88:91], v[72:75]
    v_exp_f32 v23, v23
    v_mfma_f32_16x16x32_bf16 v[76:79], v[144:147], v[92:95], v[76:79]
    v_exp_f32 v24, v24
    v_mfma_f32_16x16x32_bf16 v[80:83], v[200:203], v[88:91], v[80:83]
    v_exp_f32 v25, v25
    v_mfma_f32_16x16x32_bf16 v[84:87], v[200:203], v[92:95], v[84:87]
    s_waitcnt lgkmcnt(3)
    v_add_f32 v34, v16, v17
    v_add_f32 v34, v34, v18
    v_mfma_f32_16x16x32_bf16 v[40:43], a[28:31], v[96:99], v[40:43]
    ds_read_b128 v[88:91], v2 offset:18432
    v_add_f32 v34, v34, v19
    v_mfma_f32_16x16x32_bf16 v[44:47], a[28:31], v[100:103], v[44:47]
    ds_read_b128 v[92:95], v2 offset:19456
    v_mfma_f32_16x16x32_bf16 v[48:51], a[108:111], v[96:99], v[48:51]
    ds_read_b128 v[112:115], v3 offset:9216
    v_mfma_f32_16x16x32_bf16 v[52:55], a[108:111], v[100:103], v[52:55]
    s_mul_i32 s44, s23, 3072
    s_add_u32 m0, s44, 28672
    s_add_u32 s45, m0, s39
    v_mfma_f32_16x16x32_bf16 v[56:59], v[120:123], v[96:99], v[56:59]
    buffer_load_dwordx4 v2, s[4:7], s45 offen offset:0 sc1 lds
    v_mfma_f32_16x16x32_bf16 v[60:63], v[120:123], v[100:103], v[60:63]
    buffer_store_dword v6, v10, s[4:7], s32 offen sc1
    v_mfma_f32_16x16x32_bf16 v[64:67], a[188:191], v[96:99], v[64:67]
    v_add_f32 v34, v34, v20
    v_add_f32 v34, v34, v21
    v_mfma_f32_16x16x32_bf16 v[68:71], a[188:191], v[100:103], v[68:71]
    v_add_f32 v34, v34, v22
    v_add_f32 v34, v34, v23
    v_mfma_f32_16x16x32_bf16 v[72:75], v[148:151], v[96:99], v[72:75]
    buffer_load_dwordx4 v2, s[4:7], s45 offen offset:1024 sc1 lds
    v_mfma_f32_16x16x32_bf16 v[76:79], v[148:151], v[100:103], v[76:79]
    v_add_f32 v34, v34, v24
    v_add_f32 v34, v34, v25
    v_mfma_f32_16x16x32_bf16 v[80:83], v[204:207], v[96:99], v[80:83]
    v_mov_b32 v36, v34
    v_mfma_f32_16x16x32_bf16 v[84:87], v[204:207], v[100:103], v[84:87]
    s_waitcnt lgkmcnt(3)
    v_permlane16_swap_b32 v34, v36
    v_mfma_f32_16x16x32_bf16 v[40:43], a[32:35], v[104:107], v[40:43]
    ds_read_b128 v[96:99], v2 offset:20480
    v_add_f32 v34, v34, v36
    v_mfma_f32_16x16x32_bf16 v[44:47], a[32:35], v[108:111], v[44:47]
    ds_read_b128 v[100:103], v2 offset:21504
    v_mov_b32 v36, v34
    v_mfma_f32_16x16x32_bf16 v[48:51], a[112:115], v[104:107], v[48:51]
    ds_read_b128 v[120:123], v3 offset:10240
    v_mfma_f32_16x16x32_bf16 v[52:55], a[112:115], v[108:111], v[52:55]
    ds_read_b128 v[124:127], v3 offset:20480
    v_mfma_f32_16x16x32_bf16 v[56:59], v[128:131], v[104:107], v[56:59]
    buffer_load_dwordx4 v2, s[4:7], s45 offen offset:2048 sc1 lds
    v_mfma_f32_16x16x32_bf16 v[60:63], v[128:131], v[108:111], v[60:63]
    s_add_u32 s39, s39, 131072
    v_mfma_f32_16x16x32_bf16 v[64:67], a[192:195], v[104:107], v[64:67]
    v_permlane32_swap_b32 v34, v36
    v_mfma_f32_16x16x32_bf16 v[68:71], a[192:195], v[108:111], v[68:71]
    v_add_f32 v34, v34, v36
    v_mfma_f32_16x16x32_bf16 v[72:75], v[152:155], v[104:107], v[72:75]
    v_rcp_f32 v34, v34
    v_mfma_f32_16x16x32_bf16 v[76:79], v[152:155], v[108:111], v[76:79]
    v_mul_f32 v16, v16, v34
    v_mul_f32 v17, v17, v34
    v_mfma_f32_16x16x32_bf16 v[80:83], v[208:211], v[104:107], v[80:83]
    v_mul_f32 v18, v18, v34
    v_mul_f32 v19, v19, v34
    v_mfma_f32_16x16x32_bf16 v[84:87], v[208:211], v[108:111], v[84:87]
    s_waitcnt lgkmcnt(4)
    v_mul_f32 v20, v20, v34
    v_mul_f32 v21, v21, v34
    v_mfma_f32_16x16x32_bf16 v[40:43], a[36:39], v[88:91], v[40:43]
    ds_read_b128 v[104:107], v2 offset:22528
    v_mul_f32 v22, v22, v34
    v_mfma_f32_16x16x32_bf16 v[44:47], a[36:39], v[92:95], v[44:47]
    ds_read_b128 v[108:111], v2 offset:23552
    v_mul_f32 v23, v23, v34
    v_mfma_f32_16x16x32_bf16 v[48:51], a[116:119], v[88:91], v[48:51]
    ds_read_b128 v[128:131], v3 offset:11264
    v_mul_f32 v24, v24, v34
    v_mfma_f32_16x16x32_bf16 v[52:55], a[116:119], v[92:95], v[52:55]
    ds_read_b128 v[132:135], v3 offset:21504
    v_mul_f32 v25, v25, v34
    v_mfma_f32_16x16x32_bf16 v[56:59], v[112:115], v[88:91], v[56:59]
    v_cvt_pk_bf16_f32 v28, v16, v17
    v_cvt_pk_bf16_f32 v29, v20, v21
    v_mfma_f32_16x16x32_bf16 v[60:63], v[112:115], v[92:95], v[60:63]
    v_cvt_pk_bf16_f32 v30, v18, v19
    v_cvt_pk_bf16_f32 v31, v22, v23
    v_mfma_f32_16x16x32_bf16 v[64:67], a[196:199], v[88:91], v[64:67]
    v_cvt_pk_bf16_f32 v32, v24, v25
    v_mfma_f32_16x16x32_bf16 v[68:71], a[196:199], v[92:95], v[68:71]
    s_mov_b64 exec, s[66:67]
    buffer_store_dwordx4 v[28:31], v2, s[4:7], s33 offen sc1
    s_mov_b64 exec, -1
    v_mfma_f32_16x16x32_bf16 v[72:75], v[156:159], v[88:91], v[72:75]
    s_mov_b64 exec, s[66:67]
    buffer_store_dword v32, v11, s[4:7], s33 offen sc1
    s_mov_b64 exec, -1
    v_mfma_f32_16x16x32_bf16 v[76:79], v[156:159], v[92:95], v[76:79]
    s_add_u32 s40, s26, 0
    s_lshr_b32 s41, s40, 2
    s_xor_b32 s41, s41, s40
    v_mfma_f32_16x16x32_bf16 v[80:83], v[212:215], v[88:91], v[80:83]
    s_xor_b32 s41, s41, s28
    s_and_b32 s41, s41, 1
    s_lshl_b32 s41, s41, 13
    v_mfma_f32_16x16x32_bf16 v[84:87], v[212:215], v[92:95], v[84:87]
    s_waitcnt lgkmcnt(4)
    v_mfma_f32_16x16x32_bf16 v[40:43], a[40:43], v[96:99], v[40:43]
    ds_read_b128 v[88:91], v2 offset:24576
    v_mfma_f32_16x16x32_bf16 v[44:47], a[40:43], v[100:103], v[44:47]
    ds_read_b128 v[92:95], v2 offset:25600
    v_mfma_f32_16x16x32_bf16 v[48:51], a[120:123], v[96:99], v[48:51]
    ds_read_b128 v[112:115], v3 offset:12288
    v_mfma_f32_16x16x32_bf16 v[52:55], a[120:123], v[100:103], v[52:55]
    s_lshr_b32 s40, s40, 1
    s_lshl_b32 s40, s40, 20
    s_or_b32 s35, s40, s41
    v_mfma_f32_16x16x32_bf16 v[56:59], v[120:123], v[96:99], v[56:59]
    s_add_u32 s40, s26, 0
    s_xor_b32 s41, s40, s28
    s_and_b32 s41, s41, 1
    v_mfma_f32_16x16x32_bf16 v[60:63], v[120:123], v[100:103], v[60:63]
    s_lshl_b32 s41, s41, 13
    s_lshr_b32 s40, s40, 1
    s_lshl_b32 s40, s40, 22
    v_mfma_f32_16x16x32_bf16 v[64:67], a[200:203], v[96:99], v[64:67]
    s_add_u32 s40, s40, 37748736
    s_or_b32 s37, s40, s41
    s_add_u32 s51, s37, s52
    v_mfma_f32_16x16x32_bf16 v[68:71], a[200:203], v[100:103], v[68:71]
    s_and_b32 s57, s3, 0x4000
    s_add_u32 s57, s57, s35
    s_add_u32 s40, s36, 0
    v_mfma_f32_16x16x32_bf16 v[72:75], v[124:127], v[96:99], v[72:75]
    s_cmp_ge_u32 s40, 5
    s_cselect_b32 s41, 5, 0
    s_sub_u32 s40, s40, s41
    v_mfma_f32_16x16x32_bf16 v[76:79], v[124:127], v[100:103], v[76:79]
    s_lshl_b32 s40, s40, 15
    s_add_u32 s46, s57, s40
    s_add_u32 s40, s36, 1
    v_mfma_f32_16x16x32_bf16 v[80:83], v[216:219], v[96:99], v[80:83]
    s_cmp_ge_u32 s40, 5
    s_cselect_b32 s41, 5, 0
    s_sub_u32 s40, s40, s41
    v_mfma_f32_16x16x32_bf16 v[84:87], v[216:219], v[100:103], v[84:87]
    s_waitcnt lgkmcnt(3)
    v_mfma_f32_16x16x32_bf16 v[40:43], a[44:47], v[104:107], v[40:43]
    ds_read_b128 v[96:99], v2 offset:26624
    v_mfma_f32_16x16x32_bf16 v[44:47], a[44:47], v[108:111], v[44:47]
    ds_read_b128 v[100:103], v2 offset:27648
    v_mfma_f32_16x16x32_bf16 v[48:51], a[124:127], v[104:107], v[48:51]
    ds_read_b128 v[120:123], v3 offset:13312
    v_mfma_f32_16x16x32_bf16 v[52:55], a[124:127], v[108:111], v[52:55]
    s_lshl_b32 s40, s40, 15
    s_add_u32 s47, s57, s40
    s_add_u32 s40, s36, 2
    v_mfma_f32_16x16x32_bf16 v[56:59], v[128:131], v[104:107], v[56:59]
    s_cmp_ge_u32 s40, 5
    s_cselect_b32 s41, 5, 0
    s_sub_u32 s40, s40, s41
    v_mfma_f32_16x16x32_bf16 v[60:63], v[128:131], v[108:111], v[60:63]
    s_lshl_b32 s40, s40, 15
    s_add_u32 s48, s57, s40
    s_add_u32 s40, s36, 3
    v_mfma_f32_16x16x32_bf16 v[64:67], a[204:207], v[104:107], v[64:67]
    s_cmp_ge_u32 s40, 5
    s_cselect_b32 s41, 5, 0
    s_sub_u32 s40, s40, s41
    v_mfma_f32_16x16x32_bf16 v[68:71], a[204:207], v[108:111], v[68:71]
    s_lshl_b32 s40, s40, 15
    s_add_u32 s56, s57, s40
    s_add_u32 s40, s36, 4
    v_mfma_f32_16x16x32_bf16 v[72:75], v[132:135], v[104:107], v[72:75]
    s_cmp_ge_u32 s40, 5
    s_cselect_b32 s41, 5, 0
    s_sub_u32 s40, s40, s41
    v_mfma_f32_16x16x32_bf16 v[76:79], v[132:135], v[108:111], v[76:79]
    s_lshl_b32 s40, s40, 15
    s_add_u32 s57, s57, s40
    s_add_u32 s50, s35, s3
    v_mfma_f32_16x16x32_bf16 v[80:83], v[220:223], v[104:107], v[80:83]
    s_mov_b32 s34, 0
    s_mov_b64 s[66:67], s[64:65]
    s_lshl_b32 s40, s20, 8
    v_mfma_f32_16x16x32_bf16 v[84:87], v[220:223], v[108:111], v[84:87]
    s_waitcnt lgkmcnt(3)
    s_waitcnt vmcnt(0)
    s_barrier
    v_mfma_f32_16x16x32_bf16 v[40:43], a[48:51], v[88:91], v[40:43]
    ds_read_b128 v[104:107], v2 offset:28672
    v_mfma_f32_16x16x32_bf16 v[44:47], a[48:51], v[92:95], v[44:47]
    ds_read_b128 v[108:111], v2 offset:29696
    v_mfma_f32_16x16x32_bf16 v[48:51], a[128:131], v[88:91], v[48:51]
    ds_read_b128 v[128:131], v3 offset:14336
    v_mfma_f32_16x16x32_bf16 v[52:55], a[128:131], v[92:95], v[52:55]
    ds_read_b128 v[132:135], v3 offset:22528
    v_mfma_f32_16x16x32_bf16 v[56:59], v[112:115], v[88:91], v[56:59]
    s_add_u32 s40, s40, s35
    s_add_u32 s38, s40, 328704
    s_add_u32 s32, s40, 329728
    v_mfma_f32_16x16x32_bf16 v[60:63], v[112:115], v[92:95], v[60:63]
    s_cmp_lt_u32 s26, 2
    s_cselect_b32 s30, s69, s38
    v_mfma_f32_16x16x32_bf16 v[64:67], a[208:211], v[88:91], v[64:67]
    s_cmp_lt_u32 s26, 2
    s_cselect_b32 s31, s38, s69
    s_and_b32 s40, s3, 0x4000
    v_mfma_f32_16x16x32_bf16 v[68:71], a[208:211], v[92:95], v[68:71]
    s_add_u32 s29, s35, s40
    s_xor_b32 s49, s29, 0x4000
    v_mfma_f32_16x16x32_bf16 v[72:75], v[160:163], v[88:91], v[72:75]
    v_mfma_f32_16x16x32_bf16 v[76:79], v[160:163], v[92:95], v[76:79]
    v_mfma_f32_16x16x32_bf16 v[80:83], v[224:227], v[88:91], v[80:83]
    v_mfma_f32_16x16x32_bf16 v[84:87], v[224:227], v[92:95], v[84:87]
    s_waitcnt lgkmcnt(4)
    v_mfma_f32_16x16x32_bf16 v[40:43], a[52:55], v[96:99], v[40:43]
    ds_read_b128 v[88:91], v2 offset:30720
    v_mfma_f32_16x16x32_bf16 v[44:47], a[52:55], v[100:103], v[44:47]
    ds_read_b128 v[92:95], v2 offset:31744
    v_mfma_f32_16x16x32_bf16 v[48:51], a[132:135], v[96:99], v[48:51]
    ds_read_b128 v[112:115], v3 offset:15360
    v_mfma_f32_16x16x32_bf16 v[52:55], a[132:135], v[100:103], v[52:55]
    ds_read_b128 v[116:119], v3 offset:23552
    v_mfma_f32_16x16x32_bf16 v[56:59], v[120:123], v[96:99], v[56:59]
    v_mfma_f32_16x16x32_bf16 v[60:63], v[120:123], v[100:103], v[60:63]
    v_mfma_f32_16x16x32_bf16 v[64:67], a[212:215], v[96:99], v[64:67]
    v_mfma_f32_16x16x32_bf16 v[68:71], a[212:215], v[100:103], v[68:71]
    v_mfma_f32_16x16x32_bf16 v[72:75], v[164:167], v[96:99], v[72:75]
    v_mfma_f32_16x16x32_bf16 v[76:79], v[164:167], v[100:103], v[76:79]
    v_mfma_f32_16x16x32_bf16 v[80:83], v[228:231], v[96:99], v[80:83]
    v_mfma_f32_16x16x32_bf16 v[84:87], v[228:231], v[100:103], v[84:87]
    s_waitcnt lgkmcnt(4)
    s_barrier
    v_mfma_f32_16x16x32_bf16 v[40:43], a[56:59], v[104:107], v[40:43]
    ds_read_b128 v[96:99], v2 offset:32768
    v_mfma_f32_16x16x32_bf16 v[44:47], a[56:59], v[108:111], v[44:47]
    ds_read_b128 v[100:103], v2 offset:33792
    v_mfma_f32_16x16x32_bf16 v[48:51], a[136:139], v[104:107], v[48:51]
    ds_read_b128 v[120:123], v3 offset:16384
    v_mfma_f32_16x16x32_bf16 v[52:55], a[136:139], v[108:111], v[52:55]
    s_mul_i32 s44, s23, 7168
    s_add_u32 m0, s44, 0
    s_add_u32 s45, m0, s39
    v_mfma_f32_16x16x32_bf16 v[56:59], v[128:131], v[104:107], v[56:59]
    buffer_load_dwordx4 v2, s[4:7], s45 offen offset:0 sc1 lds
    v_mfma_f32_16x16x32_bf16 v[60:63], v[128:131], v[108:111], v[60:63]
    v_mfma_f32_16x16x32_bf16 v[64:67], a[216:219], v[104:107], v[64:67]
    v_mfma_f32_16x16x32_bf16 v[68:71], a[216:219], v[108:111], v[68:71]
    v_mfma_f32_16x16x32_bf16 v[72:75], v[132:135], v[104:107], v[72:75]
    buffer_load_dwordx4 v2, s[4:7], s45 offen offset:1024 sc1 lds
    v_mfma_f32_16x16x32_bf16 v[76:79], v[132:135], v[108:111], v[76:79]
    v_mfma_f32_16x16x32_bf16 v[80:83], v[232:235], v[104:107], v[80:83]
    v_mfma_f32_16x16x32_bf16 v[84:87], v[232:235], v[108:111], v[84:87]
    s_waitcnt lgkmcnt(3)
    v_mfma_f32_16x16x32_bf16 v[40:43], a[60:63], v[88:91], v[40:43]
    ds_read_b128 v[104:107], v2 offset:34816
    v_mfma_f32_16x16x32_bf16 v[44:47], a[60:63], v[92:95], v[44:47]
    ds_read_b128 v[108:111], v2 offset:35840
    v_mfma_f32_16x16x32_bf16 v[48:51], a[140:143], v[88:91], v[48:51]
    ds_read_b128 v[128:131], v3 offset:17408
    v_mfma_f32_16x16x32_bf16 v[52:55], a[140:143], v[92:95], v[52:55]
    buffer_load_dwordx4 v2, s[4:7], s45 offen offset:2048 sc1 lds
    v_mfma_f32_16x16x32_bf16 v[56:59], v[112:115], v[88:91], v[56:59]
    v_mfma_f32_16x16x32_bf16 v[60:63], v[112:115], v[92:95], v[60:63]
    v_mfma_f32_16x16x32_bf16 v[64:67], a[220:223], v[88:91], v[64:67]
    v_mfma_f32_16x16x32_bf16 v[68:71], a[220:223], v[92:95], v[68:71]
    buffer_load_dwordx4 v2, s[4:7], s45 offen offset:3072 sc1 lds
    v_mfma_f32_16x16x32_bf16 v[72:75], v[116:119], v[88:91], v[72:75]
    s_add_u32 m0, m0, 4096
    s_add_u32 s45, s45, 4096
    v_mfma_f32_16x16x32_bf16 v[76:79], v[116:119], v[92:95], v[76:79]
    v_mfma_f32_16x16x32_bf16 v[80:83], v[236:239], v[88:91], v[80:83]
    v_mfma_f32_16x16x32_bf16 v[84:87], v[236:239], v[92:95], v[84:87]
    s_waitcnt lgkmcnt(3)
    v_mfma_f32_16x16x32_bf16 v[40:43], a[64:67], v[96:99], v[40:43]
    ds_read_b128 v[88:91], v2 offset:36864
    v_mfma_f32_16x16x32_bf16 v[44:47], a[64:67], v[100:103], v[44:47]
    ds_read_b128 v[92:95], v2 offset:37888
    v_mfma_f32_16x16x32_bf16 v[48:51], a[144:147], v[96:99], v[48:51]
    ds_read_b128 v[112:115], v3 offset:18432
    v_mfma_f32_16x16x32_bf16 v[52:55], a[144:147], v[100:103], v[52:55]
    ds_read_b128 v[116:119], v3 offset:24576
    v_mfma_f32_16x16x32_bf16 v[56:59], v[120:123], v[96:99], v[56:59]
    buffer_load_dwordx4 v2, s[4:7], s45 offen offset:0 sc1 lds
    v_mfma_f32_16x16x32_bf16 v[60:63], v[120:123], v[100:103], v[60:63]
    v_mfma_f32_16x16x32_bf16 v[64:67], a[224:227], v[96:99], v[64:67]
    v_mfma_f32_16x16x32_bf16 v[68:71], a[224:227], v[100:103], v[68:71]
    v_mfma_f32_16x16x32_bf16 v[72:75], v[168:171], v[96:99], v[72:75]
    buffer_load_dwordx4 v2, s[4:7], s45 offen offset:1024 sc1 lds
    v_mfma_f32_16x16x32_bf16 v[76:79], v[168:171], v[100:103], v[76:79]
    v_mfma_f32_16x16x32_bf16 v[80:83], v[240:243], v[96:99], v[80:83]
    v_mfma_f32_16x16x32_bf16 v[84:87], v[240:243], v[100:103], v[84:87]
    s_waitcnt lgkmcnt(4)
    v_mfma_f32_16x16x32_bf16 v[40:43], a[68:71], v[104:107], v[40:43]
    ds_read_b128 v[96:99], v2 offset:38912
    v_mfma_f32_16x16x32_bf16 v[44:47], a[68:71], v[108:111], v[44:47]
    ds_read_b128 v[100:103], v2 offset:39936
    v_mfma_f32_16x16x32_bf16 v[48:51], a[148:151], v[104:107], v[48:51]
    ds_read_b128 v[120:123], v3 offset:19456
    v_mfma_f32_16x16x32_bf16 v[52:55], a[148:151], v[108:111], v[52:55]
    ds_read_b128 v[124:127], v3 offset:25600
    v_mfma_f32_16x16x32_bf16 v[56:59], v[128:131], v[104:107], v[56:59]
    buffer_load_dwordx4 v2, s[4:7], s45 offen offset:2048 sc1 lds
    v_mfma_f32_16x16x32_bf16 v[60:63], v[128:131], v[108:111], v[60:63]
    v_mfma_f32_16x16x32_bf16 v[64:67], a[228:231], v[104:107], v[64:67]
    v_mfma_f32_16x16x32_bf16 v[68:71], a[228:231], v[108:111], v[68:71]
    v_mfma_f32_16x16x32_bf16 v[72:75], v[172:175], v[104:107], v[72:75]
    v_mfma_f32_16x16x32_bf16 v[76:79], v[172:175], v[108:111], v[76:79]
    v_mfma_f32_16x16x32_bf16 v[80:83], v[244:247], v[104:107], v[80:83]
    v_mfma_f32_16x16x32_bf16 v[84:87], v[244:247], v[108:111], v[84:87]
    s_waitcnt lgkmcnt(4)
    v_mfma_f32_16x16x32_bf16 v[40:43], a[72:75], v[88:91], v[40:43]
    ds_read_b128 v[104:107], v3 offset:0
    v_mfma_f32_16x16x32_bf16 v[44:47], a[72:75], v[92:95], v[44:47]
    ds_read_b128 v[108:111], v3 offset:1024
    v_mfma_f32_16x16x32_bf16 v[48:51], a[152:155], v[88:91], v[48:51]
    v_mfma_f32_16x16x32_bf16 v[52:55], a[152:155], v[92:95], v[52:55]
    v_mfma_f32_16x16x32_bf16 v[56:59], v[112:115], v[88:91], v[56:59]
    v_mfma_f32_16x16x32_bf16 v[60:63], v[112:115], v[92:95], v[60:63]
    v_mfma_f32_16x16x32_bf16 v[64:67], a[232:235], v[88:91], v[64:67]
    buffer_load_dword v128, v6, s[4:7], s50 offen sc1
    v_mfma_f32_16x16x32_bf16 v[68:71], a[232:235], v[92:95], v[68:71]
    v_mfma_f32_16x16x32_bf16 v[72:75], v[116:119], v[88:91], v[72:75]
    v_mfma_f32_16x16x32_bf16 v[76:79], v[116:119], v[92:95], v[76:79]
    v_mfma_f32_16x16x32_bf16 v[80:83], v[248:251], v[88:91], v[80:83]
    v_mfma_f32_16x16x32_bf16 v[84:87], v[248:251], v[92:95], v[84:87]
    s_waitcnt lgkmcnt(2)
    buffer_load_dword v129, v6, s[4:7], s50 offen sc1
    v_mfma_f32_16x16x32_bf16 v[40:43], a[76:79], v[96:99], v[40:43]
    ds_read_b128 v[112:115], v3 offset:2048
    v_mfma_f32_16x16x32_bf16 v[44:47], a[76:79], v[100:103], v[44:47]
    ds_read_b128 v[116:119], v3 offset:3072
    v_mfma_f32_16x16x32_bf16 v[48:51], a[156:159], v[96:99], v[48:51]
    v_cvt_pk_bf16_f32 v16, v40, v41
    v_cvt_pk_bf16_f32 v17, v42, v43
    v_mfma_f32_16x16x32_bf16 v[52:55], a[156:159], v[100:103], v[52:55]
    v_cvt_pk_bf16_f32 v22, v44, v45
    v_cvt_pk_bf16_f32 v23, v46, v47
    v_mfma_f32_16x16x32_bf16 v[56:59], v[120:123], v[96:99], v[56:59]
    v_cvt_pk_bf16_f32 v18, v48, v49
    v_cvt_pk_bf16_f32 v19, v50, v51
    v_mfma_f32_16x16x32_bf16 v[60:63], v[120:123], v[100:103], v[60:63]
    v_cvt_pk_bf16_f32 v24, v52, v53
    v_cvt_pk_bf16_f32 v25, v54, v55
    v_mfma_f32_16x16x32_bf16 v[64:67], a[236:239], v[96:99], v[64:67]
    v_cvt_pk_bf16_f32 v20, v56, v57
    v_cvt_pk_bf16_f32 v21, v58, v59
    v_mfma_f32_16x16x32_bf16 v[68:71], a[236:239], v[100:103], v[68:71]
    v_cvt_pk_bf16_f32 v26, v60, v61
    v_cvt_pk_bf16_f32 v27, v62, v63
    v_mfma_f32_16x16x32_bf16 v[72:75], v[124:127], v[96:99], v[72:75]
    v_cvt_pk_bf16_f32 v28, v64, v65
    v_cvt_pk_bf16_f32 v29, v66, v67
    v_mfma_f32_16x16x32_bf16 v[76:79], v[124:127], v[100:103], v[76:79]
    v_cvt_pk_bf16_f32 v34, v68, v69
    v_cvt_pk_bf16_f32 v35, v70, v71
    v_mfma_f32_16x16x32_bf16 v[80:83], v[252:255], v[96:99], v[80:83]
    v_cvt_pk_bf16_f32 v30, v72, v73
    v_cvt_pk_bf16_f32 v31, v74, v75
    v_mfma_f32_16x16x32_bf16 v[84:87], v[252:255], v[100:103], v[84:87]
    v_cvt_pk_bf16_f32 v36, v76, v77
    v_cvt_pk_bf16_f32 v37, v78, v79
    buffer_load_dword v130, v6, s[4:7], s50 offen sc1
    ds_read_b128 v[120:123], v3 offset:4096
    ds_read_b128 v[124:127], v3 offset:5120
    v_cvt_pk_bf16_f32 v32, v80, v81
    v_cvt_pk_bf16_f32 v33, v82, v83
    s_nop 0
    v_cvt_pk_bf16_f32 v38, v84, v85
    v_cvt_pk_bf16_f32 v39, v86, v87
.p2align 6
poll_6:
    s_waitcnt vmcnt(2)
    v_cmp_eq_u32 vcc, -1, v128
    s_cbranch_vccz pd_7
    buffer_load_dword v128, v6, s[4:7], s50 offen sc1
    s_waitcnt vmcnt(2)
    v_cmp_eq_u32 vcc, -1, v129
    s_cbranch_vccz pd_7
    buffer_load_dword v129, v6, s[4:7], s50 offen sc1
    s_waitcnt vmcnt(2)
    v_cmp_eq_u32 vcc, -1, v130
    s_cbranch_vccz pd_7
    buffer_load_dword v130, v6, s[4:7], s50 offen sc1
    s_add_u32 s27, s27, 1
    s_cmp_lt_u32 s27, 131072
    s_cbranch_scc1 poll_6
    s_branch L_abort
.p2align 6
    s_nop 0
    s_nop 0
pd_7:
    s_barrier
    buffer_load_dwordx4 v[40:43], v2, s[4:7], s46 offen offset:0
    v_mov_b64 v[80:81], 0
    s_nop 5
    v_mov_b64 v[82:83], 0
    s_nop 5
    buffer_load_dwordx4 v[44:47], v2, s[4:7], s46 offen offset:1024
    v_mov_b64 v[84:85], 0
    s_nop 5
    v_mov_b64 v[86:87], 0
    s_nop 5
    buffer_load_dwordx4 v[48:51], v2, s[4:7], s47 offen offset:0
    v_mov_b64 v[88:89], 0
    s_nop 5
    v_mov_b64 v[90:91], 0
    s_nop 5
    buffer_load_dwordx4 v[52:55], v2, s[4:7], s47 offen offset:1024
    v_mov_b64 v[92:93], 0
    s_nop 5
    v_mov_b64 v[94:95], 0
    s_nop 5
    buffer_load_dwordx4 v[56:59], v2, s[4:7], s48 offen offset:0
    v_mov_b64 v[96:97], 0
    s_nop 5
    v_mov_b64 v[98:99], 0
    s_nop 5
    buffer_load_dwordx4 v[60:63], v2, s[4:7], s48 offen offset:1024
    v_mov_b64 v[100:101], 0
    s_nop 5
    v_mov_b64 v[102:103], 0
    s_nop 5
    buffer_load_dwordx4 v[64:67], v2, s[4:7], s56 offen offset:0
    s_waitcnt vmcnt(6)
    s_waitcnt lgkmcnt(4)
    v_smfmac_f32_16x16x64_bf16 v[92:95], v[40:43], v[104:111], v4
    ds_read_b128 v[104:107], v3 offset:6144
    v_smfmac_f32_16x16x64_bf16 v[80:83], v[40:43], a[0:7], v4
    ds_read_b128 v[108:111], v3 offset:7168
    v_smfmac_f32_16x16x64_bf16 v[84:87], v[40:43], a[160:167], v4
    buffer_load_dwordx4 v[68:71], v2, s[4:7], s56 offen offset:1024
    v_smfmac_f32_16x16x64_bf16 v[88:91], v[40:43], a[80:87], v4
    s_waitcnt vmcnt(6)
    s_waitcnt lgkmcnt(4)
    v_smfmac_f32_16x16x64_bf16 v[92:95], v[44:47], v[112:119], v4
    ds_read_b128 v[112:115], v3 offset:8192
    v_smfmac_f32_16x16x64_bf16 v[80:83], v[44:47], a[8:15], v4
    ds_read_b128 v[116:119], v3 offset:9216
    v_smfmac_f32_16x16x64_bf16 v[84:87], v[44:47], a[168:175], v4
    buffer_load_dwordx4 v[72:75], v2, s[4:7], s57 offen offset:0
    v_smfmac_f32_16x16x64_bf16 v[88:91], v[44:47], a[88:95], v4
    s_waitcnt vmcnt(6)
    s_waitcnt lgkmcnt(4)
    v_smfmac_f32_16x16x64_bf16 v[92:95], v[48:51], v[120:127], v4
    ds_read_b128 v[120:123], v3 offset:10240
    v_smfmac_f32_16x16x64_bf16 v[80:83], v[48:51], a[16:23], v4
    ds_read_b128 v[124:127], v3 offset:11264
    v_smfmac_f32_16x16x64_bf16 v[84:87], v[48:51], a[176:183], v4
    buffer_load_dwordx4 v[76:79], v2, s[4:7], s57 offen offset:1024
    v_smfmac_f32_16x16x64_bf16 v[88:91], v[48:51], a[96:103], v4
    s_waitcnt vmcnt(6)
    s_waitcnt lgkmcnt(4)
    v_smfmac_f32_16x16x64_bf16 v[92:95], v[52:55], v[104:111], v4
    ds_read_b128 v[104:107], v3 offset:12288
    v_smfmac_f32_16x16x64_bf16 v[80:83], v[52:55], a[24:31], v4
    ds_read_b128 v[108:111], v3 offset:13312
    v_smfmac_f32_16x16x64_bf16 v[84:87], v[52:55], a[184:191], v4
    v_cmp_u_f32 vcc, v40, v47
    v_smfmac_f32_16x16x64_bf16 v[88:91], v[52:55], a[104:111], v4
    s_waitcnt vmcnt(5)
    s_waitcnt lgkmcnt(4)
    v_smfmac_f32_16x16x64_bf16 v[92:95], v[56:59], v[112:119], v4
    ds_read_b128 v[112:115], v3 offset:14336
    v_smfmac_f32_16x16x64_bf16 v[80:83], v[56:59], a[32:39], v4
    ds_read_b128 v[116:119], v3 offset:15360
    v_smfmac_f32_16x16x64_bf16 v[84:87], v[56:59], a[192:199], v4
    s_cbranch_vccnz slow_8
    v_smfmac_f32_16x16x64_bf16 v[88:91], v[56:59], a[112:119], v4
    s_waitcnt vmcnt(4)
    s_waitcnt lgkmcnt(4)
    v_smfmac_f32_16x16x64_bf16 v[92:95], v[60:63], v[120:127], v4
    ds_read_b128 v[120:123], v3 offset:16384
    v_smfmac_f32_16x16x64_bf16 v[80:83], v[60:63], a[40:47], v4
    ds_read_b128 v[124:127], v3 offset:17408
    v_smfmac_f32_16x16x64_bf16 v[84:87], v[60:63], a[200:207], v4
    v_smfmac_f32_16x16x64_bf16 v[88:91], v[60:63], a[120:127], v4
    s_waitcnt vmcnt(3)
    s_waitcnt lgkmcnt(4)
    v_smfmac_f32_16x16x64_bf16 v[92:95], v[64:67], v[104:111], v4
    ds_read_b128 v[104:107], v3 offset:18432
    v_smfmac_f32_16x16x64_bf16 v[80:83], v[64:67], a[48:55], v4
    ds_read_b128 v[108:111], v3 offset:19456
    v_smfmac_f32_16x16x64_bf16 v[84:87], v[64:67], a[208:215], v4
    v_smfmac_f32_16x16x64_bf16 v[88:91], v[64:67], a[128:135], v4
    s_waitcnt vmcnt(2)
    s_waitcnt lgkmcnt(4)
    v_smfmac_f32_16x16x64_bf16 v[92:95], v[68:71], v[112:119], v4
    ds_read_b128 v[112:115], v3 offset:20480
    v_smfmac_f32_16x16x64_bf16 v[80:83], v[68:71], a[56:63], v4
    ds_read_b128 v[116:119], v3 offset:21504
    v_smfmac_f32_16x16x64_bf16 v[84:87], v[68:71], a[216:223], v4
    v_smfmac_f32_16x16x64_bf16 v[88:91], v[68:71], a[136:143], v4
    s_waitcnt vmcnt(1)
    s_waitcnt lgkmcnt(4)
    v_smfmac_f32_16x16x64_bf16 v[92:95], v[72:75], v[120:127], v4
    ds_read_b128 v[120:123], v3 offset:22528
    v_smfmac_f32_16x16x64_bf16 v[80:83], v[72:75], a[64:71], v4
    ds_read_b128 v[124:127], v3 offset:23552
    v_smfmac_f32_16x16x64_bf16 v[84:87], v[72:75], a[224:231], v4
    v_smfmac_f32_16x16x64_bf16 v[88:91], v[72:75], a[144:151], v4
    s_waitcnt vmcnt(0)
    s_waitcnt lgkmcnt(4)
    v_smfmac_f32_16x16x64_bf16 v[92:95], v[76:79], v[104:111], v4
    ds_read_b128 v[104:107], v3 offset:24576
    v_smfmac_f32_16x16x64_bf16 v[80:83], v[76:79], a[72:79], v4
    ds_read_b128 v[108:111], v3 offset:25600
    v_smfmac_f32_16x16x64_bf16 v[84:87], v[76:79], a[232:239], v4
    v_smfmac_f32_16x16x64_bf16 v[88:91], v[76:79], a[152:159], v4
ok_9:
    v_smfmac_f32_16x16x64_bf16 v[96:99], v[40:43], a[240:247], v4
    s_waitcnt lgkmcnt(4)
    v_cvt_pk_bf16_f32 v92, v92, v93
    v_smfmac_f32_16x16x64_bf16 v[96:99], v[60:63], v[112:119], v4
    v_cvt_pk_bf16_f32 v93, v94, v95
    v_smfmac_f32_16x16x64_bf16 v[96:99], v[44:47], a[248:255], v4
    v_cvt_pk_bf16_f32 v80, v80, v81
    v_mfma_f32_16x16x16_bf16 v[112:115], v[92:93], v[12:13], 0
    v_cvt_pk_bf16_f32 v81, v82, v83
    v_cvt_pk_bf16_f32 v82, v84, v85
    v_smfmac_f32_16x16x64_bf16 v[96:99], v[48:51], v[136:143], v4
    s_waitcnt lgkmcnt(0)
    v_cvt_pk_bf16_f32 v83, v86, v87
    v_smfmac_f32_16x16x64_bf16 v[96:99], v[68:71], v[120:127], v4
    v_cvt_pk_bf16_f32 v88, v88, v89
    v_mfma_f32_16x16x32_bf16 v[116:119], v[80:83], v[12:15], 0
    v_cvt_pk_bf16_f32 v89, v90, v91
    v_cmp_u_f32 vcc, v112, v114
    v_smfmac_f32_16x16x64_bf16 v[96:99], v[52:55], v[144:151], v4
    v_cvt_pk_bf16_f32 v132, v112, v113
    v_mfma_f32_16x16x16_bf16 v[120:123], v[88:89], v[12:13], 0
    v_cvt_pk_bf16_f32 v133, v114, v115
    v_cvt_pk_bf16_f32 v128, v116, v117
    v_smfmac_f32_16x16x64_bf16 v[96:99], v[56:59], v[152:159], v4
    v_cvt_pk_bf16_f32 v129, v118, v119
    v_mfma_f32_16x16x16_bf16 v[80:83], v[32:33], v[132:133], 0
    v_cvt_pk_bf16_f32 v130, v120, v121
    v_cvt_pk_bf16_f32 v131, v122, v123
    v_mfma_f32_16x16x16_bf16 v[84:87], v[38:39], v[132:133], 0
    s_cbranch_vccnz chk_10
bk_11:
    v_smfmac_f32_16x16x64_bf16 v[96:99], v[76:79], v[104:111], v4
    v_mfma_f32_16x16x32_bf16 v[80:83], v[28:31], v[128:131], v[80:83]
    v_smfmac_f32_16x16x64_bf16 v[96:99], v[64:67], v[160:167], v4
    v_smfmac_f32_16x16x64_bf16 v[96:99], v[72:75], v[168:175], v4
    ds_write_b128 v5, v[80:83]
    v_smfmac_f32_16x16x64_bf16 v[100:103], v[40:43], v[176:183], v4
    v_smfmac_f32_16x16x64_bf16 v[100:103], v[60:63], v[216:223], v4
    v_cvt_pk_bf16_f32 v96, v96, v97
    v_smfmac_f32_16x16x64_bf16 v[100:103], v[44:47], v[184:191], v4
    v_cvt_pk_bf16_f32 v97, v98, v99
    v_smfmac_f32_16x16x64_bf16 v[100:103], v[48:51], v[192:199], v4
    v_smfmac_f32_16x16x64_bf16 v[100:103], v[68:71], v[232:239], v4
    v_smfmac_f32_16x16x64_bf16 v[100:103], v[52:55], v[200:207], v4
    buffer_store_dword v6, v10, s[4:7], s30 offen sc1
    v_smfmac_f32_16x16x64_bf16 v[100:103], v[56:59], v[208:215], v4
    v_smfmac_f32_16x16x64_bf16 v[100:103], v[76:79], v[248:255], v4
    v_smfmac_f32_16x16x64_bf16 v[100:103], v[64:67], v[224:231], v4
    v_smfmac_f32_16x16x64_bf16 v[100:103], v[72:75], v[240:247], v4
    v_mfma_f32_16x16x32_bf16 v[84:87], v[34:37], v[128:131], v[84:87]
    v_mfma_f32_16x16x16_bf16 v[112:115], v[96:97], v[14:15], 0
    v_cvt_pk_bf16_f32 v100, v100, v101
    v_cvt_pk_bf16_f32 v101, v102, v103
    s_nop 0
    s_nop 0
    v_mfma_f32_16x16x16_bf16 v[116:119], v[100:101], v[14:15], 0
    ds_write_b128 v5, v[84:87] offset:32
    v_mfma_f32_16x16x16_bf16 v[92:95], v[128:129], v[128:129], 0
    v_cvt_pk_bf16_f32 v88, v112, v113
    v_cvt_pk_bf16_f32 v89, v114, v115
    s_nop 0
    s_nop 0
    v_cvt_pk_bf16_f32 v90, v116, v117
    v_cvt_pk_bf16_f32 v91, v118, v119
    s_nop 0
    s_nop 0
    v_mfma_f32_16x16x32_bf16 v[92:95], v[88:91], v[130:133], v[92:95]
    s_nop 0
    s_nop 0
    s_nop 0
    v_mov_b32 v60, 0
    s_nop 0
    s_nop 0
    s_nop 0
    s_cmp_ge_u32 s23, 2
    ds_write_b64 v8, v[92:93] offset:120
    s_cbranch_scc1 L_QK_w23
    v_mfma_f32_16x16x16_bf16 v[116:119], v[32:33], v[20:21], 0
    v_mfma_f32_16x16x16_bf16 v[124:127], v[32:33], v[26:27], 0
    v_mfma_f32_16x16x16_bf16 v[132:135], v[38:39], v[26:27], 0
    s_mov_b64 exec, s[42:43]
    s_waitcnt lgkmcnt(0)
    v_mov_b32 v61, 0
    s_barrier
    ds_read_b128 v[44:47], v0 offset:40960
    ds_read_b128 v[48:51], v0 offset:42496
    ds_read_b128 v[52:55], v0 offset:44032
    ds_read_b128 v[56:59], v0 offset:45568
    s_waitcnt lgkmcnt(2)
    v_pk_add_f32 v[44:45], v[44:45], v[48:49]
    v_pk_add_f32 v[46:47], v[46:47], v[50:51]
    v_pk_mul_f32 v[44:45], v[44:45], s[54:55]
    v_pk_mul_f32 v[46:47], v[46:47], s[54:55]
    s_waitcnt lgkmcnt(0)
    v_pk_add_f32 v[52:53], v[52:53], v[56:57]
    v_pk_add_f32 v[54:55], v[54:55], v[58:59]
    v_pk_fma_f32 v[40:41], v[52:53], s[54:55], v[44:45]
    v_pk_fma_f32 v[42:43], v[54:55], s[54:55], v[46:47]
    v_exp_f32 v48, v40
    v_exp_f32 v49, v41
    v_exp_f32 v50, v42
    v_exp_f32 v51, v43
    v_max3_f32 v52, abs(v40), abs(v41), abs(v42)
    v_pk_add_f32 v[62:63], v[48:49], v[50:51]
    v_add_f32 v60, v62, v63
    s_mov_b64 exec, -1
    v_max_f32 v52, abs(v43), v52
    v_add_f32_dpp v60, v60, v60 quad_perm:[1,0,3,2] row_mask:0xf bank_mask:0xf
    v_cmp_lt_f32 vcc, 1115684864, v52
    s_nop 0
    v_add_f32_dpp v60, v60, v60 quad_perm:[2,3,0,1] row_mask:0xf bank_mask:0xf
    s_nop 1
    v_add_f32_dpp v60, v60, v60 row_half_mirror row_mask:0xf bank_mask:0xf
    s_and_b64 vcc, vcc, s[60:61]
    s_cselect_b64 s[62:63], 0, s[42:43]
    v_add_f32_dpp v60, v60, v60 row_ror:8 row_mask:0xf bank_mask:0xf
L_QK_maxd:
    v_rcp_f32 v60, v60
    s_mov_b64 exec, s[62:63]
    v_pk_mul_f32 v[48:49], v[48:49], v[60:61] op_sel_hi:[1,0]
    v_pk_mul_f32 v[50:51], v[50:51], v[60:61] op_sel_hi:[1,0]
    v_cvt_pk_bf16_f32 v44, v48, v49
    v_cvt_pk_bf16_f32 v45, v50, v51
    buffer_store_dwordx2 v[44:45], v9, s[4:7], s49 offen sc1
    buffer_store_dwordx2 v[44:45], v9, s[4:7], s29 offen sc1
    s_mov_b64 exec, -1
    s_cbranch_scc1 L_QK_max
    v_mfma_f32_16x16x32_bf16 v[116:119], v[28:31], v[16:19], v[116:119]
    v_mfma_f32_16x16x32_bf16 v[124:127], v[28:31], v[22:25], v[124:127]
    v_mfma_f32_16x16x32_bf16 v[132:135], v[34:37], v[22:25], v[132:135]
    v_mfma_f32_16x16x16_bf16 v[28:31], v[128:129], v[16:17], 0
    v_mfma_f32_16x16x16_bf16 v[32:35], v[128:129], v[22:23], 0
    s_nop 1
    v_mfma_f32_16x16x32_bf16 v[28:31], v[88:91], v[18:21], v[28:31]
    s_nop 1
    v_mfma_f32_16x16x32_bf16 v[32:35], v[88:91], v[24:27], v[32:35]
L_QK_sk:
    s_barrier
    buffer_store_dword v6, v10, s[4:7], s31 offen sc1
    s_add_u32 s26, s26, 2
    s_cmp_lt_u32 s26, 64
    s_cbranch_scc1 L_QK_loop
    s_mov_b32 s33, s51
    ds_write_b64 v7, v[28:29] offset:53248
    s_nop 0
    ds_write_b64 v7, v[32:33] offset:53256
    ds_write_b128 v7, v[116:119] offset:40960
    s_lshr_b32 s40, s23, 1
    s_lshl_b32 s41, s40, 3
    s_lshl_b32 s40, s40, 12
    ds_write_b128 v7, v[124:127] offset:45056
    v_add_u32 v38, s40, v2
    v_add_u32 v39, s40, v38
    ds_write_b128 v7, v[132:135] offset:49152
    v_mov_b32 v37, 3494803967
    v_add_u32 v36, s41, v2
    s_waitcnt lgkmcnt(0)
    s_barrier
    ds_read_b128 v[16:19], v38 offset:40960
    ds_read_b128 v[20:23], v39 offset:40960
    ds_read_b64 v[24:25], v36 offset:53248
    ds_read_b128 v[26:29], v38 offset:41984
    ds_read_b128 v[30:33], v39 offset:41984
    ds_read_b64 v[34:35], v36 offset:54272
    ds_read_b128 v[116:119], v38 offset:43008
    ds_read_b128 v[124:127], v39 offset:43008
    ds_read_b64 v[132:133], v36 offset:55296
    s_waitcnt lgkmcnt(3)
    v_add_f32 v16, v16, v26
    v_add_f32 v17, v17, v27
    v_add_f32 v18, v18, v28
    v_add_f32 v19, v19, v29
    v_add_f32 v20, v20, v30
    v_add_f32 v21, v21, v31
    v_add_f32 v22, v22, v32
    v_add_f32 v23, v23, v33
    v_add_f32 v24, v24, v34
    v_add_f32 v25, v25, v35
    ds_read_b128 v[26:29], v38 offset:44032
    ds_read_b128 v[30:33], v39 offset:44032
    ds_read_b64 v[34:35], v36 offset:56320
    s_waitcnt lgkmcnt(3)
    v_add_f32 v16, v16, v116
    v_add_f32 v17, v17, v117
    v_add_f32 v18, v18, v118
    v_add_f32 v19, v19, v119
    v_add_f32 v20, v20, v124
    v_add_f32 v21, v21, v125
    v_add_f32 v22, v22, v126
    v_add_f32 v23, v23, v127
    v_add_f32 v24, v24, v132
    v_add_f32 v25, v25, v133
    s_waitcnt lgkmcnt(0)
    v_add_f32 v16, v16, v26
    v_add_f32 v17, v17, v27
    v_add_f32 v18, v18, v28
    v_add_f32 v19, v19, v29
    v_add_f32 v20, v20, v30
    v_add_f32 v21, v21, v31
    v_add_f32 v22, v22, v32
    v_add_f32 v23, v23, v33
    v_add_f32 v24, v24, v34
    v_add_f32 v25, v25, v35
    v_cndmask_b32 v16, v37, v16, s[8:9]
    v_cndmask_b32 v17, v37, v17, s[10:11]
    buffer_store_dword v6, v10, s[4:7], s32 offen sc1
    v_cndmask_b32 v18, v37, v18, s[12:13]
    v_cndmask_b32 v19, v37, v19, s[14:15]
    v_cndmask_b32 v20, v37, v20, s[94:95]
    v_cndmask_b32 v21, v37, v21, s[96:97]
    v_cndmask_b32 v22, v37, v22, s[98:99]
    v_cndmask_b32 v23, v37, v23, s[100:101]
    v_max3_f32 v34, v16, v17, v18
    v_max3_f32 v34, v34, v19, v20
    v_max3_f32 v34, v34, v21, v22
    v_max3_f32 v34, v34, v23, v24
    v_max_f32 v34, v34, v25
    v_mov_b32 v36, v34
    s_nop 1
    v_permlane16_swap_b32 v34, v36
    v_max_f32 v34, v34, v36
    v_mov_b32 v36, v34
    s_nop 1
    v_permlane32_swap_b32 v34, v36
    v_max_f32 v34, v34, v36
    v_mul_f32 v34, s54, v34
    v_fma_f32 v16, v16, s54, -v34
    v_fma_f32 v17, v17, s54, -v34
    v_fma_f32 v18, v18, s54, -v34
    v_fma_f32 v19, v19, s54, -v34
    v_fma_f32 v20, v20, s54, -v34
    v_fma_f32 v21, v21, s54, -v34
    v_fma_f32 v22, v22, s54, -v34
    v_fma_f32 v23, v23, s54, -v34
    v_fma_f32 v24, v24, s54, -v34
    v_fma_f32 v25, v25, s54, -v34
    v_exp_f32 v16, v16
    v_exp_f32 v17, v17
    v_exp_f32 v18, v18
    v_exp_f32 v19, v19
    v_exp_f32 v20, v20
    v_exp_f32 v21, v21
    v_exp_f32 v22, v22
    v_exp_f32 v23, v23
    v_exp_f32 v24, v24
    v_exp_f32 v25, v25
    v_add_f32 v34, v16, v17
    v_add_f32 v34, v34, v18
    v_add_f32 v34, v34, v19
    v_add_f32 v34, v34, v20
    v_add_f32 v34, v34, v21
    v_add_f32 v34, v34, v22
    v_add_f32 v34, v34, v23
    v_add_f32 v34, v34, v24
    v_add_f32 v34, v34, v25
    v_mov_b32 v36, v34
    s_nop 1
    v_permlane16_swap_b32 v34, v36
    v_add_f32 v34, v34, v36
    v_mov_b32 v36, v34
    s_nop 1
    v_permlane32_swap_b32 v34, v36
    v_add_f32 v34, v34, v36
    v_rcp_f32 v34, v34
    s_nop 0
    v_mul_f32 v16, v16, v34
    v_mul_f32 v17, v17, v34
    v_mul_f32 v18, v18, v34
    v_mul_f32 v19, v19, v34
    v_mul_f32 v20, v20, v34
    v_mul_f32 v21, v21, v34
    v_mul_f32 v22, v22, v34
    v_mul_f32 v23, v23, v34
    v_mul_f32 v24, v24, v34
    v_mul_f32 v25, v25, v34
    v_cvt_pk_bf16_f32 v28, v16, v17
    v_cvt_pk_bf16_f32 v29, v20, v21
    v_cvt_pk_bf16_f32 v30, v18, v19
    v_cvt_pk_bf16_f32 v31, v22, v23
    v_cvt_pk_bf16_f32 v32, v24, v25
    s_mov_b64 exec, s[66:67]
    buffer_store_dwordx4 v[28:31], v2, s[4:7], s33 offen sc1
    s_mov_b64 exec, -1
    s_mov_b64 exec, s[66:67]
    buffer_store_dword v32, v11, s[4:7], s33 offen sc1
    s_mov_b64 exec, -1
    s_branch L_end
chk_10:
    s_cmp_lt_u32 s34, 2
    s_cbranch_scc1 slow_8
    v_mov_b32 v134, 0
    v_max3_u32 v134, v134, v40, v41
    v_max3_u32 v134, v134, v42, v43
    v_max3_u32 v134, v134, v44, v45
    v_max3_u32 v134, v134, v46, v47
    v_max3_u32 v134, v134, v48, v49
    v_max3_u32 v134, v134, v50, v51
    v_max3_u32 v134, v134, v52, v53
    v_max3_u32 v134, v134, v54, v55
    v_max3_u32 v134, v134, v56, v57
    v_max3_u32 v134, v134, v58, v59
    v_max3_u32 v134, v134, v60, v61
    v_max3_u32 v134, v134, v62, v63
    v_max3_u32 v134, v134, v64, v65
    v_max3_u32 v134, v134, v66, v67
    v_max3_u32 v134, v134, v68, v69
    v_max3_u32 v134, v134, v70, v71
    v_max3_u32 v134, v134, v72, v73
    v_max3_u32 v134, v134, v74, v75
    v_max3_u32 v134, v134, v76, v77
    v_max3_u32 v134, v134, v78, v79
    v_cmp_eq_u32 vcc, -1, v134
    s_cbranch_vccz bk_11
    s_add_u32 s27, s27, 1
    s_cmp_lt_u32 s27, 131072
    s_cbranch_scc1 go_12
    s_branch L_abort
go_12:
slow_8:
    s_add_u32 s34, s34, 1
    s_nop 7
    buffer_load_dwordx4 v[40:43], v2, s[4:7], s46 offen offset:0 sc1
    s_waitcnt lgkmcnt(0)
    ds_read_b128 v[104:107], v3 offset:0
    ds_read_b128 v[108:111], v3 offset:1024
    ds_read_b128 v[112:115], v3 offset:2048
    ds_read_b128 v[116:119], v3 offset:3072
    ds_read_b128 v[120:123], v3 offset:4096
    ds_read_b128 v[124:127], v3 offset:5120
    v_mov_b64 v[80:81], 0
    s_nop 5
    v_mov_b64 v[82:83], 0
    s_nop 5
    buffer_load_dwordx4 v[44:47], v2, s[4:7], s46 offen offset:1024 sc1
    v_mov_b64 v[84:85], 0
    s_nop 5
    v_mov_b64 v[86:87], 0
    s_nop 5
    buffer_load_dwordx4 v[48:51], v2, s[4:7], s47 offen offset:0 sc1
    v_mov_b64 v[88:89], 0
    s_nop 5
    v_mov_b64 v[90:91], 0
    s_nop 5
    buffer_load_dwordx4 v[52:55], v2, s[4:7], s47 offen offset:1024 sc1
    v_mov_b64 v[92:93], 0
    s_nop 5
    v_mov_b64 v[94:95], 0
    s_nop 5
    buffer_load_dwordx4 v[56:59], v2, s[4:7], s48 offen offset:0 sc1
    v_mov_b64 v[96:97], 0
    s_nop 5
    v_mov_b64 v[98:99], 0
    s_nop 5
    buffer_load_dwordx4 v[60:63], v2, s[4:7], s48 offen offset:1024 sc1
    v_mov_b64 v[100:101], 0
    s_nop 5
    v_mov_b64 v[102:103], 0
    s_nop 5
    buffer_load_dwordx4 v[64:67], v2, s[4:7], s56 offen offset:0 sc1
    s_waitcnt vmcnt(6)
    s_waitcnt lgkmcnt(4)
    v_smfmac_f32_16x16x64_bf16 v[92:95], v[40:43], v[104:111], v4
    ds_read_b128 v[104:107], v3 offset:6144
    v_smfmac_f32_16x16x64_bf16 v[80:83], v[40:43], a[0:7], v4
    ds_read_b128 v[108:111], v3 offset:7168
    v_smfmac_f32_16x16x64_bf16 v[84:87], v[40:43], a[160:167], v4
    buffer_load_dwordx4 v[68:71], v2, s[4:7], s56 offen offset:1024 sc1
    v_smfmac_f32_16x16x64_bf16 v[88:91], v[40:43], a[80:87], v4
    s_waitcnt vmcnt(6)
    s_waitcnt lgkmcnt(4)
    v_smfmac_f32_16x16x64_bf16 v[92:95], v[44:47], v[112:119], v4
    ds_read_b128 v[112:115], v3 offset:8192
    v_smfmac_f32_16x16x64_bf16 v[80:83], v[44:47], a[8:15], v4
    ds_read_b128 v[116:119], v3 offset:9216
    v_smfmac_f32_16x16x64_bf16 v[84:87], v[44:47], a[168:175], v4
    buffer_load_dwordx4 v[72:75], v2, s[4:7], s57 offen offset:0 sc1
    v_smfmac_f32_16x16x64_bf16 v[88:91], v[44:47], a[88:95], v4
    s_waitcnt vmcnt(6)
    s_waitcnt lgkmcnt(4)
    v_smfmac_f32_16x16x64_bf16 v[92:95], v[48:51], v[120:127], v4
    ds_read_b128 v[120:123], v3 offset:10240
    v_smfmac_f32_16x16x64_bf16 v[80:83], v[48:51], a[16:23], v4
    ds_read_b128 v[124:127], v3 offset:11264
    v_smfmac_f32_16x16x64_bf16 v[84:87], v[48:51], a[176:183], v4
    buffer_load_dwordx4 v[76:79], v2, s[4:7], s57 offen offset:1024 sc1
    v_smfmac_f32_16x16x64_bf16 v[88:91], v[48:51], a[96:103], v4
    s_waitcnt vmcnt(6)
    s_waitcnt lgkmcnt(4)
    v_smfmac_f32_16x16x64_bf16 v[92:95], v[52:55], v[104:111], v4
    ds_read_b128 v[104:107], v3 offset:12288
    v_smfmac_f32_16x16x64_bf16 v[80:83], v[52:55], a[24:31], v4
    ds_read_b128 v[108:111], v3 offset:13312
    v_smfmac_f32_16x16x64_bf16 v[84:87], v[52:55], a[184:191], v4
    v_smfmac_f32_16x16x64_bf16 v[88:91], v[52:55], a[104:111], v4
    s_waitcnt vmcnt(5)
    s_waitcnt lgkmcnt(4)
    v_smfmac_f32_16x16x64_bf16 v[92:95], v[56:59], v[112:119], v4
    ds_read_b128 v[112:115], v3 offset:14336
    v_smfmac_f32_16x16x64_bf16 v[80:83], v[56:59], a[32:39], v4
    ds_read_b128 v[116:119], v3 offset:15360
    v_smfmac_f32_16x16x64_bf16 v[84:87], v[56:59], a[192:199], v4
    v_smfmac_f32_16x16x64_bf16 v[88:91], v[56:59], a[112:119], v4
    s_waitcnt vmcnt(4)
    s_waitcnt lgkmcnt(4)
    v_smfmac_f32_16x16x64_bf16 v[92:95], v[60:63], v[120:127], v4
    ds_read_b128 v[120:123], v3 offset:16384
    v_smfmac_f32_16x16x64_bf16 v[80:83], v[60:63], a[40:47], v4
    ds_read_b128 v[124:127], v3 offset:17408
    v_smfmac_f32_16x16x64_bf16 v[84:87], v[60:63], a[200:207], v4
    v_smfmac_f32_16x16x64_bf16 v[88:91], v[60:63], a[120:127], v4
    s_waitcnt vmcnt(3)
    s_waitcnt lgkmcnt(4)
    v_smfmac_f32_16x16x64_bf16 v[92:95], v[64:67], v[104:111], v4
    ds_read_b128 v[104:107], v3 offset:18432
    v_smfmac_f32_16x16x64_bf16 v[80:83], v[64:67], a[48:55], v4
    ds_read_b128 v[108:111], v3 offset:19456
    v_smfmac_f32_16x16x64_bf16 v[84:87], v[64:67], a[208:215], v4
    v_smfmac_f32_16x16x64_bf16 v[88:91], v[64:67], a[128:135], v4
    s_waitcnt vmcnt(2)
    s_waitcnt lgkmcnt(4)
    v_smfmac_f32_16x16x64_bf16 v[92:95], v[68:71], v[112:119], v4
    ds_read_b128 v[112:115], v3 offset:20480
    v_smfmac_f32_16x16x64_bf16 v[80:83], v[68:71], a[56:63], v4
    ds_read_b128 v[116:119], v3 offset:21504
    v_smfmac_f32_16x16x64_bf16 v[84:87], v[68:71], a[216:223], v4
    v_smfmac_f32_16x16x64_bf16 v[88:91], v[68:71], a[136:143], v4
    s_waitcnt vmcnt(1)
    s_waitcnt lgkmcnt(4)
    v_smfmac_f32_16x16x64_bf16 v[92:95], v[72:75], v[120:127], v4
    ds_read_b128 v[120:123], v3 offset:22528
    v_smfmac_f32_16x16x64_bf16 v[80:83], v[72:75], a[64:71], v4
    ds_read_b128 v[124:127], v3 offset:23552
    v_smfmac_f32_16x16x64_bf16 v[84:87], v[72:75], a[224:231], v4
    v_smfmac_f32_16x16x64_bf16 v[88:91], v[72:75], a[144:151], v4
    s_waitcnt vmcnt(0)
    s_waitcnt lgkmcnt(4)
    v_smfmac_f32_16x16x64_bf16 v[92:95], v[76:79], v[104:111], v4
    ds_read_b128 v[104:107], v3 offset:24576
    v_smfmac_f32_16x16x64_bf16 v[80:83], v[76:79], a[72:79], v4
    ds_read_b128 v[108:111], v3 offset:25600
    v_smfmac_f32_16x16x64_bf16 v[84:87], v[76:79], a[232:239], v4
    v_smfmac_f32_16x16x64_bf16 v[88:91], v[76:79], a[152:159], v4
    s_nop 7
    s_branch ok_9
L_QK_max:
    v_mov_b32 v52, 4048155338
    v_cndmask_b32 v40, v52, v40, s[60:61]
    v_cndmask_b32 v41, v52, v41, s[60:61]
    v_cndmask_b32 v42, v52, v42, s[60:61]
    v_cndmask_b32 v43, v52, v43, s[60:61]
    v_max3_f32 v60, v40, v41, v42
    v_max_f32 v60, v60, v43
    s_nop 1
    v_max_f32_dpp v60, v60, v60 quad_perm:[1,0,3,2] row_mask:0xf bank_mask:0xf
    s_nop 1
    v_max_f32_dpp v60, v60, v60 quad_perm:[2,3,0,1] row_mask:0xf bank_mask:0xf
    s_nop 1
    v_max_f32_dpp v60, v60, v60 row_half_mirror row_mask:0xf bank_mask:0xf
    s_nop 1
    v_max_f32_dpp v60, v60, v60 row_ror:8 row_mask:0xf bank_mask:0xf
    v_sub_f32 v40, v40, v60
    v_sub_f32 v41, v41, v60
    v_sub_f32 v42, v42, v60
    v_sub_f32 v43, v43, v60
    v_exp_f32 v48, v40
    v_exp_f32 v49, v41
    v_exp_f32 v50, v42
    v_exp_f32 v51, v43
    s_nop 0
    v_pk_add_f32 v[62:63], v[48:49], v[50:51]
    v_add_f32 v60, v62, v63
    v_cndmask_b32 v60, 0, v60, s[60:61]
    s_nop 1
    v_add_f32_dpp v60, v60, v60 quad_perm:[1,0,3,2] row_mask:0xf bank_mask:0xf
    s_nop 1
    v_add_f32_dpp v60, v60, v60 quad_perm:[2,3,0,1] row_mask:0xf bank_mask:0xf
    s_nop 1
    v_add_f32_dpp v60, v60, v60 row_half_mirror row_mask:0xf bank_mask:0xf
    s_nop 1
    v_add_f32_dpp v60, v60, v60 row_ror:8 row_mask:0xf bank_mask:0xf
    s_mov_b64 s[62:63], s[42:43]
    s_cmp_lg_u32 0, 0
    s_branch L_QK_maxd
.p2align 6
L_QK_w23:
    v_mfma_f32_16x16x16_bf16 v[116:119], v[32:33], v[20:21], 0
    v_mfma_f32_16x16x16_bf16 v[124:127], v[32:33], v[26:27], 0
    s_waitcnt lgkmcnt(0)
    s_barrier
    v_mfma_f32_16x16x16_bf16 v[132:135], v[38:39], v[26:27], 0
    v_mfma_f32_16x16x32_bf16 v[116:119], v[28:31], v[16:19], v[116:119]
    v_mfma_f32_16x16x32_bf16 v[124:127], v[28:31], v[22:25], v[124:127]
    v_mfma_f32_16x16x32_bf16 v[132:135], v[34:37], v[22:25], v[132:135]
    v_mfma_f32_16x16x16_bf16 v[28:31], v[128:129], v[16:17], 0
    v_mfma_f32_16x16x16_bf16 v[32:35], v[128:129], v[22:23], 0
    s_nop 1
    v_mfma_f32_16x16x32_bf16 v[28:31], v[88:91], v[18:21], v[28:31]
    s_nop 1
    v_mfma_f32_16x16x32_bf16 v[32:35], v[88:91], v[24:27], v[32:35]
    s_branch L_QK_sk
L_other:
    s_cmp_ge_u32 s21, 28
    s_cbranch_scc1 L_LN
    s_cmp_ge_u32 s21, 26
    s_cbranch_scc1 L_FFN
    s_cmp_ge_u32 s21, 16
    s_cbranch_scc1 L_R
L_VO:
    s_mov_b32 s47, 7864320
    s_lshl_b32 s25, s20, 3
    s_add_u32 s25, s25, s21
    s_sub_u32 s25, s25, 8
    s_mov_b32 s29, 0
    s_mov_b32 s30, 12288
    s_mov_b32 s42, s25
    s_branch L_VF
L_FFN:
    s_mov_b32 s47, 1966080
    s_lshl_b32 s25, s20, 1
    s_add_u32 s25, s25, s21
    s_sub_u32 s25, s25, 26
    s_mov_b32 s29, 1
    s_mov_b32 s30, 3072
    s_add_u32 s42, s25, 32
L_VF:
    s_lshr_b32 s40, s42, 3
    s_lshl_b32 s40, s40, 14
    s_and_b32 s41, s42, 7
    s_lshl_b32 s41, s41, 10
    s_add_u32 s49, s40, s41
    s_lshl_b32 s51, s42, 7
    s_mul_i32 s31, s25, 384
    s_lshl_b32 s32, s30, 5
    s_mul_i32 s33, s25, 245760
    s_mul_i32 s48, s22, 2
    s_xor_b32 s36, s20, s48
    v_lshlrev_b32 v2, 4, v1
    s_mul_i32 s40, s23, 26624
    s_add_u32 s40, s40, 57344
    v_add_u32 v3, s40, v2
    v_add_u32 v10, 0, v1
    v_mul_u32_u24 v11, 2731, v10
    v_lshrrev_b32 v11, 16, v11
    v_mul_u32_u24 v12, 24, v11
    v_sub_u32 v10, v10, v12
    s_lshl_b32 s40, s23, 3
    v_add_u32 v11, s40, v11
    v_mul_lo_u32 v11, v11, s30
    v_lshl_add_u32 v16, v10, 4, v11
    v_add_u32 v10, 64, v1
    v_mul_u32_u24 v11, 2731, v10
    v_lshrrev_b32 v11, 16, v11
    v_mul_u32_u24 v12, 24, v11
    v_sub_u32 v10, v10, v12
    s_lshl_b32 s40, s23, 3
    v_add_u32 v11, s40, v11
    v_mul_lo_u32 v11, v11, s30
    v_lshl_add_u32 v17, v10, 4, v11
    v_add_u32 v10, 128, v1
    v_mul_u32_u24 v11, 2731, v10
    v_lshrrev_b32 v11, 16, v11
    v_mul_u32_u24 v12, 24, v11
    v_sub_u32 v10, v10, v12
    s_lshl_b32 s40, s23, 3
    v_add_u32 v11, s40, v11
    v_mul_lo_u32 v11, v11, s30
    v_lshl_add_u32 v18, v10, 4, v11
    v_lshrrev_b32 v10, 4, v1
    v_lshlrev_b32 v10, 3, v10
    v_bfe_u32 v11, v1, 2, 2
    v_add_u32 v10, v10, v11
    v_mul_u32_u24 v10, 384, v10
    v_and_b32 v11, 3, v1
    v_lshl_add_u32 v10, v11, 3, v10
    s_xor_b32 s40, s23, s48
    s_mul_i32 s40, s40, 96
    v_add_u32 v19, s40, v10
    s_mul_i32 s44, s23, 3072
    s_waitcnt lgkmcnt(0)
    s_mov_b32 s8, s12
    s_mov_b32 s9, s13
    s_mov_b32 s10, s47
    s_mov_b32 s11, 0x20000
    s_mov_b32 s12, s14
    s_mov_b32 s13, s15
    s_mov_b32 s14, s47
    s_mov_b32 s15, 0x20000
    s_add_u32 s4, s4, 0x3fffff
    s_addc_u32 s5, s5, 0
    s_and_b32 s4, s4, 0xffc00000
    s_lshl_b32 s45, s36, 2
    s_add_u32 s45, s45, 0
    s_cmp_ge_u32 s45, 20
    s_cselect_b32 s43, 20, 0
    s_sub_u32 s45, s45, s43
    s_mul_i32 s45, s32, s45
    s_add_u32 s45, s45, s31
    s_add_u32 m0, s44, 0
    s_nop 0
    buffer_load_dwordx4 v16, s[8:11], s45 offen  lds
    s_add_u32 m0, s44, 1024
    s_nop 0
    buffer_load_dwordx4 v17, s[8:11], s45 offen  lds
    s_add_u32 m0, s44, 2048
    s_nop 0
    buffer_load_dwordx4 v18, s[8:11], s45 offen  lds
    s_lshl_b32 s45, s36, 2
    s_add_u32 s45, s45, 1
    s_cmp_ge_u32 s45, 20
    s_cselect_b32 s43, 20, 0
    s_sub_u32 s45, s45, s43
    s_mul_i32 s45, s32, s45
    s_add_u32 s45, s45, s31
    s_add_u32 m0, s44, 12288
    s_nop 0
    buffer_load_dwordx4 v16, s[8:11], s45 offen  lds
    s_add_u32 m0, s44, 13312
    s_nop 0
    buffer_load_dwordx4 v17, s[8:11], s45 offen  lds
    s_add_u32 m0, s44, 14336
    s_nop 0
    buffer_load_dwordx4 v18, s[8:11], s45 offen  lds
    s_lshl_b32 s45, s36, 2
    s_add_u32 s45, s45, 2
    s_cmp_ge_u32 s45, 20
    s_cselect_b32 s43, 20, 0
    s_sub_u32 s45, s45, s43
    s_mul_i32 s45, s32, s45
    s_add_u32 s45, s45, s31
    s_add_u32 m0, s44, 24576
    s_nop 0
    buffer_load_dwordx4 v16, s[8:11], s45 offen  lds
    s_add_u32 m0, s44, 25600
    s_nop 0
    buffer_load_dwordx4 v17, s[8:11], s45 offen  lds
    s_add_u32 m0, s44, 26624
    s_nop 0
    buffer_load_dwordx4 v18, s[8:11], s45 offen  lds
    s_mul_i32 s40, s23, 192
    s_add_u32 s40, s40, 0
    s_min_u32 s40, s40, 576
    v_add_u32 v10, s40, v1
    v_mul_u32_u24 v11, 1639, v10
    v_lshrrev_b32 v11, 16, v11
    v_mul_u32_u24 v12, 40, v11
    v_sub_u32 v12, v10, v12
    v_mul_u32_u24 v11, 1280, v11
    v_lshl_add_u32 v20, v12, 4, v11
    s_mul_i32 s40, s23, 192
    s_add_u32 s40, s40, 64
    s_min_u32 s40, s40, 576
    v_add_u32 v10, s40, v1
    v_mul_u32_u24 v11, 1639, v10
    v_lshrrev_b32 v11, 16, v11
    v_mul_u32_u24 v12, 40, v11
    v_sub_u32 v12, v10, v12
    v_mul_u32_u24 v11, 1280, v11
    v_lshl_add_u32 v21, v12, 4, v11
    s_mul_i32 s40, s23, 192
    s_add_u32 s40, s40, 128
    s_min_u32 s40, s40, 576
    v_add_u32 v10, s40, v1
    v_mul_u32_u24 v11, 1639, v10
    v_lshrrev_b32 v11, 16, v11
    v_mul_u32_u24 v12, 40, v11
    v_sub_u32 v12, v10, v12
    v_mul_u32_u24 v11, 1280, v11
    v_lshl_add_u32 v22, v12, 4, v11
    v_lshrrev_b32 v10, 2, v1
    v_mul_u32_u24 v10, 640, v10
    v_and_b32 v11, 3, v1
    v_lshl_add_u32 v10, v11, 3, v10
    s_mul_i32 s40, s23, 160
    v_add_u32 v23, s40, v10
    v_and_b32 v13, 15, v1
    v_lshrrev_b32 v14, 4, v1
    v_and_b32 v4, 1, v1
    v_mul_u32_u24 v4, 0xaaaa, v4
    v_add_u32 v4, 0x4444, v4
    s_mul_i32 s40, s23, 3
    s_add_u32 s40, s40, 0
    s_lshr_b32 s41, s40, 1
    s_and_b32 s40, s40, 1
    s_lshl_b32 s43, s41, 10
    s_lshl_b32 s44, s40, 3
    s_add_u32 s43, s43, s44
    s_add_u32 s43, s43, 40960
    v_add_u32 v5, s43, v2
    s_lshl_b32 s43, s41, 9
    s_lshl_b32 s44, s40, 2
    s_add_u32 s43, s43, s44
    s_add_u32 s43, s43, 53248
    v_mov_b32 v7, s43
    s_mul_i32 s40, s23, 3
    s_add_u32 s40, s40, 1
    s_lshr_b32 s41, s40, 1
    s_and_b32 s40, s40, 1
    s_lshl_b32 s43, s41, 10
    s_lshl_b32 s44, s40, 3
    s_add_u32 s43, s43, s44
    s_add_u32 s43, s43, 40960
    v_add_u32 v6, s43, v2
    s_lshl_b32 s43, s41, 9
    s_lshl_b32 s44, s40, 2
    s_add_u32 s43, s43, s44
    s_add_u32 s43, s43, 53248
    v_mov_b32 v8, s43
    v_lshrrev_b32 v10, 3, v13
    v_lshlrev_b32 v10, 8, v10
    v_bfe_u32 v11, v13, 1, 1
    v_lshl_add_u32 v10, v11, 4, v10
    v_bfe_u32 v11, v13, 2, 1
    v_lshl_add_u32 v10, v11, 3, v10
    v_and_b32 v11, 1, v13
    v_lshl_add_u32 v10, v11, 5, v10
    v_lshl_add_u32 v10, v14, 6, v10
    v_add_u32 v7, v7, v10
    v_add_u32 v8, v8, v10
    v_and_b32 v10, 1, v14
    v_lshrrev_b32 v11, 1, v14
    v_lshl_add_u32 v12, v10, 1, v11
    s_and_b32 s40, s23, 1
    s_mul_i32 s40, s40, 10
    s_add_u32 s40, s40, 24
    s_lshl_b32 s40, s40, 14
    s_lshl_b32 s41, s25, 8
    s_add_u32 s40, s40, s41
    v_lshl_add_u32 v15, v13, 4, s40
    v_lshl_add_u32 v9, v12, 15, v15
    v_lshlrev_b32 v10, 3, v10
    v_add_u32 v11, 13, v11
    v_lshl_add_u32 v11, v11, 15, v15
    v_add_u32 v11, v11, v10
    v_add_u32 v10, 294912, v9
    v_add_u32 v15, 131072, v9
    v_cmp_eq_u32 vcc, 0, v12
    s_nop 1
    v_cndmask_b32 v10, v10, v15, vcc
    v_lshrrev_b32 v15, 19, v9
    v_lshl_add_u32 v9, v15, 14, v9
    v_lshrrev_b32 v15, 19, v10
    v_lshl_add_u32 v10, v15, 14, v10
    v_lshrrev_b32 v15, 19, v11
    v_lshl_add_u32 v11, v15, 14, v11
    v_and_b32 v12, 1, v1
    v_cmp_eq_u32 vcc, 1, v12
    v_mov_b32 v14, 0x05040100
    v_mov_b32 v12, 0x03020706
    v_cndmask_b32 v14, v14, v12, vcc
    v_mov_b32 v12, 0
    s_mul_i32 s44, s23, 3072
    s_sub_u32 s40, s2, s26
    s_and_b32 s42, s40, 1
    s_bfe_u32 s41, s40, 0x10001
    s_lshl_b32 s41, s41, 9
    s_or_b32 s42, s42, s41
    s_bfe_u32 s41, s40, 0x10002
    s_lshl_b32 s41, s41, 18
    s_or_b32 s42, s42, s41
    v_mov_b32 v32, 128
    v_mov_b32 v33, s42
    v_mov_b32 v34, 0
    s_and_b32 s46, s21, 7
    s_lshl_b32 s47, s23, 3
    s_or_b32 s46, s46, s47
    s_waitcnt vmcnt(6)
    s_barrier
    s_lshl_b32 s45, s36, 2
    s_add_u32 s45, s45, 3
    s_cmp_ge_u32 s45, 20
    s_cselect_b32 s43, 20, 0
    s_sub_u32 s45, s45, s43
    s_mul_i32 s45, s32, s45
    s_add_u32 s45, s45, s31
    s_add_u32 m0, s44, 36864
    s_nop 0
    buffer_load_dwordx4 v16, s[8:11], s45 offen  lds
    s_add_u32 m0, s44, 37888
    s_nop 0
    buffer_load_dwordx4 v17, s[8:11], s45 offen  lds
    s_add_u32 m0, s44, 38912
    s_nop 0
    buffer_load_dwordx4 v18, s[8:11], s45 offen  lds
    ds_read_b64_tr_b16 a[240:241], v19 offset:0
    ds_read_b64_tr_b16 a[242:243], v19 offset:1536
    ds_read_b64_tr_b16 v[200:201], v19 offset:32
    ds_read_b64_tr_b16 v[202:203], v19 offset:1568
    ds_read_b64_tr_b16 v[40:41], v19 offset:64
    ds_read_b64_tr_b16 v[42:43], v19 offset:1600
    s_waitcnt lgkmcnt(0)
    ds_write_b128 v3, v[40:43] offset:0
    s_waitcnt vmcnt(6)
    s_barrier
    s_cmp_eq_u32 s46, 0
    s_cselect_b64 exec, 1, 0
    buffer_atomic_add_x2 v[32:33], v34, s[16:19], s28 offen sc1
    s_mov_b64 exec, -1
    s_lshl_b32 s45, s36, 2
    s_add_u32 s45, s45, 4
    s_cmp_ge_u32 s45, 20
    s_cselect_b32 s43, 20, 0
    s_sub_u32 s45, s45, s43
    s_mul_i32 s45, s32, s45
    s_add_u32 s45, s45, s31
    s_add_u32 m0, s44, 0
    s_nop 0
    buffer_load_dwordx4 v16, s[8:11], s45 offen  lds
    s_add_u32 m0, s44, 1024
    s_nop 0
    buffer_load_dwordx4 v17, s[8:11], s45 offen  lds
    s_add_u32 m0, s44, 2048
    s_nop 0
    buffer_load_dwordx4 v18, s[8:11], s45 offen  lds
    ds_read_b64_tr_b16 a[244:245], v19 offset:12288
    ds_read_b64_tr_b16 a[246:247], v19 offset:13824
    ds_read_b64_tr_b16 v[204:205], v19 offset:12320
    ds_read_b64_tr_b16 v[206:207], v19 offset:13856
    ds_read_b64_tr_b16 v[40:41], v19 offset:12352
    ds_read_b64_tr_b16 v[42:43], v19 offset:13888
    s_waitcnt lgkmcnt(0)
    ds_write_b128 v3, v[40:43] offset:1024
    s_waitcnt vmcnt(6)
    s_barrier
    s_cmp_eq_u32 s46, 1
    s_cselect_b64 exec, 1, 0
    buffer_atomic_add_x2 v[32:33], v34, s[16:19], s28 offen sc1
    s_mov_b64 exec, -1
    s_lshl_b32 s45, s36, 2
    s_add_u32 s45, s45, 5
    s_cmp_ge_u32 s45, 20
    s_cselect_b32 s43, 20, 0
    s_sub_u32 s45, s45, s43
    s_mul_i32 s45, s32, s45
    s_add_u32 s45, s45, s31
    s_add_u32 m0, s44, 12288
    s_nop 0
    buffer_load_dwordx4 v16, s[8:11], s45 offen  lds
    s_add_u32 m0, s44, 13312
    s_nop 0
    buffer_load_dwordx4 v17, s[8:11], s45 offen  lds
    s_add_u32 m0, s44, 14336
    s_nop 0
    buffer_load_dwordx4 v18, s[8:11], s45 offen  lds
    ds_read_b64_tr_b16 a[248:249], v19 offset:24576
    ds_read_b64_tr_b16 a[250:251], v19 offset:26112
    ds_read_b64_tr_b16 v[208:209], v19 offset:24608
    ds_read_b64_tr_b16 v[210:211], v19 offset:26144
    ds_read_b64_tr_b16 v[40:41], v19 offset:24640
    ds_read_b64_tr_b16 v[42:43], v19 offset:26176
    s_waitcnt lgkmcnt(0)
    ds_write_b128 v3, v[40:43] offset:2048
    s_waitcnt vmcnt(6)
    s_barrier
    s_cmp_eq_u32 s46, 2
    s_cselect_b64 exec, 1, 0
    buffer_atomic_add_x2 v[32:33], v34, s[16:19], s28 offen sc1
    s_mov_b64 exec, -1
    s_lshl_b32 s45, s36, 2
    s_add_u32 s45, s45, 6
    s_cmp_ge_u32 s45, 20
    s_cselect_b32 s43, 20, 0
    s_sub_u32 s45, s45, s43
    s_mul_i32 s45, s32, s45
    s_add_u32 s45, s45, s31
    s_add_u32 m0, s44, 24576
    s_nop 0
    buffer_load_dwordx4 v16, s[8:11], s45 offen  lds
    s_add_u32 m0, s44, 25600
    s_nop 0
    buffer_load_dwordx4 v17, s[8:11], s45 offen  lds
    s_add_u32 m0, s44, 26624
    s_nop 0
    buffer_load_dwordx4 v18, s[8:11], s45 offen  lds
    ds_read_b64_tr_b16 a[252:253], v19 offset:36864
    ds_read_b64_tr_b16 a[254:255], v19 offset:38400
    ds_read_b64_tr_b16 v[212:213], v19 offset:36896
    ds_read_b64_tr_b16 v[214:215], v19 offset:38432
    ds_read_b64_tr_b16 v[40:41], v19 offset:36928
    ds_read_b64_tr_b16 v[42:43], v19 offset:38464
    s_waitcnt lgkmcnt(0)
    ds_write_b128 v3, v[40:43] offset:3072
    s_waitcnt vmcnt(6)
    s_barrier
    s_cmp_eq_u32 s46, 3
    s_cselect_b64 exec, 1, 0
    buffer_atomic_add_x2 v[32:33], v34, s[16:19], s28 offen sc1
    s_mov_b64 exec, -1
    s_lshl_b32 s45, s36, 2
    s_add_u32 s45, s45, 7
    s_cmp_ge_u32 s45, 20
    s_cselect_b32 s43, 20, 0
    s_sub_u32 s45, s45, s43
    s_mul_i32 s45, s32, s45
    s_add_u32 s45, s45, s31
    s_add_u32 m0, s44, 36864
    s_nop 0
    buffer_load_dwordx4 v16, s[8:11], s45 offen  lds
    s_add_u32 m0, s44, 37888
    s_nop 0
    buffer_load_dwordx4 v17, s[8:11], s45 offen  lds
    s_add_u32 m0, s44, 38912
    s_nop 0
    buffer_load_dwordx4 v18, s[8:11], s45 offen  lds
    ds_read_b64_tr_b16 v[136:137], v19 offset:0
    ds_read_b64_tr_b16 v[138:139], v19 offset:1536
    ds_read_b64_tr_b16 v[40:41], v19 offset:32
    ds_read_b64_tr_b16 v[42:43], v19 offset:1568
    ds_read_b64_tr_b16 v[44:45], v19 offset:64
    ds_read_b64_tr_b16 v[46:47], v19 offset:1600
    s_waitcnt lgkmcnt(0)
    ds_write_b128 v3, v[40:43] offset:20480
    ds_write_b128 v3, v[44:47] offset:4096
    s_waitcnt vmcnt(6)
    s_barrier
    s_cmp_eq_u32 s46, 4
    s_cselect_b64 exec, 1, 0
    buffer_atomic_add_x2 v[32:33], v34, s[16:19], s28 offen sc1
    s_mov_b64 exec, -1
    s_lshl_b32 s45, s36, 2
    s_add_u32 s45, s45, 8
    s_cmp_ge_u32 s45, 20
    s_cselect_b32 s43, 20, 0
    s_sub_u32 s45, s45, s43
    s_mul_i32 s45, s32, s45
    s_add_u32 s45, s45, s31
    s_add_u32 m0, s44, 0
    s_nop 0
    buffer_load_dwordx4 v16, s[8:11], s45 offen  lds
    s_add_u32 m0, s44, 1024
    s_nop 0
    buffer_load_dwordx4 v17, s[8:11], s45 offen  lds
    s_add_u32 m0, s44, 2048
    s_nop 0
    buffer_load_dwordx4 v18, s[8:11], s45 offen  lds
    ds_read_b64_tr_b16 v[140:141], v19 offset:12288
    ds_read_b64_tr_b16 v[142:143], v19 offset:13824
    ds_read_b64_tr_b16 v[40:41], v19 offset:12320
    ds_read_b64_tr_b16 v[42:43], v19 offset:13856
    ds_read_b64_tr_b16 v[44:45], v19 offset:12352
    ds_read_b64_tr_b16 v[46:47], v19 offset:13888
    s_waitcnt lgkmcnt(0)
    ds_write_b128 v3, v[40:43] offset:21504
    ds_write_b128 v3, v[44:47] offset:5120
    s_waitcnt vmcnt(6)
    s_barrier
    s_cmp_eq_u32 s46, 5
    s_cselect_b64 exec, 1, 0
    buffer_atomic_add_x2 v[32:33], v34, s[16:19], s28 offen sc1
    s_mov_b64 exec, -1
    s_lshl_b32 s45, s36, 2
    s_add_u32 s45, s45, 9
    s_cmp_ge_u32 s45, 20
    s_cselect_b32 s43, 20, 0
    s_sub_u32 s45, s45, s43
    s_mul_i32 s45, s32, s45
    s_add_u32 s45, s45, s31
    s_add_u32 m0, s44, 12288
    s_nop 0
    buffer_load_dwordx4 v16, s[8:11], s45 offen  lds
    s_add_u32 m0, s44, 13312
    s_nop 0
    buffer_load_dwordx4 v17, s[8:11], s45 offen  lds
    s_add_u32 m0, s44, 14336
    s_nop 0
    buffer_load_dwordx4 v18, s[8:11], s45 offen  lds
    ds_read_b64_tr_b16 v[144:145], v19 offset:24576
    ds_read_b64_tr_b16 v[146:147], v19 offset:26112
    ds_read_b64_tr_b16 v[216:217], v19 offset:24608
    ds_read_b64_tr_b16 v[218:219], v19 offset:26144
    ds_read_b64_tr_b16 v[40:41], v19 offset:24640
    ds_read_b64_tr_b16 v[42:43], v19 offset:26176
    s_waitcnt lgkmcnt(0)
    ds_write_b128 v3, v[40:43] offset:6144
    s_waitcnt vmcnt(6)
    s_barrier
    s_cmp_eq_u32 s46, 6
    s_cselect_b64 exec, 1, 0
    buffer_atomic_add_x2 v[32:33], v34, s[16:19], s28 offen sc1
    s_mov_b64 exec, -1
    s_lshl_b32 s45, s36, 2
    s_add_u32 s45, s45, 10
    s_cmp_ge_u32 s45, 20
    s_cselect_b32 s43, 20, 0
    s_sub_u32 s45, s45, s43
    s_mul_i32 s45, s32, s45
    s_add_u32 s45, s45, s31
    s_add_u32 m0, s44, 24576
    s_nop 0
    buffer_load_dwordx4 v16, s[8:11], s45 offen  lds
    s_add_u32 m0, s44, 25600
    s_nop 0
    buffer_load_dwordx4 v17, s[8:11], s45 offen  lds
    s_add_u32 m0, s44, 26624
    s_nop 0
    buffer_load_dwordx4 v18, s[8:11], s45 offen  lds
    ds_read_b64_tr_b16 v[148:149], v19 offset:36864
    ds_read_b64_tr_b16 v[150:151], v19 offset:38400
    ds_read_b64_tr_b16 v[220:221], v19 offset:36896
    ds_read_b64_tr_b16 v[222:223], v19 offset:38432
    ds_read_b64_tr_b16 v[40:41], v19 offset:36928
    ds_read_b64_tr_b16 v[42:43], v19 offset:38464
    s_waitcnt lgkmcnt(0)
    ds_write_b128 v3, v[40:43] offset:7168
    s_waitcnt vmcnt(6)
    s_barrier
    s_cmp_eq_u32 s46, 7
    s_cselect_b64 exec, 1, 0
    buffer_atomic_add_x2 v[32:33], v34, s[16:19], s28 offen sc1
    s_mov_b64 exec, -1
    s_lshl_b32 s45, s36, 2
    s_add_u32 s45, s45, 11
    s_cmp_ge_u32 s45, 20
    s_cselect_b32 s43, 20, 0
    s_sub_u32 s45, s45, s43
    s_mul_i32 s45, s32, s45
    s_add_u32 s45, s45, s31
    s_add_u32 m0, s44, 36864
    s_nop 0
    buffer_load_dwordx4 v16, s[8:11], s45 offen  lds
    s_add_u32 m0, s44, 37888
    s_nop 0
    buffer_load_dwordx4 v17, s[8:11], s45 offen  lds
    s_add_u32 m0, s44, 38912
    s_nop 0
    buffer_load_dwordx4 v18, s[8:11], s45 offen  lds
    ds_read_b64_tr_b16 v[152:153], v19 offset:0
    ds_read_b64_tr_b16 v[154:155], v19 offset:1536
    ds_read_b64_tr_b16 v[224:225], v19 offset:32
    ds_read_b64_tr_b16 v[226:227], v19 offset:1568
    ds_read_b64_tr_b16 v[40:41], v19 offset:64
    ds_read_b64_tr_b16 v[42:43], v19 offset:1600
    s_waitcnt lgkmcnt(0)
    ds_write_b128 v3, v[40:43] offset:8192
    s_waitcnt vmcnt(6)
    s_barrier
    s_lshl_b32 s45, s36, 2
    s_add_u32 s45, s45, 12
    s_cmp_ge_u32 s45, 20
    s_cselect_b32 s43, 20, 0
    s_sub_u32 s45, s45, s43
    s_mul_i32 s45, s32, s45
    s_add_u32 s45, s45, s31
    s_add_u32 m0, s44, 0
    s_nop 0
    buffer_load_dwordx4 v16, s[8:11], s45 offen  lds
    s_add_u32 m0, s44, 1024
    s_nop 0
    buffer_load_dwordx4 v17, s[8:11], s45 offen  lds
    s_add_u32 m0, s44, 2048
    s_nop 0
    buffer_load_dwordx4 v18, s[8:11], s45 offen  lds
    ds_read_b64_tr_b16 v[156:157], v19 offset:12288
    ds_read_b64_tr_b16 v[158:159], v19 offset:13824
    ds_read_b64_tr_b16 v[228:229], v19 offset:12320
    ds_read_b64_tr_b16 v[230:231], v19 offset:13856
    ds_read_b64_tr_b16 v[40:41], v19 offset:12352
    ds_read_b64_tr_b16 v[42:43], v19 offset:13888
    s_waitcnt lgkmcnt(0)
    ds_write_b128 v3, v[40:43] offset:9216
    s_waitcnt vmcnt(6)
    s_barrier
    s_lshl_b32 s45, s36, 2
    s_add_u32 s45, s45, 13
    s_cmp_ge_u32 s45, 20
    s_cselect_b32 s43, 20, 0
    s_sub_u32 s45, s45, s43
    s_mul_i32 s45, s32, s45
    s_add_u32 s45, s45, s31
    s_add_u32 m0, s44, 12288
    s_nop 0
    buffer_load_dwordx4 v16, s[8:11], s45 offen  lds
    s_add_u32 m0, s44, 13312
    s_nop 0
    buffer_load_dwordx4 v17, s[8:11], s45 offen  lds
    s_add_u32 m0, s44, 14336
    s_nop 0
    buffer_load_dwordx4 v18, s[8:11], s45 offen  lds
    ds_read_b64_tr_b16 v[160:161], v19 offset:24576
    ds_read_b64_tr_b16 v[162:163], v19 offset:26112
    ds_read_b64_tr_b16 v[40:41], v19 offset:24608
    ds_read_b64_tr_b16 v[42:43], v19 offset:26144
    ds_read_b64_tr_b16 v[44:45], v19 offset:24640
    ds_read_b64_tr_b16 v[46:47], v19 offset:26176
    s_waitcnt lgkmcnt(0)
    ds_write_b128 v3, v[40:43] offset:22528
    ds_write_b128 v3, v[44:47] offset:10240
    s_waitcnt vmcnt(6)
    s_barrier
    s_lshl_b32 s45, s36, 2
    s_add_u32 s45, s45, 14
    s_cmp_ge_u32 s45, 20
    s_cselect_b32 s43, 20, 0
    s_sub_u32 s45, s45, s43
    s_mul_i32 s45, s32, s45
    s_add_u32 s45, s45, s31
    s_add_u32 m0, s44, 24576
    s_nop 0
    buffer_load_dwordx4 v16, s[8:11], s45 offen  lds
    s_add_u32 m0, s44, 25600
    s_nop 0
    buffer_load_dwordx4 v17, s[8:11], s45 offen  lds
    s_add_u32 m0, s44, 26624
    s_nop 0
    buffer_load_dwordx4 v18, s[8:11], s45 offen  lds
    ds_read_b64_tr_b16 v[164:165], v19 offset:36864
    ds_read_b64_tr_b16 v[166:167], v19 offset:38400
    ds_read_b64_tr_b16 v[40:41], v19 offset:36896
    ds_read_b64_tr_b16 v[42:43], v19 offset:38432
    ds_read_b64_tr_b16 v[44:45], v19 offset:36928
    ds_read_b64_tr_b16 v[46:47], v19 offset:38464
    s_waitcnt lgkmcnt(0)
    ds_write_b128 v3, v[40:43] offset:23552
    ds_write_b128 v3, v[44:47] offset:11264
    s_waitcnt vmcnt(6)
    s_barrier
    s_lshl_b32 s45, s36, 2
    s_add_u32 s45, s45, 15
    s_cmp_ge_u32 s45, 20
    s_cselect_b32 s43, 20, 0
    s_sub_u32 s45, s45, s43
    s_mul_i32 s45, s32, s45
    s_add_u32 s45, s45, s31
    s_add_u32 m0, s44, 36864
    s_nop 0
    buffer_load_dwordx4 v16, s[8:11], s45 offen  lds
    s_add_u32 m0, s44, 37888
    s_nop 0
    buffer_load_dwordx4 v17, s[8:11], s45 offen  lds
    s_add_u32 m0, s44, 38912
    s_nop 0
    buffer_load_dwordx4 v18, s[8:11], s45 offen  lds
    ds_read_b64_tr_b16 v[168:169], v19 offset:0
    ds_read_b64_tr_b16 v[170:171], v19 offset:1536
    ds_read_b64_tr_b16 v[232:233], v19 offset:32
    ds_read_b64_tr_b16 v[234:235], v19 offset:1568
    ds_read_b64_tr_b16 v[40:41], v19 offset:64
    ds_read_b64_tr_b16 v[42:43], v19 offset:1600
    s_waitcnt lgkmcnt(0)
    ds_write_b128 v3, v[40:43] offset:12288
    s_waitcnt vmcnt(6)
    s_barrier
    s_lshl_b32 s45, s36, 2
    s_add_u32 s45, s45, 16
    s_cmp_ge_u32 s45, 20
    s_cselect_b32 s43, 20, 0
    s_sub_u32 s45, s45, s43
    s_mul_i32 s45, s32, s45
    s_add_u32 s45, s45, s31
    s_add_u32 m0, s44, 0
    s_nop 0
    buffer_load_dwordx4 v16, s[8:11], s45 offen  lds
    s_add_u32 m0, s44, 1024
    s_nop 0
    buffer_load_dwordx4 v17, s[8:11], s45 offen  lds
    s_add_u32 m0, s44, 2048
    s_nop 0
    buffer_load_dwordx4 v18, s[8:11], s45 offen  lds
    ds_read_b64_tr_b16 v[172:173], v19 offset:12288
    ds_read_b64_tr_b16 v[174:175], v19 offset:13824
    ds_read_b64_tr_b16 v[236:237], v19 offset:12320
    ds_read_b64_tr_b16 v[238:239], v19 offset:13856
    ds_read_b64_tr_b16 v[40:41], v19 offset:12352
    ds_read_b64_tr_b16 v[42:43], v19 offset:13888
    s_waitcnt lgkmcnt(0)
    ds_write_b128 v3, v[40:43] offset:13312
    s_waitcnt vmcnt(6)
    s_barrier
    s_lshl_b32 s45, s36, 2
    s_add_u32 s45, s45, 17
    s_cmp_ge_u32 s45, 20
    s_cselect_b32 s43, 20, 0
    s_sub_u32 s45, s45, s43
    s_mul_i32 s45, s32, s45
    s_add_u32 s45, s45, s31
    s_add_u32 m0, s44, 12288
    s_nop 0
    buffer_load_dwordx4 v16, s[8:11], s45 offen  lds
    s_add_u32 m0, s44, 13312
    s_nop 0
    buffer_load_dwordx4 v17, s[8:11], s45 offen  lds
    s_add_u32 m0, s44, 14336
    s_nop 0
    buffer_load_dwordx4 v18, s[8:11], s45 offen  lds
    ds_read_b64_tr_b16 v[176:177], v19 offset:24576
    ds_read_b64_tr_b16 v[178:179], v19 offset:26112
    ds_read_b64_tr_b16 v[240:241], v19 offset:24608
    ds_read_b64_tr_b16 v[242:243], v19 offset:26144
    ds_read_b64_tr_b16 v[40:41], v19 offset:24640
    ds_read_b64_tr_b16 v[42:43], v19 offset:26176
    s_waitcnt lgkmcnt(0)
    ds_write_b128 v3, v[40:43] offset:14336
    s_waitcnt vmcnt(6)
    s_barrier
    s_lshl_b32 s45, s36, 2
    s_add_u32 s45, s45, 18
    s_cmp_ge_u32 s45, 20
    s_cselect_b32 s43, 20, 0
    s_sub_u32 s45, s45, s43
    s_mul_i32 s45, s32, s45
    s_add_u32 s45, s45, s31
    s_add_u32 m0, s44, 24576
    s_nop 0
    buffer_load_dwordx4 v16, s[8:11], s45 offen  lds
    s_add_u32 m0, s44, 25600
    s_nop 0
    buffer_load_dwordx4 v17, s[8:11], s45 offen  lds
    s_add_u32 m0, s44, 26624
    s_nop 0
    buffer_load_dwordx4 v18, s[8:11], s45 offen  lds
    ds_read_b64_tr_b16 v[180:181], v19 offset:36864
    ds_read_b64_tr_b16 v[182:183], v19 offset:38400
    ds_read_b64_tr_b16 v[244:245], v19 offset:36896
    ds_read_b64_tr_b16 v[246:247], v19 offset:38432
    ds_read_b64_tr_b16 v[40:41], v19 offset:36928
    ds_read_b64_tr_b16 v[42:43], v19 offset:38464
    s_waitcnt lgkmcnt(0)
    ds_write_b128 v3, v[40:43] offset:15360
    s_waitcnt vmcnt(6)
    s_barrier
    s_lshl_b32 s45, s36, 2
    s_add_u32 s45, s45, 19
    s_cmp_ge_u32 s45, 20
    s_cselect_b32 s43, 20, 0
    s_sub_u32 s45, s45, s43
    s_mul_i32 s45, s32, s45
    s_add_u32 s45, s45, s31
    s_add_u32 m0, s44, 36864
    s_nop 0
    buffer_load_dwordx4 v16, s[8:11], s45 offen  lds
    s_add_u32 m0, s44, 37888
    s_nop 0
    buffer_load_dwordx4 v17, s[8:11], s45 offen  lds
    s_add_u32 m0, s44, 38912
    s_nop 0
    buffer_load_dwordx4 v18, s[8:11], s45 offen  lds
    ds_read_b64_tr_b16 v[184:185], v19 offset:0
    ds_read_b64_tr_b16 v[186:187], v19 offset:1536
    ds_read_b64_tr_b16 v[40:41], v19 offset:32
    ds_read_b64_tr_b16 v[42:43], v19 offset:1568
    ds_read_b64_tr_b16 v[44:45], v19 offset:64
    ds_read_b64_tr_b16 v[46:47], v19 offset:1600
    s_waitcnt lgkmcnt(0)
    ds_write_b128 v3, v[40:43] offset:24576
    ds_write_b128 v3, v[44:47] offset:16384
    s_waitcnt vmcnt(6)
    s_barrier
    s_mul_i32 s45, s48, 61440
    s_add_u32 s45, s45, s33
    s_add_u32 s45, s45, 0
    s_add_u32 m0, s44, 0
    s_nop 0
    buffer_load_dwordx4 v20, s[12:15], s45 offen  lds
    s_add_u32 m0, s44, 1024
    s_nop 0
    buffer_load_dwordx4 v21, s[12:15], s45 offen  lds
    s_add_u32 m0, s44, 2048
    s_nop 0
    buffer_load_dwordx4 v22, s[12:15], s45 offen  lds
    ds_read_b64_tr_b16 v[188:189], v19 offset:12288
    ds_read_b64_tr_b16 v[190:191], v19 offset:13824
    ds_read_b64_tr_b16 v[40:41], v19 offset:12320
    ds_read_b64_tr_b16 v[42:43], v19 offset:13856
    ds_read_b64_tr_b16 v[44:45], v19 offset:12352
    ds_read_b64_tr_b16 v[46:47], v19 offset:13888
    s_waitcnt lgkmcnt(0)
    ds_write_b128 v3, v[40:43] offset:25600
    ds_write_b128 v3, v[44:47] offset:17408
    s_waitcnt vmcnt(6)
    s_barrier
    s_mul_i32 s45, s48, 61440
    s_add_u32 s45, s45, s33
    s_add_u32 s45, s45, 640
    s_add_u32 m0, s44, 12288
    s_nop 0
    buffer_load_dwordx4 v20, s[12:15], s45 offen  lds
    s_add_u32 m0, s44, 13312
    s_nop 0
    buffer_load_dwordx4 v21, s[12:15], s45 offen  lds
    s_add_u32 m0, s44, 14336
    s_nop 0
    buffer_load_dwordx4 v22, s[12:15], s45 offen  lds
    ds_read_b64_tr_b16 v[192:193], v19 offset:24576
    ds_read_b64_tr_b16 v[194:195], v19 offset:26112
    ds_read_b64_tr_b16 v[248:249], v19 offset:24608
    ds_read_b64_tr_b16 v[250:251], v19 offset:26144
    ds_read_b64_tr_b16 v[40:41], v19 offset:24640
    ds_read_b64_tr_b16 v[42:43], v19 offset:26176
    s_waitcnt lgkmcnt(0)
    ds_write_b128 v3, v[40:43] offset:18432
    s_waitcnt vmcnt(6)
    s_barrier
    s_mul_i32 s45, s48, 61440
    s_add_u32 s45, s45, s33
    s_add_u32 s45, s45, 20480
    s_add_u32 m0, s44, 24576
    s_nop 0
    buffer_load_dwordx4 v20, s[12:15], s45 offen  lds
    s_add_u32 m0, s44, 25600
    s_nop 0
    buffer_load_dwordx4 v21, s[12:15], s45 offen  lds
    s_add_u32 m0, s44, 26624
    s_nop 0
    buffer_load_dwordx4 v22, s[12:15], s45 offen  lds
    ds_read_b64_tr_b16 v[196:197], v19 offset:36864
    ds_read_b64_tr_b16 v[198:199], v19 offset:38400
    ds_read_b64_tr_b16 v[252:253], v19 offset:36896
    ds_read_b64_tr_b16 v[254:255], v19 offset:38432
    ds_read_b64_tr_b16 v[40:41], v19 offset:36928
    ds_read_b64_tr_b16 v[42:43], v19 offset:38464
    s_waitcnt lgkmcnt(0)
    ds_write_b128 v3, v[40:43] offset:19456
    s_waitcnt vmcnt(6)
    s_barrier
    s_mul_i32 s45, s48, 61440
    s_add_u32 s45, s45, s33
    s_add_u32 s45, s45, 21120
    s_add_u32 m0, s44, 36864
    s_nop 0
    buffer_load_dwordx4 v20, s[12:15], s45 offen  lds
    s_add_u32 m0, s44, 37888
    s_nop 0
    buffer_load_dwordx4 v21, s[12:15], s45 offen  lds
    s_add_u32 m0, s44, 38912
    s_nop 0
    buffer_load_dwordx4 v22, s[12:15], s45 offen  lds
    ds_read_b64_tr_b16 a[0:1], v23 offset:0
    ds_read_b64_tr_b16 a[24:25], v23 offset:32
    ds_read_b64_tr_b16 a[48:49], v23 offset:64
    ds_read_b64_tr_b16 a[72:73], v23 offset:96
    ds_read_b64_tr_b16 a[96:97], v23 offset:128
    s_waitcnt lgkmcnt(0)
    s_waitcnt vmcnt(6)
    s_barrier
    s_mul_i32 s45, s48, 61440
    s_add_u32 s45, s45, s33
    s_add_u32 s45, s45, 40960
    s_add_u32 m0, s44, 0
    s_nop 0
    buffer_load_dwordx4 v20, s[12:15], s45 offen  lds
    s_add_u32 m0, s44, 1024
    s_nop 0
    buffer_load_dwordx4 v21, s[12:15], s45 offen  lds
    s_add_u32 m0, s44, 2048
    s_nop 0
    buffer_load_dwordx4 v22, s[12:15], s45 offen  lds
    ds_read_b64_tr_b16 a[120:121], v23 offset:12288
    ds_read_b64_tr_b16 a[144:145], v23 offset:12320
    ds_read_b64_tr_b16 a[168:169], v23 offset:12352
    ds_read_b64_tr_b16 a[192:193], v23 offset:12384
    ds_read_b64_tr_b16 a[216:217], v23 offset:12416
    s_waitcnt lgkmcnt(0)
    s_waitcnt vmcnt(6)
    s_barrier
    s_mul_i32 s45, s48, 61440
    s_add_u32 s45, s45, s33
    s_add_u32 s45, s45, 41600
    s_add_u32 m0, s44, 12288
    s_nop 0
    buffer_load_dwordx4 v20, s[12:15], s45 offen  lds
    s_add_u32 m0, s44, 13312
    s_nop 0
    buffer_load_dwordx4 v21, s[12:15], s45 offen  lds
    s_add_u32 m0, s44, 14336
    s_nop 0
    buffer_load_dwordx4 v22, s[12:15], s45 offen  lds
    ds_read_b64_tr_b16 a[2:3], v23 offset:24576
    ds_read_b64_tr_b16 a[26:27], v23 offset:24608
    ds_read_b64_tr_b16 a[50:51], v23 offset:24640
    ds_read_b64_tr_b16 a[74:75], v23 offset:24672
    ds_read_b64_tr_b16 a[98:99], v23 offset:24704
    s_waitcnt lgkmcnt(0)
    s_waitcnt vmcnt(6)
    s_barrier
    s_mul_i32 s45, s48, 61440
    s_add_u32 s45, s45, s33
    s_add_u32 s45, s45, 61440
    s_add_u32 m0, s44, 24576
    s_nop 0
    buffer_load_dwordx4 v20, s[12:15], s45 offen  lds
    s_add_u32 m0, s44, 25600
    s_nop 0
    buffer_load_dwordx4 v21, s[12:15], s45 offen  lds
    s_add_u32 m0, s44, 26624
    s_nop 0
    buffer_load_dwordx4 v22, s[12:15], s45 offen  lds
    ds_read_b64_tr_b16 a[122:123], v23 offset:36864
    ds_read_b64_tr_b16 a[146:147], v23 offset:36896
    ds_read_b64_tr_b16 a[170:171], v23 offset:36928
    ds_read_b64_tr_b16 a[194:195], v23 offset:36960
    ds_read_b64_tr_b16 a[218:219], v23 offset:36992
    s_waitcnt lgkmcnt(0)
    s_waitcnt vmcnt(6)
    s_barrier
    s_mul_i32 s45, s48, 61440
    s_add_u32 s45, s45, s33
    s_add_u32 s45, s45, 62080
    s_add_u32 m0, s44, 36864
    s_nop 0
    buffer_load_dwordx4 v20, s[12:15], s45 offen  lds
    s_add_u32 m0, s44, 37888
    s_nop 0
    buffer_load_dwordx4 v21, s[12:15], s45 offen  lds
    s_add_u32 m0, s44, 38912
    s_nop 0
    buffer_load_dwordx4 v22, s[12:15], s45 offen  lds
    ds_read_b64_tr_b16 a[4:5], v23 offset:0
    ds_read_b64_tr_b16 a[28:29], v23 offset:32
    ds_read_b64_tr_b16 a[52:53], v23 offset:64
    ds_read_b64_tr_b16 a[76:77], v23 offset:96
    ds_read_b64_tr_b16 a[100:101], v23 offset:128
    s_waitcnt lgkmcnt(0)
    s_waitcnt vmcnt(6)
    s_barrier
    s_mul_i32 s45, s48, 61440
    s_add_u32 s45, s45, s33
    s_add_u32 s45, s45, 81920
    s_add_u32 m0, s44, 0
    s_nop 0
    buffer_load_dwordx4 v20, s[12:15], s45 offen  lds
    s_add_u32 m0, s44, 1024
    s_nop 0
    buffer_load_dwordx4 v21, s[12:15], s45 offen  lds
    s_add_u32 m0, s44, 2048
    s_nop 0
    buffer_load_dwordx4 v22, s[12:15], s45 offen  lds
    ds_read_b64_tr_b16 a[124:125], v23 offset:12288
    ds_read_b64_tr_b16 a[148:149], v23 offset:12320
    ds_read_b64_tr_b16 a[172:173], v23 offset:12352
    ds_read_b64_tr_b16 a[196:197], v23 offset:12384
    ds_read_b64_tr_b16 a[220:221], v23 offset:12416
    s_waitcnt lgkmcnt(0)
    s_waitcnt vmcnt(6)
    s_barrier
    s_mul_i32 s45, s48, 61440
    s_add_u32 s45, s45, s33
    s_add_u32 s45, s45, 82560
    s_add_u32 m0, s44, 12288
    s_nop 0
    buffer_load_dwordx4 v20, s[12:15], s45 offen  lds
    s_add_u32 m0, s44, 13312
    s_nop 0
    buffer_load_dwordx4 v21, s[12:15], s45 offen  lds
    s_add_u32 m0, s44, 14336
    s_nop 0
    buffer_load_dwordx4 v22, s[12:15], s45 offen  lds
    ds_read_b64_tr_b16 a[6:7], v23 offset:24576
    ds_read_b64_tr_b16 a[30:31], v23 offset:24608
    ds_read_b64_tr_b16 a[54:55], v23 offset:24640
    ds_read_b64_tr_b16 a[78:79], v23 offset:24672
    ds_read_b64_tr_b16 a[102:103], v23 offset:24704
    s_waitcnt lgkmcnt(0)
    s_waitcnt vmcnt(6)
    s_barrier
    s_mul_i32 s45, s48, 61440
    s_add_u32 s45, s45, s33
    s_add_u32 s45, s45, 102400
    s_add_u32 m0, s44, 24576
    s_nop 0
    buffer_load_dwordx4 v20, s[12:15], s45 offen  lds
    s_add_u32 m0, s44, 25600
    s_nop 0
    buffer_load_dwordx4 v21, s[12:15], s45 offen  lds
    s_add_u32 m0, s44, 26624
    s_nop 0
    buffer_load_dwordx4 v22, s[12:15], s45 offen  lds
    ds_read_b64_tr_b16 a[126:127], v23 offset:36864
    ds_read_b64_tr_b16 a[150:151], v23 offset:36896
    ds_read_b64_tr_b16 a[174:175], v23 offset:36928
    ds_read_b64_tr_b16 a[198:199], v23 offset:36960
    ds_read_b64_tr_b16 a[222:223], v23 offset:36992
    s_waitcnt lgkmcnt(0)
    s_waitcnt vmcnt(6)
    s_barrier
    s_mul_i32 s45, s48, 61440
    s_add_u32 s45, s45, s33
    s_add_u32 s45, s45, 103040
    s_add_u32 m0, s44, 36864
    s_nop 0
    buffer_load_dwordx4 v20, s[12:15], s45 offen  lds
    s_add_u32 m0, s44, 37888
    s_nop 0
    buffer_load_dwordx4 v21, s[12:15], s45 offen  lds
    s_add_u32 m0, s44, 38912
    s_nop 0
    buffer_load_dwordx4 v22, s[12:15], s45 offen  lds
    ds_read_b64_tr_b16 a[8:9], v23 offset:0
    ds_read_b64_tr_b16 a[32:33], v23 offset:32
    ds_read_b64_tr_b16 a[56:57], v23 offset:64
    ds_read_b64_tr_b16 a[80:81], v23 offset:96
    ds_read_b64_tr_b16 a[104:105], v23 offset:128
    s_waitcnt lgkmcnt(0)
    s_waitcnt vmcnt(6)
    s_barrier
    s_mul_i32 s45, s48, -61440
    s_add_u32 s45, s45, s33
    s_add_u32 s45, s45, 122880
    s_add_u32 m0, s44, 0
    s_nop 0
    buffer_load_dwordx4 v20, s[12:15], s45 offen  lds
    s_add_u32 m0, s44, 1024
    s_nop 0
    buffer_load_dwordx4 v21, s[12:15], s45 offen  lds
    s_add_u32 m0, s44, 2048
    s_nop 0
    buffer_load_dwordx4 v22, s[12:15], s45 offen  lds
    ds_read_b64_tr_b16 a[128:129], v23 offset:12288
    ds_read_b64_tr_b16 a[152:153], v23 offset:12320
    ds_read_b64_tr_b16 a[176:177], v23 offset:12352
    ds_read_b64_tr_b16 a[200:201], v23 offset:12384
    ds_read_b64_tr_b16 a[224:225], v23 offset:12416
    s_waitcnt lgkmcnt(0)
    s_waitcnt vmcnt(6)
    s_barrier
    s_mul_i32 s45, s48, -61440
    s_add_u32 s45, s45, s33
    s_add_u32 s45, s45, 123520
    s_add_u32 m0, s44, 12288
    s_nop 0
    buffer_load_dwordx4 v20, s[12:15], s45 offen  lds
    s_add_u32 m0, s44, 13312
    s_nop 0
    buffer_load_dwordx4 v21, s[12:15], s45 offen  lds
    s_add_u32 m0, s44, 14336
    s_nop 0
    buffer_load_dwordx4 v22, s[12:15], s45 offen  lds
    ds_read_b64_tr_b16 a[10:11], v23 offset:24576
    ds_read_b64_tr_b16 a[34:35], v23 offset:24608
    ds_read_b64_tr_b16 a[58:59], v23 offset:24640
    ds_read_b64_tr_b16 a[82:83], v23 offset:24672
    ds_read_b64_tr_b16 a[106:107], v23 offset:24704
    s_waitcnt lgkmcnt(0)
    s_waitcnt vmcnt(6)
    s_barrier
    s_mul_i32 s45, s48, -61440
    s_add_u32 s45, s45, s33
    s_add_u32 s45, s45, 143360
    s_add_u32 m0, s44, 24576
    s_nop 0
    buffer_load_dwordx4 v20, s[12:15], s45 offen  lds
    s_add_u32 m0, s44, 25600
    s_nop 0
    buffer_load_dwordx4 v21, s[12:15], s45 offen  lds
    s_add_u32 m0, s44, 26624
    s_nop 0
    buffer_load_dwordx4 v22, s[12:15], s45 offen  lds
    ds_read_b64_tr_b16 a[130:131], v23 offset:36864
    ds_read_b64_tr_b16 a[154:155], v23 offset:36896
    ds_read_b64_tr_b16 a[178:179], v23 offset:36928
    ds_read_b64_tr_b16 a[202:203], v23 offset:36960
    ds_read_b64_tr_b16 a[226:227], v23 offset:36992
    s_waitcnt lgkmcnt(0)
    s_waitcnt vmcnt(6)
    s_barrier
    s_mul_i32 s45, s48, -61440
    s_add_u32 s45, s45, s33
    s_add_u32 s45, s45, 144000
    s_add_u32 m0, s44, 36864
    s_nop 0
    buffer_load_dwordx4 v20, s[12:15], s45 offen  lds
    s_add_u32 m0, s44, 37888
    s_nop 0
    buffer_load_dwordx4 v21, s[12:15], s45 offen  lds
    s_add_u32 m0, s44, 38912
    s_nop 0
    buffer_load_dwordx4 v22, s[12:15], s45 offen  lds
    ds_read_b64_tr_b16 a[12:13], v23 offset:0
    ds_read_b64_tr_b16 a[36:37], v23 offset:32
    ds_read_b64_tr_b16 a[60:61], v23 offset:64
    ds_read_b64_tr_b16 a[84:85], v23 offset:96
    ds_read_b64_tr_b16 a[108:109], v23 offset:128
    s_waitcnt lgkmcnt(0)
    s_waitcnt vmcnt(6)
    s_barrier
    s_mul_i32 s45, s48, -61440
    s_add_u32 s45, s45, s33
    s_add_u32 s45, s45, 163840
    s_add_u32 m0, s44, 0
    s_nop 0
    buffer_load_dwordx4 v20, s[12:15], s45 offen  lds
    s_add_u32 m0, s44, 1024
    s_nop 0
    buffer_load_dwordx4 v21, s[12:15], s45 offen  lds
    s_add_u32 m0, s44, 2048
    s_nop 0
    buffer_load_dwordx4 v22, s[12:15], s45 offen  lds
    ds_read_b64_tr_b16 a[132:133], v23 offset:12288
    ds_read_b64_tr_b16 a[156:157], v23 offset:12320
    ds_read_b64_tr_b16 a[180:181], v23 offset:12352
    ds_read_b64_tr_b16 a[204:205], v23 offset:12384
    ds_read_b64_tr_b16 a[228:229], v23 offset:12416
    s_waitcnt lgkmcnt(0)
    s_waitcnt vmcnt(6)
    s_barrier
    s_mul_i32 s45, s48, -61440
    s_add_u32 s45, s45, s33
    s_add_u32 s45, s45, 164480
    s_add_u32 m0, s44, 12288
    s_nop 0
    buffer_load_dwordx4 v20, s[12:15], s45 offen  lds
    s_add_u32 m0, s44, 13312
    s_nop 0
    buffer_load_dwordx4 v21, s[12:15], s45 offen  lds
    s_add_u32 m0, s44, 14336
    s_nop 0
    buffer_load_dwordx4 v22, s[12:15], s45 offen  lds
    ds_read_b64_tr_b16 a[14:15], v23 offset:24576
    ds_read_b64_tr_b16 a[38:39], v23 offset:24608
    ds_read_b64_tr_b16 a[62:63], v23 offset:24640
    ds_read_b64_tr_b16 a[86:87], v23 offset:24672
    ds_read_b64_tr_b16 a[110:111], v23 offset:24704
    s_waitcnt lgkmcnt(0)
    s_waitcnt vmcnt(6)
    s_barrier
    s_mul_i32 s45, s48, -61440
    s_add_u32 s45, s45, s33
    s_add_u32 s45, s45, 184320
    s_add_u32 m0, s44, 24576
    s_nop 0
    buffer_load_dwordx4 v20, s[12:15], s45 offen  lds
    s_add_u32 m0, s44, 25600
    s_nop 0
    buffer_load_dwordx4 v21, s[12:15], s45 offen  lds
    s_add_u32 m0, s44, 26624
    s_nop 0
    buffer_load_dwordx4 v22, s[12:15], s45 offen  lds
    ds_read_b64_tr_b16 a[134:135], v23 offset:36864
    ds_read_b64_tr_b16 a[158:159], v23 offset:36896
    ds_read_b64_tr_b16 a[182:183], v23 offset:36928
    ds_read_b64_tr_b16 a[206:207], v23 offset:36960
    ds_read_b64_tr_b16 a[230:231], v23 offset:36992
    s_waitcnt lgkmcnt(0)
    s_waitcnt vmcnt(6)
    s_barrier
    s_mul_i32 s45, s48, -61440
    s_add_u32 s45, s45, s33
    s_add_u32 s45, s45, 184960
    s_add_u32 m0, s44, 36864
    s_nop 0
    buffer_load_dwordx4 v20, s[12:15], s45 offen  lds
    s_add_u32 m0, s44, 37888
    s_nop 0
    buffer_load_dwordx4 v21, s[12:15], s45 offen  lds
    s_add_u32 m0, s44, 38912
    s_nop 0
    buffer_load_dwordx4 v22, s[12:15], s45 offen  lds
    ds_read_b64_tr_b16 a[16:17], v23 offset:0
    ds_read_b64_tr_b16 a[40:41], v23 offset:32
    ds_read_b64_tr_b16 a[64:65], v23 offset:64
    ds_read_b64_tr_b16 a[88:89], v23 offset:96
    ds_read_b64_tr_b16 a[112:113], v23 offset:128
    s_waitcnt lgkmcnt(0)
    s_waitcnt vmcnt(6)
    s_barrier
    v_mov_b32 v30, 0
    buffer_load_dword v31, v30, s[16:19], s28 offen offset:128 sc1
    s_mul_i32 s45, s48, -61440
    s_add_u32 s45, s45, s33
    s_add_u32 s45, s45, 204800
    s_add_u32 m0, s44, 0
    s_nop 0
    buffer_load_dwordx4 v20, s[12:15], s45 offen  lds
    s_add_u32 m0, s44, 1024
    s_nop 0
    buffer_load_dwordx4 v21, s[12:15], s45 offen  lds
    s_add_u32 m0, s44, 2048
    s_nop 0
    buffer_load_dwordx4 v22, s[12:15], s45 offen  lds
    ds_read_b64_tr_b16 a[136:137], v23 offset:12288
    ds_read_b64_tr_b16 a[160:161], v23 offset:12320
    ds_read_b64_tr_b16 a[184:185], v23 offset:12352
    ds_read_b64_tr_b16 a[208:209], v23 offset:12384
    ds_read_b64_tr_b16 a[232:233], v23 offset:12416
    s_waitcnt lgkmcnt(0)
    s_waitcnt vmcnt(7)
    s_barrier
    s_mul_i32 s45, s48, -61440
    s_add_u32 s45, s45, s33
    s_add_u32 s45, s45, 205440
    s_add_u32 m0, s44, 12288
    s_nop 0
    buffer_load_dwordx4 v20, s[12:15], s45 offen  lds
    s_add_u32 m0, s44, 13312
    s_nop 0
    buffer_load_dwordx4 v21, s[12:15], s45 offen  lds
    s_add_u32 m0, s44, 14336
    s_nop 0
    buffer_load_dwordx4 v22, s[12:15], s45 offen  lds
    ds_read_b64_tr_b16 a[18:19], v23 offset:24576
    ds_read_b64_tr_b16 a[42:43], v23 offset:24608
    ds_read_b64_tr_b16 a[66:67], v23 offset:24640
    ds_read_b64_tr_b16 a[90:91], v23 offset:24672
    ds_read_b64_tr_b16 a[114:115], v23 offset:24704
    s_waitcnt lgkmcnt(0)
    s_waitcnt vmcnt(7)
    s_barrier
    s_mul_i32 s45, s48, -61440
    s_add_u32 s45, s45, s33
    s_add_u32 s45, s45, 225280
    s_add_u32 m0, s44, 24576
    s_nop 0
    buffer_load_dwordx4 v20, s[12:15], s45 offen  lds
    s_add_u32 m0, s44, 25600
    s_nop 0
    buffer_load_dwordx4 v21, s[12:15], s45 offen  lds
    s_add_u32 m0, s44, 26624
    s_nop 0
    buffer_load_dwordx4 v22, s[12:15], s45 offen  lds
    ds_read_b64_tr_b16 a[138:139], v23 offset:36864
    ds_read_b64_tr_b16 a[162:163], v23 offset:36896
    ds_read_b64_tr_b16 a[186:187], v23 offset:36928
    ds_read_b64_tr_b16 a[210:211], v23 offset:36960
    ds_read_b64_tr_b16 a[234:235], v23 offset:36992
    s_waitcnt lgkmcnt(0)
    s_waitcnt vmcnt(6)
    s_barrier
    s_mul_i32 s45, s48, -61440
    s_add_u32 s45, s45, s33
    s_add_u32 s45, s45, 225920
    s_add_u32 m0, s44, 36864
    s_nop 0
    buffer_load_dwordx4 v20, s[12:15], s45 offen  lds
    s_add_u32 m0, s44, 37888
    s_nop 0
    buffer_load_dwordx4 v21, s[12:15], s45 offen  lds
    s_add_u32 m0, s44, 38912
    s_nop 0
    buffer_load_dwordx4 v22, s[12:15], s45 offen  lds
    ds_read_b64_tr_b16 a[20:21], v23 offset:0
    ds_read_b64_tr_b16 a[44:45], v23 offset:32
    ds_read_b64_tr_b16 a[68:69], v23 offset:64
    ds_read_b64_tr_b16 a[92:93], v23 offset:96
    ds_read_b64_tr_b16 a[116:117], v23 offset:128
    s_waitcnt lgkmcnt(0)
    s_waitcnt vmcnt(6)
    s_barrier
    s_branch wsc_16
ws_14:
    v_mov_b32 v30, 0
    buffer_load_dword v31, v30, s[16:19], s28 offen offset:128 sc1
    s_waitcnt vmcnt(0)
wsc_16:
    v_readfirstlane_b32 s40, v31
    s_nop 0
    s_cmp_lt_i32 s40, 0
    s_cbranch_scc1 L_restart
    s_cmp_lg_u32 s40, 0
    s_cbranch_scc1 wsd_15
    s_sleep 4
    s_add_u32 s27, s27, 1
    s_cmp_lt_u32 s27, 131072
    s_cbranch_scc1 ws_14
    s_branch L_abort
wsd_15:
    s_bfe_u32 s41, s40, 0x40010
    s_cmp_ge_u32 s41, 5
    s_cselect_b32 s28, 1, 0
    s_bfe_u32 s41, s40, 0x40018
    s_cmp_ge_u32 s41, 5
    s_cselect_b32 s41, 1, 0
    s_xor_b32 s3, s20, s41
    s_and_b32 s3, s3, 1
    s_lshl_b32 s3, s3, 14
    s_lshl_b32 s40, s23, 8
    s_add_u32 s3, s3, s40
    s_lshr_b32 s40, s20, 1
    s_lshl_b32 s40, s40, 7
    s_add_u32 s3, s3, s40
    s_add_u32 s3, s3, 327680
    s_lshr_b32 s40, s23, 1
    s_xor_b32 s40, s40, s41
    s_lshl_b32 s40, s40, 14
    v_xor_b32 v9, s40, v9
    v_xor_b32 v10, s40, v10
    v_xor_b32 v11, s40, v11
    s_lshl_b32 s39, s22, 3
    s_add_u32 s39, s39, s36
    s_lshl_b32 s39, s39, 13
    s_add_u32 s39, s39, 180355072
    s_mul_i32 s44, s23, 3072
    s_add_u32 m0, s44, 0
    s_add_u32 s45, m0, s39
    buffer_load_dwordx4 v2, s[4:7], s45 offen offset:0 sc1 lds
    buffer_load_dwordx4 v2, s[4:7], s45 offen offset:1024 sc1 lds
    buffer_load_dwordx4 v2, s[4:7], s45 offen offset:2048 sc1 lds
    ds_read_b64_tr_b16 a[140:141], v23 offset:12288
    ds_read_b64_tr_b16 a[164:165], v23 offset:12320
    ds_read_b64_tr_b16 a[188:189], v23 offset:12352
    ds_read_b64_tr_b16 a[212:213], v23 offset:12384
    ds_read_b64_tr_b16 a[236:237], v23 offset:12416
    s_waitcnt lgkmcnt(0)
    s_waitcnt vmcnt(6)
    s_barrier
    s_mul_i32 s44, s23, 3072
    s_add_u32 m0, s44, 12288
    s_add_u32 s45, m0, s39
    buffer_load_dwordx4 v2, s[4:7], s45 offen offset:0 sc1 lds
    buffer_load_dwordx4 v2, s[4:7], s45 offen offset:1024 sc1 lds
    buffer_load_dwordx4 v2, s[4:7], s45 offen offset:2048 sc1 lds
    ds_read_b64_tr_b16 a[22:23], v23 offset:24576
    ds_read_b64_tr_b16 a[46:47], v23 offset:24608
    ds_read_b64_tr_b16 a[70:71], v23 offset:24640
    ds_read_b64_tr_b16 a[94:95], v23 offset:24672
    ds_read_b64_tr_b16 a[118:119], v23 offset:24704
    s_waitcnt lgkmcnt(0)
    s_waitcnt vmcnt(6)
    s_barrier
    s_mul_i32 s44, s23, 3072
    s_add_u32 m0, s44, 24576
    s_add_u32 s45, m0, s39
    buffer_load_dwordx4 v2, s[4:7], s45 offen offset:0 sc1 lds
    buffer_load_dwordx4 v2, s[4:7], s45 offen offset:1024 sc1 lds
    buffer_load_dwordx4 v2, s[4:7], s45 offen offset:2048 sc1 lds
    ds_read_b64_tr_b16 a[142:143], v23 offset:36864
    ds_read_b64_tr_b16 a[166:167], v23 offset:36896
    ds_read_b64_tr_b16 a[190:191], v23 offset:36928
    ds_read_b64_tr_b16 a[214:215], v23 offset:36960
    ds_read_b64_tr_b16 a[238:239], v23 offset:36992
    s_waitcnt lgkmcnt(0)
    s_waitcnt vmcnt(3)
    s_waitcnt lgkmcnt(0)
    s_barrier
    s_mul_i32 s44, s23, 1024
    s_add_u32 m0, s44, 36864
    s_add_u32 s45, m0, s39
    buffer_load_dwordx4 v2, s[4:7], s45 offen offset:0 sc1 lds
    s_sub_u32 s26, s22, 2
    s_mov_b32 s43, 0
    s_mov_b32 s52, 0
    s_or_b32 s64, s29, s22
    s_xor_b32 s64, s64, 1
L_VF_E:
    s_mov_b64 s[54:55], 0
    s_mov_b64 s[56:57], 0
    s_mov_b64 s[60:61], 0
    s_mov_b32 s53, 1
    ds_read_b128 v[40:43], v2 offset:0
    ds_read_b128 v[44:47], v2 offset:1024
    ds_read_b128 v[64:67], v3 offset:0
    ds_read_b128 v[48:51], v2 offset:2048
    ds_read_b128 v[52:55], v2 offset:3072
    ds_read_b128 v[72:75], v3 offset:1024
    s_waitcnt lgkmcnt(0)
    s_branch L_VF_B
.p2align 6
L_VF_loop:
    ds_read_b128 v[84:87], v2 offset:40960
    ds_read_b128 v[88:91], v2 offset:47104
    ds_read_b128 v[92:95], v2 offset:41984
    ds_read_b128 v[96:99], v2 offset:48128
    ds_read_b128 v[100:103], v2 offset:43008
    ds_read_b128 v[104:107], v2 offset:49152
    ds_read_b128 v[108:111], v2 offset:44032
    ds_read_b128 v[112:115], v2 offset:50176
    ds_read_b128 v[116:119], v2 offset:45056
    ds_read_b128 v[120:123], v2 offset:51200
    ds_read_b128 v[124:127], v2 offset:46080
    ds_read_b128 v[128:131], v2 offset:52224
    s_waitcnt lgkmcnt(10)
    v_mfma_f32_16x16x32_bf16 v[16:19], v[84:87], a[0:3], 0
    s_add_u32 s39, s39, 131072
    s_mov_b32 s53, s29
    s_mov_b64 s[60:61], -1
    v_mfma_f32_16x16x32_bf16 v[20:23], v[88:91], a[0:3], 0
    s_add_u32 s40, s26, 0
    s_xor_b32 s41, s40, s28
    s_and_b32 s41, s41, 1
    s_waitcnt lgkmcnt(8)
    v_mfma_f32_16x16x32_bf16 v[16:19], v[92:95], a[4:7], v[16:19]
    s_lshl_b32 s41, s41, 13
    s_lshr_b32 s40, s40, 1
    s_lshl_b32 s40, s40, 22
    v_mfma_f32_16x16x32_bf16 v[20:23], v[96:99], a[4:7], v[20:23]
    s_add_u32 s40, s40, 37748736
    s_or_b32 s37, s40, s41
    s_add_u32 s38, s37, 2097152
    s_waitcnt lgkmcnt(6)
    v_mfma_f32_16x16x32_bf16 v[16:19], v[100:103], a[8:11], v[16:19]
    s_xor_b32 s38, s38, 8192
    s_mul_i32 s42, s23, 409600
    s_add_u32 s42, s42, s49
    v_mfma_f32_16x16x32_bf16 v[20:23], v[104:107], a[8:11], v[20:23]
    s_add_u32 s43, s42, s38
    s_add_u32 s42, s42, s37
    s_add_u32 s52, s37, s51
    s_waitcnt lgkmcnt(4)
    v_mfma_f32_16x16x32_bf16 v[16:19], v[108:111], a[12:15], v[16:19]
    s_add_u32 s52, s52, 1802240
    s_cmp_eq_u32 s29, 0
    s_cselect_b64 s[54:55], -1, 0
    v_mfma_f32_16x16x32_bf16 v[20:23], v[112:115], a[12:15], v[20:23]
    s_cmp_eq_u32 s23, 0
    s_cselect_b64 s[56:57], 1, 0
    s_waitcnt lgkmcnt(2)
    v_mfma_f32_16x16x32_bf16 v[16:19], v[116:119], a[16:19], v[16:19]
    v_mfma_f32_16x16x32_bf16 v[20:23], v[120:123], a[16:19], v[20:23]
    s_waitcnt lgkmcnt(0)
    v_mfma_f32_16x16x32_bf16 v[16:19], v[124:127], a[20:23], v[16:19]
    v_mfma_f32_16x16x32_bf16 v[20:23], v[128:131], a[20:23], v[20:23]
    v_mfma_f32_16x16x32_bf16 v[24:27], v[84:87], a[24:27], 0
    v_mfma_f32_16x16x32_bf16 v[28:31], v[88:91], a[24:27], 0
    v_cvt_pk_bf16_f32 v32, v16, v17
    v_cvt_pk_bf16_f32 v34, v18, v19
    v_mfma_f32_16x16x32_bf16 v[24:27], v[92:95], a[28:31], v[24:27]
    v_cvt_pk_bf16_f32 v33, v20, v21
    v_cvt_pk_bf16_f32 v35, v22, v23
    v_mfma_f32_16x16x32_bf16 v[28:31], v[96:99], a[28:31], v[28:31]
    buffer_store_dwordx4 v[32:35], v2, s[4:7], s42 offen sc1
    v_mfma_f32_16x16x32_bf16 v[24:27], v[100:103], a[32:35], v[24:27]
    v_mfma_f32_16x16x32_bf16 v[28:31], v[104:107], a[32:35], v[28:31]
    s_mul_i32 s44, s23, 10240
    s_add_u32 m0, s44, 0
    s_add_u32 s45, m0, s39
    v_mfma_f32_16x16x32_bf16 v[24:27], v[108:111], a[36:39], v[24:27]
    buffer_load_dwordx4 v2, s[4:7], s45 offen offset:0 sc1 lds
    v_mfma_f32_16x16x32_bf16 v[28:31], v[112:115], a[36:39], v[28:31]
    v_mfma_f32_16x16x32_bf16 v[24:27], v[116:119], a[40:43], v[24:27]
    v_mfma_f32_16x16x32_bf16 v[28:31], v[120:123], a[40:43], v[28:31]
    v_mfma_f32_16x16x32_bf16 v[24:27], v[124:127], a[44:47], v[24:27]
    buffer_load_dwordx4 v2, s[4:7], s45 offen offset:1024 sc1 lds
    v_mfma_f32_16x16x32_bf16 v[28:31], v[128:131], a[44:47], v[28:31]
    v_mfma_f32_16x16x32_bf16 v[16:19], v[84:87], a[48:51], 0
    v_mfma_f32_16x16x32_bf16 v[20:23], v[88:91], a[48:51], 0
    v_cvt_pk_bf16_f32 v36, v24, v25
    v_cvt_pk_bf16_f32 v38, v26, v27
    v_mfma_f32_16x16x32_bf16 v[16:19], v[92:95], a[52:55], v[16:19]
    v_cvt_pk_bf16_f32 v37, v28, v29
    v_cvt_pk_bf16_f32 v39, v30, v31
    v_mfma_f32_16x16x32_bf16 v[20:23], v[96:99], a[52:55], v[20:23]
    s_add_u32 s42, s42, 81920
    buffer_store_dwordx4 v[36:39], v2, s[4:7], s42 offen sc1
    v_mfma_f32_16x16x32_bf16 v[16:19], v[100:103], a[56:59], v[16:19]
    v_mfma_f32_16x16x32_bf16 v[20:23], v[104:107], a[56:59], v[20:23]
    v_mfma_f32_16x16x32_bf16 v[16:19], v[108:111], a[60:63], v[16:19]
    buffer_load_dwordx4 v2, s[4:7], s45 offen offset:2048 sc1 lds
    v_mfma_f32_16x16x32_bf16 v[20:23], v[112:115], a[60:63], v[20:23]
    v_mfma_f32_16x16x32_bf16 v[16:19], v[116:119], a[64:67], v[16:19]
    v_mfma_f32_16x16x32_bf16 v[20:23], v[120:123], a[64:67], v[20:23]
    v_mfma_f32_16x16x32_bf16 v[16:19], v[124:127], a[68:71], v[16:19]
    buffer_load_dwordx4 v2, s[4:7], s45 offen offset:3072 sc1 lds
    v_mfma_f32_16x16x32_bf16 v[20:23], v[128:131], a[68:71], v[20:23]
    v_mfma_f32_16x16x32_bf16 v[24:27], v[84:87], a[72:75], 0
    v_mfma_f32_16x16x32_bf16 v[28:31], v[88:91], a[72:75], 0
    v_cvt_pk_bf16_f32 v32, v16, v17
    v_cvt_pk_bf16_f32 v34, v18, v19
    v_mfma_f32_16x16x32_bf16 v[24:27], v[92:95], a[76:79], v[24:27]
    v_cvt_pk_bf16_f32 v33, v20, v21
    v_cvt_pk_bf16_f32 v35, v22, v23
    v_mfma_f32_16x16x32_bf16 v[28:31], v[96:99], a[76:79], v[28:31]
    s_add_u32 s42, s42, 81920
    buffer_store_dwordx4 v[32:35], v2, s[4:7], s42 offen sc1
    v_mfma_f32_16x16x32_bf16 v[24:27], v[100:103], a[80:83], v[24:27]
    v_mfma_f32_16x16x32_bf16 v[28:31], v[104:107], a[80:83], v[28:31]
    s_add_u32 m0, m0, 4096
    s_add_u32 s45, s45, 4096
    v_mfma_f32_16x16x32_bf16 v[24:27], v[108:111], a[84:87], v[24:27]
    buffer_load_dwordx4 v2, s[4:7], s45 offen offset:0 sc1 lds
    v_mfma_f32_16x16x32_bf16 v[28:31], v[112:115], a[84:87], v[28:31]
    v_mfma_f32_16x16x32_bf16 v[24:27], v[116:119], a[88:91], v[24:27]
    v_mfma_f32_16x16x32_bf16 v[28:31], v[120:123], a[88:91], v[28:31]
    v_mfma_f32_16x16x32_bf16 v[24:27], v[124:127], a[92:95], v[24:27]
    buffer_load_dwordx4 v2, s[4:7], s45 offen offset:1024 sc1 lds
    v_mfma_f32_16x16x32_bf16 v[28:31], v[128:131], a[92:95], v[28:31]
    v_mfma_f32_16x16x32_bf16 v[16:19], v[84:87], a[96:99], 0
    v_mfma_f32_16x16x32_bf16 v[20:23], v[88:91], a[96:99], 0
    v_cvt_pk_bf16_f32 v36, v24, v25
    v_cvt_pk_bf16_f32 v38, v26, v27
    v_mfma_f32_16x16x32_bf16 v[16:19], v[92:95], a[100:103], v[16:19]
    v_cvt_pk_bf16_f32 v37, v28, v29
    v_cvt_pk_bf16_f32 v39, v30, v31
    v_mfma_f32_16x16x32_bf16 v[20:23], v[96:99], a[100:103], v[20:23]
    s_add_u32 s42, s42, 81920
    buffer_store_dwordx4 v[36:39], v2, s[4:7], s42 offen sc1
    v_mfma_f32_16x16x32_bf16 v[16:19], v[100:103], a[104:107], v[16:19]
    v_mfma_f32_16x16x32_bf16 v[20:23], v[104:107], a[104:107], v[20:23]
    v_mfma_f32_16x16x32_bf16 v[16:19], v[108:111], a[108:111], v[16:19]
    buffer_load_dwordx4 v2, s[4:7], s45 offen offset:2048 sc1 lds
    v_mfma_f32_16x16x32_bf16 v[20:23], v[112:115], a[108:111], v[20:23]
    v_mfma_f32_16x16x32_bf16 v[16:19], v[116:119], a[112:115], v[16:19]
    v_mfma_f32_16x16x32_bf16 v[20:23], v[120:123], a[112:115], v[20:23]
    v_mfma_f32_16x16x32_bf16 v[16:19], v[124:127], a[116:119], v[16:19]
    buffer_load_dwordx4 v2, s[4:7], s45 offen offset:3072 sc1 lds
    v_mfma_f32_16x16x32_bf16 v[20:23], v[128:131], a[116:119], v[20:23]
    v_mfma_f32_16x16x32_bf16 v[24:27], v[84:87], a[120:123], 0
    v_mfma_f32_16x16x32_bf16 v[28:31], v[88:91], a[120:123], 0
    v_cvt_pk_bf16_f32 v32, v16, v17
    v_cvt_pk_bf16_f32 v34, v18, v19
    v_mfma_f32_16x16x32_bf16 v[24:27], v[92:95], a[124:127], v[24:27]
    v_cvt_pk_bf16_f32 v33, v20, v21
    v_cvt_pk_bf16_f32 v35, v22, v23
    v_mfma_f32_16x16x32_bf16 v[28:31], v[96:99], a[124:127], v[28:31]
    s_add_u32 s42, s42, 81920
    buffer_store_dwordx4 v[32:35], v2, s[4:7], s42 offen sc1
    v_mfma_f32_16x16x32_bf16 v[24:27], v[100:103], a[128:131], v[24:27]
    v_mfma_f32_16x16x32_bf16 v[28:31], v[104:107], a[128:131], v[28:31]
    s_add_u32 m0, m0, 4096
    s_add_u32 s45, s45, 4096
    v_mfma_f32_16x16x32_bf16 v[24:27], v[108:111], a[132:135], v[24:27]
    buffer_load_dwordx4 v2, s[4:7], s45 offen offset:0 sc1 lds
    v_mfma_f32_16x16x32_bf16 v[28:31], v[112:115], a[132:135], v[28:31]
    v_mfma_f32_16x16x32_bf16 v[24:27], v[116:119], a[136:139], v[24:27]
    v_mfma_f32_16x16x32_bf16 v[28:31], v[120:123], a[136:139], v[28:31]
    v_mfma_f32_16x16x32_bf16 v[24:27], v[124:127], a[140:143], v[24:27]
    buffer_load_dwordx4 v2, s[4:7], s45 offen offset:1024 sc1 lds
    v_mfma_f32_16x16x32_bf16 v[28:31], v[128:131], a[140:143], v[28:31]
    v_mfma_f32_16x16x32_bf16 v[16:19], v[84:87], a[144:147], 0
    v_mfma_f32_16x16x32_bf16 v[20:23], v[88:91], a[144:147], 0
    v_cvt_pk_bf16_f32 v36, v24, v25
    v_cvt_pk_bf16_f32 v38, v26, v27
    v_mfma_f32_16x16x32_bf16 v[16:19], v[92:95], a[148:151], v[16:19]
    v_cvt_pk_bf16_f32 v37, v28, v29
    v_cvt_pk_bf16_f32 v39, v30, v31
    v_mfma_f32_16x16x32_bf16 v[20:23], v[96:99], a[148:151], v[20:23]
    buffer_store_dwordx4 v[36:39], v2, s[4:7], s43 offen sc1
    v_mfma_f32_16x16x32_bf16 v[16:19], v[100:103], a[152:155], v[16:19]
    v_mfma_f32_16x16x32_bf16 v[20:23], v[104:107], a[152:155], v[20:23]
    v_mfma_f32_16x16x32_bf16 v[16:19], v[108:111], a[156:159], v[16:19]
    v_mfma_f32_16x16x32_bf16 v[20:23], v[112:115], a[156:159], v[20:23]
    v_mfma_f32_16x16x32_bf16 v[16:19], v[116:119], a[160:163], v[16:19]
    v_mfma_f32_16x16x32_bf16 v[20:23], v[120:123], a[160:163], v[20:23]
    v_mfma_f32_16x16x32_bf16 v[16:19], v[124:127], a[164:167], v[16:19]
    v_mfma_f32_16x16x32_bf16 v[20:23], v[128:131], a[164:167], v[20:23]
    v_mfma_f32_16x16x32_bf16 v[24:27], v[84:87], a[168:171], 0
    v_mfma_f32_16x16x32_bf16 v[28:31], v[88:91], a[168:171], 0
    v_cvt_pk_bf16_f32 v32, v16, v17
    v_cvt_pk_bf16_f32 v34, v18, v19
    v_mfma_f32_16x16x32_bf16 v[24:27], v[92:95], a[172:175], v[24:27]
    v_cvt_pk_bf16_f32 v33, v20, v21
    v_cvt_pk_bf16_f32 v35, v22, v23
    v_mfma_f32_16x16x32_bf16 v[28:31], v[96:99], a[172:175], v[28:31]
    s_add_u32 s43, s43, 81920
    buffer_store_dwordx4 v[32:35], v2, s[4:7], s43 offen sc1
    v_mfma_f32_16x16x32_bf16 v[24:27], v[100:103], a[176:179], v[24:27]
    v_mfma_f32_16x16x32_bf16 v[28:31], v[104:107], a[176:179], v[28:31]
    v_mfma_f32_16x16x32_bf16 v[24:27], v[108:111], a[180:183], v[24:27]
    v_mfma_f32_16x16x32_bf16 v[28:31], v[112:115], a[180:183], v[28:31]
    v_mfma_f32_16x16x32_bf16 v[24:27], v[116:119], a[184:187], v[24:27]
    v_mfma_f32_16x16x32_bf16 v[28:31], v[120:123], a[184:187], v[28:31]
    v_mfma_f32_16x16x32_bf16 v[24:27], v[124:127], a[188:191], v[24:27]
    v_mfma_f32_16x16x32_bf16 v[28:31], v[128:131], a[188:191], v[28:31]
    v_mfma_f32_16x16x32_bf16 v[16:19], v[84:87], a[192:195], 0
    v_mfma_f32_16x16x32_bf16 v[20:23], v[88:91], a[192:195], 0
    v_cvt_pk_bf16_f32 v36, v24, v25
    v_cvt_pk_bf16_f32 v38, v26, v27
    v_mfma_f32_16x16x32_bf16 v[16:19], v[92:95], a[196:199], v[16:19]
    v_cvt_pk_bf16_f32 v37, v28, v29
    v_cvt_pk_bf16_f32 v39, v30, v31
    v_mfma_f32_16x16x32_bf16 v[20:23], v[96:99], a[196:199], v[20:23]
    s_add_u32 s43, s43, 81920
    buffer_store_dwordx4 v[36:39], v2, s[4:7], s43 offen sc1
    v_mfma_f32_16x16x32_bf16 v[16:19], v[100:103], a[200:203], v[16:19]
    v_mfma_f32_16x16x32_bf16 v[20:23], v[104:107], a[200:203], v[20:23]
    v_mfma_f32_16x16x32_bf16 v[16:19], v[108:111], a[204:207], v[16:19]
    v_mfma_f32_16x16x32_bf16 v[20:23], v[112:115], a[204:207], v[20:23]
    v_mfma_f32_16x16x32_bf16 v[16:19], v[116:119], a[208:211], v[16:19]
    v_mfma_f32_16x16x32_bf16 v[20:23], v[120:123], a[208:211], v[20:23]
    v_mfma_f32_16x16x32_bf16 v[16:19], v[124:127], a[212:215], v[16:19]
    v_mfma_f32_16x16x32_bf16 v[20:23], v[128:131], a[212:215], v[20:23]
    v_mfma_f32_16x16x32_bf16 v[24:27], v[84:87], a[216:219], 0
    v_mfma_f32_16x16x32_bf16 v[28:31], v[88:91], a[216:219], 0
    v_cvt_pk_bf16_f32 v32, v16, v17
    v_cvt_pk_bf16_f32 v34, v18, v19
    v_mfma_f32_16x16x32_bf16 v[24:27], v[92:95], a[220:223], v[24:27]
    v_cvt_pk_bf16_f32 v33, v20, v21
    v_cvt_pk_bf16_f32 v35, v22, v23
    v_mfma_f32_16x16x32_bf16 v[28:31], v[96:99], a[220:223], v[28:31]
    s_add_u32 s43, s43, 81920
    buffer_store_dwordx4 v[32:35], v2, s[4:7], s43 offen sc1
    v_mfma_f32_16x16x32_bf16 v[24:27], v[100:103], a[224:227], v[24:27]
    s_waitcnt vmcnt(4)
    s_barrier
    v_mfma_f32_16x16x32_bf16 v[28:31], v[104:107], a[224:227], v[28:31]
    ds_read_b128 v[40:43], v2 offset:0
    v_mfma_f32_16x16x32_bf16 v[24:27], v[108:111], a[228:231], v[24:27]
    ds_read_b128 v[44:47], v2 offset:1024
    v_mfma_f32_16x16x32_bf16 v[28:31], v[112:115], a[228:231], v[28:31]
    ds_read_b128 v[64:67], v3 offset:0
    v_mfma_f32_16x16x32_bf16 v[24:27], v[116:119], a[232:235], v[24:27]
    ds_read_b128 v[48:51], v2 offset:2048
    v_mfma_f32_16x16x32_bf16 v[28:31], v[120:123], a[232:235], v[28:31]
    ds_read_b128 v[52:55], v2 offset:3072
    v_mfma_f32_16x16x32_bf16 v[24:27], v[124:127], a[236:239], v[24:27]
    ds_read_b128 v[72:75], v3 offset:1024
    v_mfma_f32_16x16x32_bf16 v[28:31], v[128:131], a[236:239], v[28:31]
    s_cmp_lg_u32 s64, 0
    s_cbranch_scc1 L_VF_lite
L_VF_B:
    s_waitcnt lgkmcnt(3)
    v_mfma_f32_16x16x32_bf16 v[92:95], a[240:243], v[40:43], 0
    ds_read_b128 v[56:59], v2 offset:4096
    v_mfma_f32_16x16x32_bf16 v[96:99], a[240:243], v[44:47], 0
    ds_read_b128 v[60:63], v2 offset:5120
    v_cvt_pk_bf16_f32 v36, v24, v25
    v_mfma_f32_16x16x32_bf16 v[100:103], v[200:203], v[40:43], 0
    ds_read_b128 v[80:83], v3 offset:2048
    v_cvt_pk_bf16_f32 v38, v26, v27
    v_mfma_f32_16x16x32_bf16 v[104:107], v[200:203], v[44:47], 0
    v_cvt_pk_bf16_f32 v37, v28, v29
    v_cvt_pk_bf16_f32 v39, v30, v31
    v_mfma_f32_16x16x32_bf16 v[108:111], v[64:67], v[40:43], 0
    s_add_u32 s43, s43, 81920
    v_mfma_f32_16x16x32_bf16 v[112:115], v[64:67], v[44:47], 0
    s_waitcnt lgkmcnt(3)
    v_mfma_f32_16x16x32_bf16 v[92:95], a[244:247], v[48:51], v[92:95]
    ds_read_b128 v[40:43], v2 offset:6144
    v_mfma_f32_16x16x32_bf16 v[96:99], a[244:247], v[52:55], v[96:99]
    ds_read_b128 v[44:47], v2 offset:7168
    v_mfma_f32_16x16x32_bf16 v[100:103], v[204:207], v[48:51], v[100:103]
    ds_read_b128 v[64:67], v3 offset:3072
    v_mfma_f32_16x16x32_bf16 v[104:107], v[204:207], v[52:55], v[104:107]
    s_mov_b64 exec, s[60:61]
    buffer_store_dwordx4 v[36:39], v2, s[4:7], s43 offen sc1
    s_mov_b64 exec, -1
    v_mfma_f32_16x16x32_bf16 v[108:111], v[72:75], v[48:51], v[108:111]
    s_add_u32 s40, s26, 0
    s_lshr_b32 s41, s40, 2
    s_xor_b32 s41, s41, s40
    v_mfma_f32_16x16x32_bf16 v[112:115], v[72:75], v[52:55], v[112:115]
    s_waitcnt lgkmcnt(3)
    v_mfma_f32_16x16x32_bf16 v[92:95], a[248:251], v[56:59], v[92:95]
    ds_read_b128 v[48:51], v2 offset:8192
    v_mfma_f32_16x16x32_bf16 v[96:99], a[248:251], v[60:63], v[96:99]
    ds_read_b128 v[52:55], v2 offset:9216
    v_mfma_f32_16x16x32_bf16 v[100:103], v[208:211], v[56:59], v[100:103]
    ds_read_b128 v[72:75], v3 offset:20480
    v_mfma_f32_16x16x32_bf16 v[104:107], v[208:211], v[60:63], v[104:107]
    ds_read_b128 v[76:79], v3 offset:4096
    v_mfma_f32_16x16x32_bf16 v[108:111], v[80:83], v[56:59], v[108:111]
    s_xor_b32 s41, s41, s28
    s_and_b32 s41, s41, 1
    s_lshl_b32 s41, s41, 13
    v_mfma_f32_16x16x32_bf16 v[112:115], v[80:83], v[60:63], v[112:115]
    s_waitcnt lgkmcnt(4)
    v_mfma_f32_16x16x32_bf16 v[92:95], a[252:255], v[40:43], v[92:95]
    ds_read_b128 v[56:59], v2 offset:10240
    v_mfma_f32_16x16x32_bf16 v[96:99], a[252:255], v[44:47], v[96:99]
    ds_read_b128 v[60:63], v2 offset:11264
    v_mfma_f32_16x16x32_bf16 v[100:103], v[212:215], v[40:43], v[100:103]
    ds_read_b128 v[80:83], v3 offset:21504
    v_mfma_f32_16x16x32_bf16 v[104:107], v[212:215], v[44:47], v[104:107]
    ds_read_b128 v[84:87], v3 offset:5120
    v_mfma_f32_16x16x32_bf16 v[108:111], v[64:67], v[40:43], v[108:111]
    s_lshr_b32 s40, s40, 1
    s_lshl_b32 s40, s40, 20
    s_or_b32 s35, s40, s41
    v_mfma_f32_16x16x32_bf16 v[112:115], v[64:67], v[44:47], v[112:115]
    s_waitcnt lgkmcnt(4)
    v_mfma_f32_16x16x32_bf16 v[92:95], v[136:139], v[48:51], v[92:95]
    ds_read_b128 v[40:43], v2 offset:12288
    v_mfma_f32_16x16x32_bf16 v[96:99], v[136:139], v[52:55], v[96:99]
    ds_read_b128 v[44:47], v2 offset:13312
    v_mfma_f32_16x16x32_bf16 v[100:103], v[72:75], v[48:51], v[100:103]
    ds_read_b128 v[64:67], v3 offset:6144
    v_mfma_f32_16x16x32_bf16 v[104:107], v[72:75], v[52:55], v[104:107]
    s_and_b32 s59, s3, 0x4000
    s_add_u32 s59, s59, s35
    s_add_u32 s40, s36, 0
    v_mfma_f32_16x16x32_bf16 v[108:111], v[76:79], v[48:51], v[108:111]
    s_cmp_ge_u32 s40, 5
    s_cselect_b32 s41, 5, 0
    s_sub_u32 s40, s40, s41
    v_mfma_f32_16x16x32_bf16 v[112:115], v[76:79], v[52:55], v[112:115]
    s_waitcnt lgkmcnt(3)
    v_mfma_f32_16x16x32_bf16 v[92:95], v[140:143], v[56:59], v[92:95]
    ds_read_b128 v[48:51], v2 offset:14336
    v_mfma_f32_16x16x32_bf16 v[96:99], v[140:143], v[60:63], v[96:99]
    ds_read_b128 v[52:55], v2 offset:15360
    v_mfma_f32_16x16x32_bf16 v[100:103], v[80:83], v[56:59], v[100:103]
    ds_read_b128 v[72:75], v3 offset:7168
    v_mfma_f32_16x16x32_bf16 v[104:107], v[80:83], v[60:63], v[104:107]
    s_lshl_b32 s40, s40, 15
    s_add_u32 s46, s59, s40
    s_add_u32 s40, s36, 1
    v_mfma_f32_16x16x32_bf16 v[108:111], v[84:87], v[56:59], v[108:111]
    s_cmp_ge_u32 s40, 5
    s_cselect_b32 s41, 5, 0
    s_sub_u32 s40, s40, s41
    v_mfma_f32_16x16x32_bf16 v[112:115], v[84:87], v[60:63], v[112:115]
    s_waitcnt lgkmcnt(3)
    v_mfma_f32_16x16x32_bf16 v[92:95], v[144:147], v[40:43], v[92:95]
    ds_read_b128 v[56:59], v2 offset:16384
    v_mfma_f32_16x16x32_bf16 v[96:99], v[144:147], v[44:47], v[96:99]
    ds_read_b128 v[60:63], v2 offset:17408
    v_mfma_f32_16x16x32_bf16 v[100:103], v[216:219], v[40:43], v[100:103]
    ds_read_b128 v[80:83], v3 offset:8192
    v_mfma_f32_16x16x32_bf16 v[104:107], v[216:219], v[44:47], v[104:107]
    s_lshl_b32 s40, s40, 15
    s_add_u32 s47, s59, s40
    s_add_u32 s40, s36, 2
    v_mfma_f32_16x16x32_bf16 v[108:111], v[64:67], v[40:43], v[108:111]
    s_cmp_ge_u32 s40, 5
    s_cselect_b32 s41, 5, 0
    s_sub_u32 s40, s40, s41
    v_mfma_f32_16x16x32_bf16 v[112:115], v[64:67], v[44:47], v[112:115]
    s_waitcnt lgkmcnt(3)
    v_mfma_f32_16x16x32_bf16 v[92:95], v[148:151], v[48:51], v[92:95]
    ds_read_b128 v[40:43], v2 offset:18432
    v_mfma_f32_16x16x32_bf16 v[96:99], v[148:151], v[52:55], v[96:99]
    ds_read_b128 v[44:47], v2 offset:19456
    v_mfma_f32_16x16x32_bf16 v[100:103], v[220:223], v[48:51], v[100:103]
    ds_read_b128 v[64:67], v3 offset:9216
    v_mfma_f32_16x16x32_bf16 v[104:107], v[220:223], v[52:55], v[104:107]
    s_lshl_b32 s40, s40, 15
    s_add_u32 s48, s59, s40
    s_add_u32 s40, s36, 3
    v_mfma_f32_16x16x32_bf16 v[108:111], v[72:75], v[48:51], v[108:111]
    s_cmp_ge_u32 s40, 5
    s_cselect_b32 s41, 5, 0
    s_sub_u32 s40, s40, s41
    v_mfma_f32_16x16x32_bf16 v[112:115], v[72:75], v[52:55], v[112:115]
    s_waitcnt lgkmcnt(3)
    s_waitcnt vmcnt(0)
    s_barrier
    v_mfma_f32_16x16x32_bf16 v[92:95], v[152:155], v[56:59], v[92:95]
    ds_read_b128 v[48:51], v2 offset:20480
    v_mfma_f32_16x16x32_bf16 v[96:99], v[152:155], v[60:63], v[96:99]
    ds_read_b128 v[52:55], v2 offset:21504
    v_mfma_f32_16x16x32_bf16 v[100:103], v[224:227], v[56:59], v[100:103]
    ds_read_b128 v[72:75], v3 offset:22528
    v_mfma_f32_16x16x32_bf16 v[104:107], v[224:227], v[60:63], v[104:107]
    ds_read_b128 v[76:79], v3 offset:10240
    v_mfma_f32_16x16x32_bf16 v[108:111], v[80:83], v[56:59], v[108:111]
    s_mov_b64 exec, s[56:57]
    buffer_store_dword v12, v12, s[4:7], s52 offen sc1
    s_mov_b64 exec, -1
    v_mfma_f32_16x16x32_bf16 v[112:115], v[80:83], v[60:63], v[112:115]
    s_waitcnt lgkmcnt(4)
    v_mfma_f32_16x16x32_bf16 v[92:95], v[156:159], v[40:43], v[92:95]
    ds_read_b128 v[56:59], v2 offset:22528
    v_mfma_f32_16x16x32_bf16 v[96:99], v[156:159], v[44:47], v[96:99]
    ds_read_b128 v[60:63], v2 offset:23552
    v_mfma_f32_16x16x32_bf16 v[100:103], v[228:231], v[40:43], v[100:103]
    ds_read_b128 v[80:83], v3 offset:23552
    v_mfma_f32_16x16x32_bf16 v[104:107], v[228:231], v[44:47], v[104:107]
    ds_read_b128 v[84:87], v3 offset:11264
    v_mfma_f32_16x16x32_bf16 v[108:111], v[64:67], v[40:43], v[108:111]
    s_lshl_b32 s40, s40, 15
    s_add_u32 s58, s59, s40
    s_add_u32 s40, s36, 4
    v_mfma_f32_16x16x32_bf16 v[112:115], v[64:67], v[44:47], v[112:115]
    s_waitcnt lgkmcnt(4)
    v_mfma_f32_16x16x32_bf16 v[92:95], v[160:163], v[48:51], v[92:95]
    ds_read_b128 v[40:43], v2 offset:24576
    v_mfma_f32_16x16x32_bf16 v[96:99], v[160:163], v[52:55], v[96:99]
    ds_read_b128 v[44:47], v2 offset:25600
    v_mfma_f32_16x16x32_bf16 v[100:103], v[72:75], v[48:51], v[100:103]
    ds_read_b128 v[64:67], v3 offset:12288
    v_mfma_f32_16x16x32_bf16 v[104:107], v[72:75], v[52:55], v[104:107]
    s_cmp_ge_u32 s40, 5
    s_cselect_b32 s41, 5, 0
    s_sub_u32 s40, s40, s41
    v_mfma_f32_16x16x32_bf16 v[108:111], v[76:79], v[48:51], v[108:111]
    s_lshl_b32 s40, s40, 15
    s_add_u32 s59, s59, s40
    s_add_u32 s50, s35, s3
    v_mfma_f32_16x16x32_bf16 v[112:115], v[76:79], v[52:55], v[112:115]
    s_waitcnt lgkmcnt(3)
    v_mfma_f32_16x16x32_bf16 v[92:95], v[164:167], v[56:59], v[92:95]
    ds_read_b128 v[48:51], v2 offset:26624
    v_mfma_f32_16x16x32_bf16 v[96:99], v[164:167], v[60:63], v[96:99]
    ds_read_b128 v[52:55], v2 offset:27648
    v_mfma_f32_16x16x32_bf16 v[100:103], v[80:83], v[56:59], v[100:103]
    ds_read_b128 v[72:75], v3 offset:13312
    v_mfma_f32_16x16x32_bf16 v[104:107], v[80:83], v[60:63], v[104:107]
    s_mov_b32 s34, 0
    v_mfma_f32_16x16x32_bf16 v[108:111], v[84:87], v[56:59], v[108:111]
    v_mfma_f32_16x16x32_bf16 v[112:115], v[84:87], v[60:63], v[112:115]
    s_waitcnt lgkmcnt(3)
    v_mfma_f32_16x16x32_bf16 v[92:95], v[168:171], v[40:43], v[92:95]
    ds_read_b128 v[56:59], v2 offset:28672
    v_mfma_f32_16x16x32_bf16 v[96:99], v[168:171], v[44:47], v[96:99]
    ds_read_b128 v[60:63], v2 offset:29696
    v_mfma_f32_16x16x32_bf16 v[100:103], v[232:235], v[40:43], v[100:103]
    ds_read_b128 v[80:83], v3 offset:14336
    v_mfma_f32_16x16x32_bf16 v[104:107], v[232:235], v[44:47], v[104:107]
    v_mfma_f32_16x16x32_bf16 v[108:111], v[64:67], v[40:43], v[108:111]
    v_mfma_f32_16x16x32_bf16 v[112:115], v[64:67], v[44:47], v[112:115]
    s_waitcnt lgkmcnt(3)
    v_mfma_f32_16x16x32_bf16 v[92:95], v[172:175], v[48:51], v[92:95]
    ds_read_b128 v[40:43], v2 offset:30720
    v_mfma_f32_16x16x32_bf16 v[96:99], v[172:175], v[52:55], v[96:99]
    ds_read_b128 v[44:47], v2 offset:31744
    v_mfma_f32_16x16x32_bf16 v[100:103], v[236:239], v[48:51], v[100:103]
    ds_read_b128 v[64:67], v3 offset:15360
    v_mfma_f32_16x16x32_bf16 v[104:107], v[236:239], v[52:55], v[104:107]
    v_mfma_f32_16x16x32_bf16 v[108:111], v[72:75], v[48:51], v[108:111]
    v_mfma_f32_16x16x32_bf16 v[112:115], v[72:75], v[52:55], v[112:115]
    s_waitcnt lgkmcnt(3)
    v_mfma_f32_16x16x32_bf16 v[92:95], v[176:179], v[56:59], v[92:95]
    ds_read_b128 v[48:51], v2 offset:32768
    v_mfma_f32_16x16x32_bf16 v[96:99], v[176:179], v[60:63], v[96:99]
    ds_read_b128 v[52:55], v2 offset:33792
    v_mfma_f32_16x16x32_bf16 v[100:103], v[240:243], v[56:59], v[100:103]
    ds_read_b128 v[72:75], v3 offset:24576
    v_mfma_f32_16x16x32_bf16 v[104:107], v[240:243], v[60:63], v[104:107]
    ds_read_b128 v[76:79], v3 offset:16384
    v_mfma_f32_16x16x32_bf16 v[108:111], v[80:83], v[56:59], v[108:111]
    v_mfma_f32_16x16x32_bf16 v[112:115], v[80:83], v[60:63], v[112:115]
    s_waitcnt lgkmcnt(4)
    v_mfma_f32_16x16x32_bf16 v[92:95], v[180:183], v[40:43], v[92:95]
    ds_read_b128 v[56:59], v2 offset:34816
    v_mfma_f32_16x16x32_bf16 v[96:99], v[180:183], v[44:47], v[96:99]
    ds_read_b128 v[60:63], v2 offset:35840
    v_mfma_f32_16x16x32_bf16 v[100:103], v[244:247], v[40:43], v[100:103]
    ds_read_b128 v[80:83], v3 offset:25600
    v_mfma_f32_16x16x32_bf16 v[104:107], v[244:247], v[44:47], v[104:107]
    ds_read_b128 v[84:87], v3 offset:17408
    v_mfma_f32_16x16x32_bf16 v[108:111], v[64:67], v[40:43], v[108:111]
    v_mfma_f32_16x16x32_bf16 v[112:115], v[64:67], v[44:47], v[112:115]
    s_waitcnt lgkmcnt(4)
    v_mfma_f32_16x16x32_bf16 v[92:95], v[184:187], v[48:51], v[92:95]
    ds_read_b128 v[40:43], v2 offset:36864
    v_mfma_f32_16x16x32_bf16 v[96:99], v[184:187], v[52:55], v[96:99]
    ds_read_b128 v[44:47], v2 offset:37888
    v_mfma_f32_16x16x32_bf16 v[100:103], v[72:75], v[48:51], v[100:103]
    ds_read_b128 v[64:67], v3 offset:18432
    v_mfma_f32_16x16x32_bf16 v[104:107], v[72:75], v[52:55], v[104:107]
    v_mfma_f32_16x16x32_bf16 v[108:111], v[76:79], v[48:51], v[108:111]
    v_mfma_f32_16x16x32_bf16 v[112:115], v[76:79], v[52:55], v[112:115]
    s_waitcnt lgkmcnt(3)
    v_mfma_f32_16x16x32_bf16 v[92:95], v[188:191], v[56:59], v[92:95]
    ds_read_b128 v[48:51], v2 offset:38912
    v_mfma_f32_16x16x32_bf16 v[96:99], v[188:191], v[60:63], v[96:99]
    ds_read_b128 v[52:55], v2 offset:39936
    v_mfma_f32_16x16x32_bf16 v[100:103], v[80:83], v[56:59], v[100:103]
    ds_read_b128 v[72:75], v3 offset:19456
    v_mfma_f32_16x16x32_bf16 v[104:107], v[80:83], v[60:63], v[104:107]
    v_mfma_f32_16x16x32_bf16 v[108:111], v[84:87], v[56:59], v[108:111]
    v_mfma_f32_16x16x32_bf16 v[112:115], v[84:87], v[60:63], v[112:115]
    s_waitcnt lgkmcnt(3)
    v_mfma_f32_16x16x32_bf16 v[92:95], v[192:195], v[40:43], v[92:95]
    v_mfma_f32_16x16x32_bf16 v[96:99], v[192:195], v[44:47], v[96:99]
    v_mfma_f32_16x16x32_bf16 v[100:103], v[248:251], v[40:43], v[100:103]
    v_mfma_f32_16x16x32_bf16 v[104:107], v[248:251], v[44:47], v[104:107]
    v_mfma_f32_16x16x32_bf16 v[108:111], v[64:67], v[40:43], v[108:111]
    v_mfma_f32_16x16x32_bf16 v[112:115], v[64:67], v[44:47], v[112:115]
    s_waitcnt lgkmcnt(0)
    v_mfma_f32_16x16x32_bf16 v[92:95], v[196:199], v[48:51], v[92:95]
    v_mfma_f32_16x16x32_bf16 v[96:99], v[196:199], v[52:55], v[96:99]
    buffer_load_dword v132, v12, s[4:7], s50 offen sc1
    v_mfma_f32_16x16x32_bf16 v[100:103], v[252:255], v[48:51], v[100:103]
    v_mfma_f32_16x16x32_bf16 v[104:107], v[252:255], v[52:55], v[104:107]
    v_mfma_f32_16x16x32_bf16 v[108:111], v[72:75], v[48:51], v[108:111]
    v_mfma_f32_16x16x32_bf16 v[112:115], v[72:75], v[52:55], v[112:115]
    s_cmp_lg_u32 s29, 0
    s_cbranch_scc1 L_silu
nsilu_18:
    v_cvt_pk_bf16_f32 v16, v92, v93
    v_cvt_pk_bf16_f32 v17, v94, v95
    ds_write_b64 v5, v[16:17] offset:0
    v_cvt_pk_bf16_f32 v18, v96, v97
    v_cvt_pk_bf16_f32 v19, v98, v99
    ds_write_b64 v5, v[18:19] offset:6144
    buffer_load_dword v133, v12, s[4:7], s50 offen sc1
    v_cvt_pk_bf16_f32 v20, v100, v101
    v_cvt_pk_bf16_f32 v21, v102, v103
    ds_write_b64 v6, v[20:21] offset:0
    v_cvt_pk_bf16_f32 v22, v104, v105
    v_cvt_pk_bf16_f32 v23, v106, v107
    ds_write_b64 v6, v[22:23] offset:6144
    buffer_load_dword v134, v12, s[4:7], s50 offen sc1
    v_cvt_pk_bf16_f32 v24, v108, v109
    v_cvt_pk_bf16_f32 v25, v110, v111
    ds_write_b64 v5, v[24:25] offset:1024
    v_cvt_pk_bf16_f32 v26, v112, v113
    v_cvt_pk_bf16_f32 v27, v114, v115
    ds_write_b64 v5, v[26:27] offset:7168
    s_cmp_lg_u32 s53, 0
    s_cbranch_scc1 L_VF_skip
L_VF_C:
    ds_read_b128 v[68:71], v3 offset:0
    ds_read_b128 v[72:75], v3 offset:1024
    ds_read_b128 v[76:79], v3 offset:2048
    ds_read_b128 v[80:83], v3 offset:3072
    ds_read_b128 v[84:87], v3 offset:4096
    ds_read_b128 v[88:91], v3 offset:5120
.p2align 6
poll_19:
    s_waitcnt vmcnt(2)
    v_cmp_eq_u32 vcc, -1, v132
    s_cbranch_vccz pd_20
    buffer_load_dword v132, v12, s[4:7], s50 offen sc1
    s_waitcnt vmcnt(2)
    v_cmp_eq_u32 vcc, -1, v133
    s_cbranch_vccz pd_20
    buffer_load_dword v133, v12, s[4:7], s50 offen sc1
    s_waitcnt vmcnt(2)
    v_cmp_eq_u32 vcc, -1, v134
    s_cbranch_vccz pd_20
    buffer_load_dword v134, v12, s[4:7], s50 offen sc1
    s_add_u32 s27, s27, 1
    s_cmp_lt_u32 s27, 131072
    s_cbranch_scc1 poll_19
    s_branch L_abort
.p2align 6
    s_nop 0
    s_nop 0
pd_20:
    s_barrier
    buffer_load_dwordx4 v[16:19], v2, s[4:7], s46 offen offset:0
    v_mov_b64 v[56:57], 0
    s_nop 1
    v_mov_b64 v[58:59], 0
    s_nop 2
    v_mov_b64 v[60:61], 0
    s_nop 1
    v_mov_b64 v[62:63], 0
    s_nop 2
    buffer_load_dwordx4 v[20:23], v2, s[4:7], s46 offen offset:1024
    v_mov_b64 v[64:65], 0
    s_nop 1
    v_mov_b64 v[66:67], 0
    s_nop 2
    v_mov_b64 v[92:93], 0
    s_nop 1
    v_mov_b64 v[94:95], 0
    s_nop 2
    buffer_load_dwordx4 v[24:27], v2, s[4:7], s47 offen offset:0
    v_mov_b64 v[96:97], 0
    s_nop 1
    v_mov_b64 v[98:99], 0
    s_nop 2
    v_mov_b64 v[100:101], 0
    s_nop 1
    v_mov_b64 v[102:103], 0
    s_nop 2
    buffer_load_dwordx4 v[28:31], v2, s[4:7], s47 offen offset:1024
    v_mov_b64 v[104:105], 0
    s_nop 1
    v_mov_b64 v[106:107], 0
    s_nop 2
    v_mov_b64 v[108:109], 0
    s_nop 1
    v_mov_b64 v[110:111], 0
    s_nop 2
    buffer_load_dwordx4 v[32:35], v2, s[4:7], s48 offen offset:0
    v_mov_b64 v[112:113], 0
    s_nop 1
    v_mov_b64 v[114:115], 0
    s_nop 2
    v_mov_b64 v[116:117], 0
    s_nop 1
    v_mov_b64 v[118:119], 0
    s_nop 2
    buffer_load_dwordx4 v[36:39], v2, s[4:7], s48 offen offset:1024
    v_mov_b64 v[120:121], 0
    s_nop 5
    v_mov_b64 v[122:123], 0
    s_nop 5
    buffer_load_dwordx4 v[40:43], v2, s[4:7], s58 offen offset:0
    s_waitcnt vmcnt(6)
    s_waitcnt lgkmcnt(4)
    v_smfmac_f32_16x16x64_bf16 v[64:67], v[16:19], v[68:75], v4
    ds_read_b128 v[68:71], v3 offset:20480
    v_smfmac_f32_16x16x64_bf16 v[60:63], v[16:19], v[200:207], v4
    ds_read_b128 v[72:75], v3 offset:21504
    v_smfmac_f32_16x16x64_bf16 v[56:59], v[16:19], a[240:247], v4
    buffer_load_dwordx4 v[44:47], v2, s[4:7], s58 offen offset:1024
    s_waitcnt vmcnt(6)
    s_waitcnt lgkmcnt(4)
    v_smfmac_f32_16x16x64_bf16 v[64:67], v[20:23], v[76:83], v4
    ds_read_b128 v[76:79], v3 offset:6144
    v_smfmac_f32_16x16x64_bf16 v[60:63], v[20:23], v[208:215], v4
    ds_read_b128 v[80:83], v3 offset:7168
    v_smfmac_f32_16x16x64_bf16 v[56:59], v[20:23], a[248:255], v4
    buffer_load_dwordx4 v[48:51], v2, s[4:7], s59 offen offset:0
    s_waitcnt vmcnt(6)
    s_waitcnt lgkmcnt(4)
    v_smfmac_f32_16x16x64_bf16 v[64:67], v[24:27], v[84:91], v4
    ds_read_b128 v[84:87], v3 offset:8192
    s_waitcnt lgkmcnt(3)
    v_smfmac_f32_16x16x64_bf16 v[60:63], v[24:27], v[68:75], v4
    ds_read_b128 v[88:91], v3 offset:9216
    v_smfmac_f32_16x16x64_bf16 v[56:59], v[24:27], v[136:143], v4
    ds_read_b128 v[68:71], v3 offset:10240
    ds_read_b128 v[72:75], v3 offset:11264
    buffer_load_dwordx4 v[52:55], v2, s[4:7], s59 offen offset:1024
    s_waitcnt vmcnt(6)
    s_waitcnt lgkmcnt(4)
    v_smfmac_f32_16x16x64_bf16 v[64:67], v[28:31], v[76:83], v4
    ds_read_b128 v[76:79], v3 offset:22528
    v_smfmac_f32_16x16x64_bf16 v[60:63], v[28:31], v[216:223], v4
    ds_read_b128 v[80:83], v3 offset:23552
    v_smfmac_f32_16x16x64_bf16 v[56:59], v[28:31], v[144:151], v4
    v_cmp_u_f32 vcc, v16, v23
    s_waitcnt vmcnt(5)
    s_waitcnt lgkmcnt(4)
    v_smfmac_f32_16x16x64_bf16 v[64:67], v[32:35], v[84:91], v4
    ds_read_b128 v[84:87], v3 offset:12288
    v_smfmac_f32_16x16x64_bf16 v[60:63], v[32:35], v[224:231], v4
    ds_read_b128 v[88:91], v3 offset:13312
    v_smfmac_f32_16x16x64_bf16 v[56:59], v[32:35], v[152:159], v4
    s_cbranch_vccnz slow_21
    s_waitcnt vmcnt(4)
    s_waitcnt lgkmcnt(4)
    v_smfmac_f32_16x16x64_bf16 v[64:67], v[36:39], v[68:75], v4
    ds_read_b128 v[68:71], v3 offset:14336
    s_waitcnt lgkmcnt(3)
    v_smfmac_f32_16x16x64_bf16 v[60:63], v[36:39], v[76:83], v4
    ds_read_b128 v[72:75], v3 offset:15360
    v_smfmac_f32_16x16x64_bf16 v[56:59], v[36:39], v[160:167], v4
    ds_read_b128 v[76:79], v3 offset:16384
    ds_read_b128 v[80:83], v3 offset:17408
    s_waitcnt vmcnt(3)
    s_waitcnt lgkmcnt(4)
    v_smfmac_f32_16x16x64_bf16 v[64:67], v[40:43], v[84:91], v4
    ds_read_b128 v[84:87], v3 offset:24576
    v_smfmac_f32_16x16x64_bf16 v[60:63], v[40:43], v[232:239], v4
    ds_read_b128 v[88:91], v3 offset:25600
    v_smfmac_f32_16x16x64_bf16 v[56:59], v[40:43], v[168:175], v4
    s_waitcnt vmcnt(2)
    s_waitcnt lgkmcnt(4)
    v_smfmac_f32_16x16x64_bf16 v[64:67], v[44:47], v[68:75], v4
    ds_read_b128 v[68:71], v3 offset:18432
    v_smfmac_f32_16x16x64_bf16 v[60:63], v[44:47], v[240:247], v4
    ds_read_b128 v[72:75], v3 offset:19456
    v_smfmac_f32_16x16x64_bf16 v[56:59], v[44:47], v[176:183], v4
    s_waitcnt vmcnt(1)
    s_waitcnt lgkmcnt(4)
    v_smfmac_f32_16x16x64_bf16 v[64:67], v[48:51], v[76:83], v4
    s_waitcnt lgkmcnt(2)
    v_smfmac_f32_16x16x64_bf16 v[60:63], v[48:51], v[84:91], v4
    v_smfmac_f32_16x16x64_bf16 v[56:59], v[48:51], v[184:191], v4
    s_waitcnt vmcnt(0)
    s_waitcnt lgkmcnt(0)
    v_smfmac_f32_16x16x64_bf16 v[64:67], v[52:55], v[68:75], v4
    v_smfmac_f32_16x16x64_bf16 v[60:63], v[52:55], v[248:255], v4
    v_smfmac_f32_16x16x64_bf16 v[56:59], v[52:55], v[192:199], v4
ok_22:
    v_add_f32 v64, v64, v65
    v_add_f32 v66, v66, v67
    v_cvt_pk_bf16_f32 v65, v64, v66
    s_nop 0
    v_add_f32 v60, v60, v61
    v_add_f32 v62, v62, v63
    v_cvt_pk_bf16_f32 v61, v60, v62
    v_mov_b32_dpp v67, v65 quad_perm:[1,0,3,2] row_mask:0xf bank_mask:0xf
    v_perm_b32 v65, v67, v65, v14
    ds_write_b32 v7, v65 offset:512
    v_add_f32 v56, v56, v57
    v_add_f32 v58, v58, v59
    v_cvt_pk_bf16_f32 v57, v56, v58
    v_mov_b32_dpp v63, v61 quad_perm:[1,0,3,2] row_mask:0xf bank_mask:0xf
    v_perm_b32 v61, v63, v61, v14
    ds_write_b32 v8, v61 offset:0
    v_mov_b32_dpp v59, v57 quad_perm:[1,0,3,2] row_mask:0xf bank_mask:0xf
    v_perm_b32 v57, v59, v57, v14
    ds_write_b32 v7, v57 offset:0
    v_cmp_u_f32 vcc, v64, v66
    v_mov_b64 v[124:125], 0
    s_nop 2
    s_cbranch_vccnz chk_23
bk_24:
    s_waitcnt lgkmcnt(0)
    v_mov_b64 v[126:127], 0
    s_barrier
    ds_read_b128 v[16:19], v2 offset:53248
    ds_read_b128 v[20:23], v2 offset:54272
    ds_read_b128 v[24:27], v2 offset:55296
    v_mov_b64 v[128:129], 0
    s_nop 4
    v_mov_b64 v[130:131], 0
    s_waitcnt lgkmcnt(2)
    v_smfmac_f32_16x16x64_bf16 v[92:95], v[16:19], a[0:7], v4
    s_waitcnt lgkmcnt(1)
    v_smfmac_f32_16x16x64_bf16 v[92:95], v[20:23], a[8:15], v4
    s_waitcnt lgkmcnt(0)
    v_smfmac_f32_16x16x64_bf16 v[92:95], v[24:27], a[16:23], v4
    v_smfmac_f32_16x16x64_bf16 v[96:99], v[16:19], a[24:31], v4
    v_smfmac_f32_16x16x64_bf16 v[96:99], v[20:23], a[32:39], v4
    v_add_f32 v92, v92, v93
    v_smfmac_f32_16x16x64_bf16 v[96:99], v[24:27], a[40:47], v4
    v_add_f32 v94, v94, v95
    v_smfmac_f32_16x16x64_bf16 v[100:103], v[16:19], a[48:55], v4
    v_cvt_pk_bf16_f32 v28, v92, v94
    v_smfmac_f32_16x16x64_bf16 v[100:103], v[20:23], a[56:63], v4
    v_add_f32 v96, v96, v97
    v_smfmac_f32_16x16x64_bf16 v[100:103], v[24:27], a[64:71], v4
    v_add_f32 v98, v98, v99
    v_smfmac_f32_16x16x64_bf16 v[104:107], v[16:19], a[72:79], v4
    v_cvt_pk_bf16_f32 v29, v96, v98
    v_smfmac_f32_16x16x64_bf16 v[104:107], v[20:23], a[80:87], v4
    v_add_f32 v100, v100, v101
    v_smfmac_f32_16x16x64_bf16 v[104:107], v[24:27], a[88:95], v4
    v_permlane32_swap_b32 v28, v29
    v_smfmac_f32_16x16x64_bf16 v[108:111], v[16:19], a[96:103], v4
    v_add_f32 v102, v102, v103
    v_smfmac_f32_16x16x64_bf16 v[108:111], v[20:23], a[104:111], v4
    v_cvt_pk_bf16_f32 v30, v100, v102
    v_smfmac_f32_16x16x64_bf16 v[108:111], v[24:27], a[112:119], v4
    v_add_f32 v104, v104, v105
    v_smfmac_f32_16x16x64_bf16 v[112:115], v[16:19], a[120:127], v4
    v_add_f32 v106, v106, v107
    v_smfmac_f32_16x16x64_bf16 v[112:115], v[20:23], a[128:135], v4
    v_cvt_pk_bf16_f32 v31, v104, v106
    v_smfmac_f32_16x16x64_bf16 v[112:115], v[24:27], a[136:143], v4
    v_add_f32 v108, v108, v109
    v_smfmac_f32_16x16x64_bf16 v[116:119], v[16:19], a[144:151], v4
    v_permlane32_swap_b32 v30, v31
    v_smfmac_f32_16x16x64_bf16 v[116:119], v[20:23], a[152:159], v4
    v_add_f32 v110, v110, v111
    v_smfmac_f32_16x16x64_bf16 v[116:119], v[24:27], a[160:167], v4
    v_permlane16_swap_b32 v28, v30
    v_smfmac_f32_16x16x64_bf16 v[120:123], v[16:19], a[168:175], v4
    v_permlane16_swap_b32 v29, v31
    v_smfmac_f32_16x16x64_bf16 v[120:123], v[20:23], a[176:183], v4
    buffer_store_dwordx4 v[28:31], v9, s[4:7], s35 offen sc1
    v_smfmac_f32_16x16x64_bf16 v[120:123], v[24:27], a[184:191], v4
    v_cvt_pk_bf16_f32 v32, v108, v110
    v_smfmac_f32_16x16x64_bf16 v[124:127], v[16:19], a[192:199], v4
    v_add_f32 v112, v112, v113
    v_smfmac_f32_16x16x64_bf16 v[124:127], v[20:23], a[200:207], v4
    v_add_f32 v114, v114, v115
    v_smfmac_f32_16x16x64_bf16 v[124:127], v[24:27], a[208:215], v4
    v_cvt_pk_bf16_f32 v33, v112, v114
    v_smfmac_f32_16x16x64_bf16 v[128:131], v[16:19], a[216:223], v4
    v_add_f32 v116, v116, v117
    v_smfmac_f32_16x16x64_bf16 v[128:131], v[20:23], a[224:231], v4
    v_permlane32_swap_b32 v32, v33
    v_smfmac_f32_16x16x64_bf16 v[128:131], v[24:27], a[232:239], v4
    v_add_f32 v118, v118, v119
    v_cvt_pk_bf16_f32 v34, v116, v118
    v_add_f32 v120, v120, v121
    v_add_f32 v122, v122, v123
    v_cvt_pk_bf16_f32 v35, v120, v122
    v_add_f32 v124, v124, v125
    v_add_f32 v126, v126, v127
    v_permlane32_swap_b32 v34, v35
    v_cvt_pk_bf16_f32 v36, v124, v126
    v_add_f32 v128, v128, v129
    v_permlane16_swap_b32 v32, v34
    v_permlane16_swap_b32 v33, v35
    buffer_store_dwordx4 v[32:35], v10, s[4:7], s35 offen sc1
    v_add_f32 v130, v130, v131
    v_cvt_pk_bf16_f32 v37, v128, v130
    s_nop 0
    s_nop 0
    v_permlane32_swap_b32 v36, v37
    buffer_store_dwordx2 v[36:37], v11, s[4:7], s35 offen sc1
    s_cmp_lg_u32 s64, 0
    s_mov_b32 s64, 0
    s_cbranch_scc1 L_VF_E
L_VF_next:
    s_add_u32 s26, s26, 2
    s_cmp_lt_u32 s26, 64
    s_cbranch_scc1 L_VF_loop
    s_branch L_end
L_VF_skip:
    s_waitcnt lgkmcnt(0)
    s_cmp_eq_u32 s29, 0
    s_cbranch_scc1 ng_25
    s_cmp_lt_i32 s26, 2
    s_cbranch_scc1 ng_25
    s_add_u32 s40, s26, -2
    s_lshr_b32 s41, s40, 2
    s_xor_b32 s41, s41, s40
    s_xor_b32 s41, s41, s28
    s_and_b32 s41, s41, 1
    s_lshl_b32 s41, s41, 13
    s_lshr_b32 s40, s40, 1
    s_lshl_b32 s40, s40, 20
    s_or_b32 s42, s40, s41
    s_add_u32 s42, s42, s3
    s_add_u32 s42, s42, 1024
    buffer_load_dword v132, v12, s[4:7], s42 offen sc1
.p2align 6
poll_26:
    s_waitcnt vmcnt(0)
    v_cmp_eq_u32 vcc, -1, v132
    s_cbranch_vccz pd_27
    s_sleep 1
    buffer_load_dword v132, v12, s[4:7], s42 offen sc1
    s_add_u32 s27, s27, 1
    s_cmp_lt_u32 s27, 131072
    s_cbranch_scc1 poll_26
    s_branch L_abort
.p2align 6
pd_27:
ng_25:
    s_barrier
    s_branch L_VF_next
chk_23:
    s_cmp_lt_u32 s34, 2
    s_cbranch_scc1 slow_21
    v_mov_b32 v13, 0
    v_max3_u32 v13, v13, v16, v17
    v_max3_u32 v13, v13, v18, v19
    v_max3_u32 v13, v13, v20, v21
    v_max3_u32 v13, v13, v22, v23
    v_max3_u32 v13, v13, v24, v25
    v_max3_u32 v13, v13, v26, v27
    v_max3_u32 v13, v13, v28, v29
    v_max3_u32 v13, v13, v30, v31
    v_max3_u32 v13, v13, v32, v33
    v_max3_u32 v13, v13, v34, v35
    v_max3_u32 v13, v13, v36, v37
    v_max3_u32 v13, v13, v38, v39
    v_max3_u32 v13, v13, v40, v41
    v_max3_u32 v13, v13, v42, v43
    v_max3_u32 v13, v13, v44, v45
    v_max3_u32 v13, v13, v46, v47
    v_max3_u32 v13, v13, v48, v49
    v_max3_u32 v13, v13, v50, v51
    v_max3_u32 v13, v13, v52, v53
    v_max3_u32 v13, v13, v54, v55
    v_cmp_eq_u32 vcc, -1, v13
    s_cbranch_vccz bk_24
    s_add_u32 s27, s27, 1
    s_cmp_lt_u32 s27, 131072
    s_cbranch_scc1 go_28
    s_branch L_abort
go_28:
slow_21:
    s_add_u32 s34, s34, 1
    s_nop 7
    buffer_load_dwordx4 v[16:19], v2, s[4:7], s46 offen offset:0 sc1
    s_waitcnt lgkmcnt(0)
    ds_read_b128 v[68:71], v3 offset:0
    ds_read_b128 v[72:75], v3 offset:1024
    ds_read_b128 v[76:79], v3 offset:2048
    ds_read_b128 v[80:83], v3 offset:3072
    ds_read_b128 v[84:87], v3 offset:4096
    ds_read_b128 v[88:91], v3 offset:5120
    v_mov_b64 v[56:57], 0
    s_nop 1
    v_mov_b64 v[58:59], 0
    s_nop 2
    v_mov_b64 v[60:61], 0
    s_nop 1
    v_mov_b64 v[62:63], 0
    s_nop 2
    buffer_load_dwordx4 v[20:23], v2, s[4:7], s46 offen offset:1024 sc1
    v_mov_b64 v[64:65], 0
    s_nop 1
    v_mov_b64 v[66:67], 0
    s_nop 2
    v_mov_b64 v[92:93], 0
    s_nop 1
    v_mov_b64 v[94:95], 0
    s_nop 2
    buffer_load_dwordx4 v[24:27], v2, s[4:7], s47 offen offset:0 sc1
    v_mov_b64 v[96:97], 0
    s_nop 1
    v_mov_b64 v[98:99], 0
    s_nop 2
    v_mov_b64 v[100:101], 0
    s_nop 1
    v_mov_b64 v[102:103], 0
    s_nop 2
    buffer_load_dwordx4 v[28:31], v2, s[4:7], s47 offen offset:1024 sc1
    v_mov_b64 v[104:105], 0
    s_nop 1
    v_mov_b64 v[106:107], 0
    s_nop 2
    v_mov_b64 v[108:109], 0
    s_nop 1
    v_mov_b64 v[110:111], 0
    s_nop 2
    buffer_load_dwordx4 v[32:35], v2, s[4:7], s48 offen offset:0 sc1
    v_mov_b64 v[112:113], 0
    s_nop 1
    v_mov_b64 v[114:115], 0
    s_nop 2
    v_mov_b64 v[116:117], 0
    s_nop 1
    v_mov_b64 v[118:119], 0
    s_nop 2
    buffer_load_dwordx4 v[36:39], v2, s[4:7], s48 offen offset:1024 sc1
    v_mov_b64 v[120:121], 0
    s_nop 5
    v_mov_b64 v[122:123], 0
    s_nop 5
    buffer_load_dwordx4 v[40:43], v2, s[4:7], s58 offen offset:0 sc1
    s_waitcnt vmcnt(6)
    s_waitcnt lgkmcnt(4)
    v_smfmac_f32_16x16x64_bf16 v[64:67], v[16:19], v[68:75], v4
    ds_read_b128 v[68:71], v3 offset:20480
    v_smfmac_f32_16x16x64_bf16 v[60:63], v[16:19], v[200:207], v4
    ds_read_b128 v[72:75], v3 offset:21504
    v_smfmac_f32_16x16x64_bf16 v[56:59], v[16:19], a[240:247], v4
    buffer_load_dwordx4 v[44:47], v2, s[4:7], s58 offen offset:1024 sc1
    s_waitcnt vmcnt(6)
    s_waitcnt lgkmcnt(4)
    v_smfmac_f32_16x16x64_bf16 v[64:67], v[20:23], v[76:83], v4
    ds_read_b128 v[76:79], v3 offset:6144
    v_smfmac_f32_16x16x64_bf16 v[60:63], v[20:23], v[208:215], v4
    ds_read_b128 v[80:83], v3 offset:7168
    v_smfmac_f32_16x16x64_bf16 v[56:59], v[20:23], a[248:255], v4
    buffer_load_dwordx4 v[48:51], v2, s[4:7], s59 offen offset:0 sc1
    s_waitcnt vmcnt(6)
    s_waitcnt lgkmcnt(4)
    v_smfmac_f32_16x16x64_bf16 v[64:67], v[24:27], v[84:91], v4
    ds_read_b128 v[84:87], v3 offset:8192
    s_waitcnt lgkmcnt(3)
    v_smfmac_f32_16x16x64_bf16 v[60:63], v[24:27], v[68:75], v4
    ds_read_b128 v[88:91], v3 offset:9216
    v_smfmac_f32_16x16x64_bf16 v[56:59], v[24:27], v[136:143], v4
    ds_read_b128 v[68:71], v3 offset:10240
    ds_read_b128 v[72:75], v3 offset:11264
    buffer_load_dwordx4 v[52:55], v2, s[4:7], s59 offen offset:1024 sc1
    s_waitcnt vmcnt(6)
    s_waitcnt lgkmcnt(4)
    v_smfmac_f32_16x16x64_bf16 v[64:67], v[28:31], v[76:83], v4
    ds_read_b128 v[76:79], v3 offset:22528
    v_smfmac_f32_16x16x64_bf16 v[60:63], v[28:31], v[216:223], v4
    ds_read_b128 v[80:83], v3 offset:23552
    v_smfmac_f32_16x16x64_bf16 v[56:59], v[28:31], v[144:151], v4
    s_waitcnt vmcnt(5)
    s_waitcnt lgkmcnt(4)
    v_smfmac_f32_16x16x64_bf16 v[64:67], v[32:35], v[84:91], v4
    ds_read_b128 v[84:87], v3 offset:12288
    v_smfmac_f32_16x16x64_bf16 v[60:63], v[32:35], v[224:231], v4
    ds_read_b128 v[88:91], v3 offset:13312
    v_smfmac_f32_16x16x64_bf16 v[56:59], v[32:35], v[152:159], v4
    s_waitcnt vmcnt(4)
    s_waitcnt lgkmcnt(4)
    v_smfmac_f32_16x16x64_bf16 v[64:67], v[36:39], v[68:75], v4
    ds_read_b128 v[68:71], v3 offset:14336
    s_waitcnt lgkmcnt(3)
    v_smfmac_f32_16x16x64_bf16 v[60:63], v[36:39], v[76:83], v4
    ds_read_b128 v[72:75], v3 offset:15360
    v_smfmac_f32_16x16x64_bf16 v[56:59], v[36:39], v[160:167], v4
    ds_read_b128 v[76:79], v3 offset:16384
    ds_read_b128 v[80:83], v3 offset:17408
    s_waitcnt vmcnt(3)
    s_waitcnt lgkmcnt(4)
    v_smfmac_f32_16x16x64_bf16 v[64:67], v[40:43], v[84:91], v4
    ds_read_b128 v[84:87], v3 offset:24576
    v_smfmac_f32_16x16x64_bf16 v[60:63], v[40:43], v[232:239], v4
    ds_read_b128 v[88:91], v3 offset:25600
    v_smfmac_f32_16x16x64_bf16 v[56:59], v[40:43], v[168:175], v4
    s_waitcnt vmcnt(2)
    s_waitcnt lgkmcnt(4)
    v_smfmac_f32_16x16x64_bf16 v[64:67], v[44:47], v[68:75], v4
    ds_read_b128 v[68:71], v3 offset:18432
    v_smfmac_f32_16x16x64_bf16 v[60:63], v[44:47], v[240:247], v4
    ds_read_b128 v[72:75], v3 offset:19456
    v_smfmac_f32_16x16x64_bf16 v[56:59], v[44:47], v[176:183], v4
    s_waitcnt vmcnt(1)
    s_waitcnt lgkmcnt(4)
    v_smfmac_f32_16x16x64_bf16 v[64:67], v[48:51], v[76:83], v4
    s_waitcnt lgkmcnt(2)
    v_smfmac_f32_16x16x64_bf16 v[60:63], v[48:51], v[84:91], v4
    v_smfmac_f32_16x16x64_bf16 v[56:59], v[48:51], v[184:191], v4
    s_waitcnt vmcnt(0)
    s_waitcnt lgkmcnt(0)
    v_smfmac_f32_16x16x64_bf16 v[64:67], v[52:55], v[68:75], v4
    v_smfmac_f32_16x16x64_bf16 v[60:63], v[52:55], v[248:255], v4
    v_smfmac_f32_16x16x64_bf16 v[56:59], v[52:55], v[192:199], v4
    s_nop 7
    s_branch ok_22
L_silu:
    s_nop 7
    v_cvt_pk_bf16_f32 v16, v92, v93
    v_lshlrev_b32 v92, 16, v16
    v_and_b32 v93, 0xffff0000, v16
    v_mul_f32 v16, 3216550459, v92
    v_mul_f32 v17, 3216550459, v93
    v_exp_f32 v16, v16
    v_exp_f32 v17, v17
    v_add_f32 v16, 1.0, v16
    v_add_f32 v17, 1.0, v17
    v_rcp_f32 v16, v16
    v_rcp_f32 v17, v17
    v_mul_f32 v92, v92, v16
    v_mul_f32 v93, v93, v17
    v_cvt_pk_bf16_f32 v16, v94, v95
    v_lshlrev_b32 v94, 16, v16
    v_and_b32 v95, 0xffff0000, v16
    v_mul_f32 v16, 3216550459, v94
    v_mul_f32 v17, 3216550459, v95
    v_exp_f32 v16, v16
    v_exp_f32 v17, v17
    v_add_f32 v16, 1.0, v16
    v_add_f32 v17, 1.0, v17
    v_rcp_f32 v16, v16
    v_rcp_f32 v17, v17
    v_mul_f32 v94, v94, v16
    v_mul_f32 v95, v95, v17
    v_cvt_pk_bf16_f32 v16, v96, v97
    v_lshlrev_b32 v96, 16, v16
    v_and_b32 v97, 0xffff0000, v16
    v_mul_f32 v16, 3216550459, v96
    v_mul_f32 v17, 3216550459, v97
    v_exp_f32 v16, v16
    v_exp_f32 v17, v17
    v_add_f32 v16, 1.0, v16
    v_add_f32 v17, 1.0, v17
    v_rcp_f32 v16, v16
    v_rcp_f32 v17, v17
    v_mul_f32 v96, v96, v16
    v_mul_f32 v97, v97, v17
    v_cvt_pk_bf16_f32 v16, v98, v99
    v_lshlrev_b32 v98, 16, v16
    v_and_b32 v99, 0xffff0000, v16
    v_mul_f32 v16, 3216550459, v98
    v_mul_f32 v17, 3216550459, v99
    v_exp_f32 v16, v16
    v_exp_f32 v17, v17
    v_add_f32 v16, 1.0, v16
    v_add_f32 v17, 1.0, v17
    v_rcp_f32 v16, v16
    v_rcp_f32 v17, v17
    v_mul_f32 v98, v98, v16
    v_mul_f32 v99, v99, v17
    v_cvt_pk_bf16_f32 v16, v100, v101
    v_lshlrev_b32 v100, 16, v16
    v_and_b32 v101, 0xffff0000, v16
    v_mul_f32 v16, 3216550459, v100
    v_mul_f32 v17, 3216550459, v101
    v_exp_f32 v16, v16
    v_exp_f32 v17, v17
    v_add_f32 v16, 1.0, v16
    v_add_f32 v17, 1.0, v17
    v_rcp_f32 v16, v16
    v_rcp_f32 v17, v17
    v_mul_f32 v100, v100, v16
    v_mul_f32 v101, v101, v17
    v_cvt_pk_bf16_f32 v16, v102, v103
    v_lshlrev_b32 v102, 16, v16
    v_and_b32 v103, 0xffff0000, v16
    v_mul_f32 v16, 3216550459, v102
    v_mul_f32 v17, 3216550459, v103
    v_exp_f32 v16, v16
    v_exp_f32 v17, v17
    v_add_f32 v16, 1.0, v16
    v_add_f32 v17, 1.0, v17
    v_rcp_f32 v16, v16
    v_rcp_f32 v17, v17
    v_mul_f32 v102, v102, v16
    v_mul_f32 v103, v103, v17
    v_cvt_pk_bf16_f32 v16, v104, v105
    v_lshlrev_b32 v104, 16, v16
    v_and_b32 v105, 0xffff0000, v16
    v_mul_f32 v16, 3216550459, v104
    v_mul_f32 v17, 3216550459, v105
    v_exp_f32 v16, v16
    v_exp_f32 v17, v17
    v_add_f32 v16, 1.0, v16
    v_add_f32 v17, 1.0, v17
    v_rcp_f32 v16, v16
    v_rcp_f32 v17, v17
    v_mul_f32 v104, v104, v16
    v_mul_f32 v105, v105, v17
    v_cvt_pk_bf16_f32 v16, v106, v107
    v_lshlrev_b32 v106, 16, v16
    v_and_b32 v107, 0xffff0000, v16
    v_mul_f32 v16, 3216550459, v106
    v_mul_f32 v17, 3216550459, v107
    v_exp_f32 v16, v16
    v_exp_f32 v17, v17
    v_add_f32 v16, 1.0, v16
    v_add_f32 v17, 1.0, v17
    v_rcp_f32 v16, v16
    v_rcp_f32 v17, v17
    v_mul_f32 v106, v106, v16
    v_mul_f32 v107, v107, v17
    v_cvt_pk_bf16_f32 v16, v108, v109
    v_lshlrev_b32 v108, 16, v16
    v_and_b32 v109, 0xffff0000, v16
    v_mul_f32 v16, 3216550459, v108
    v_mul_f32 v17, 3216550459, v109
    v_exp_f32 v16, v16
    v_exp_f32 v17, v17
    v_add_f32 v16, 1.0, v16
    v_add_f32 v17, 1.0, v17
    v_rcp_f32 v16, v16
    v_rcp_f32 v17, v17
    v_mul_f32 v108, v108, v16
    v_mul_f32 v109, v109, v17
    v_cvt_pk_bf16_f32 v16, v110, v111
    v_lshlrev_b32 v110, 16, v16
    v_and_b32 v111, 0xffff0000, v16
    v_mul_f32 v16, 3216550459, v110
    v_mul_f32 v17, 3216550459, v111
    v_exp_f32 v16, v16
    v_exp_f32 v17, v17
    v_add_f32 v16, 1.0, v16
    v_add_f32 v17, 1.0, v17
    v_rcp_f32 v16, v16
    v_rcp_f32 v17, v17
    v_mul_f32 v110, v110, v16
    v_mul_f32 v111, v111, v17
    v_cvt_pk_bf16_f32 v16, v112, v113
    v_lshlrev_b32 v112, 16, v16
    v_and_b32 v113, 0xffff0000, v16
    v_mul_f32 v16, 3216550459, v112
    v_mul_f32 v17, 3216550459, v113
    v_exp_f32 v16, v16
    v_exp_f32 v17, v17
    v_add_f32 v16, 1.0, v16
    v_add_f32 v17, 1.0, v17
    v_rcp_f32 v16, v16
    v_rcp_f32 v17, v17
    v_mul_f32 v112, v112, v16
    v_mul_f32 v113, v113, v17
    v_cvt_pk_bf16_f32 v16, v114, v115
    v_lshlrev_b32 v114, 16, v16
    v_and_b32 v115, 0xffff0000, v16
    v_mul_f32 v16, 3216550459, v114
    v_mul_f32 v17, 3216550459, v115
    v_exp_f32 v16, v16
    v_exp_f32 v17, v17
    v_add_f32 v16, 1.0, v16
    v_add_f32 v17, 1.0, v17
    v_rcp_f32 v16, v16
    v_rcp_f32 v17, v17
    v_mul_f32 v114, v114, v16
    v_mul_f32 v115, v115, v17
    s_branch nsilu_18
L_VF_lite:
    s_nop 7
    v_cvt_pk_bf16_f32 v36, v24, v25
    v_cvt_pk_bf16_f32 v38, v26, v27
    v_cvt_pk_bf16_f32 v37, v28, v29
    v_cvt_pk_bf16_f32 v39, v30, v31
    s_add_u32 s43, s43, 81920
    s_mov_b64 exec, s[60:61]
    buffer_store_dwordx4 v[36:39], v2, s[4:7], s43 offen sc1
    s_mov_b64 exec, -1
    s_add_u32 s40, s26, 0
    s_lshr_b32 s41, s40, 2
    s_xor_b32 s41, s41, s40
    s_xor_b32 s41, s41, s28
    s_and_b32 s41, s41, 1
    s_lshl_b32 s41, s41, 13
    s_lshr_b32 s40, s40, 1
    s_lshl_b32 s40, s40, 20
    s_or_b32 s35, s40, s41
    s_and_b32 s59, s3, 0x4000
    s_add_u32 s59, s59, s35
    s_add_u32 s40, s36, 0
    s_cmp_ge_u32 s40, 5
    s_cselect_b32 s41, 5, 0
    s_sub_u32 s40, s40, s41
    s_lshl_b32 s40, s40, 15
    s_add_u32 s46, s59, s40
    s_add_u32 s40, s36, 1
    s_cmp_ge_u32 s40, 5
    s_cselect_b32 s41, 5, 0
    s_sub_u32 s40, s40, s41
    s_lshl_b32 s40, s40, 15
    s_add_u32 s47, s59, s40
    s_add_u32 s40, s36, 2
    s_cmp_ge_u32 s40, 5
    s_cselect_b32 s41, 5, 0
    s_sub_u32 s40, s40, s41
    s_lshl_b32 s40, s40, 15
    s_add_u32 s48, s59, s40
    s_add_u32 s40, s36, 3
    s_cmp_ge_u32 s40, 5
    s_cselect_b32 s41, 5, 0
    s_sub_u32 s40, s40, s41
    s_lshl_b32 s40, s40, 15
    s_add_u32 s58, s59, s40
    s_add_u32 s40, s36, 4
    s_cmp_ge_u32 s40, 5
    s_cselect_b32 s41, 5, 0
    s_sub_u32 s40, s40, s41
    s_lshl_b32 s40, s40, 15
    s_add_u32 s59, s59, s40
    s_add_u32 s50, s35, s3
    s_mov_b32 s34, 0
    s_waitcnt vmcnt(0)
    s_barrier
    s_mov_b64 exec, s[56:57]
    buffer_store_dword v12, v12, s[4:7], s52 offen sc1
    s_mov_b64 exec, -1
    buffer_load_dword v132, v12, s[4:7], s50 offen sc1
    buffer_load_dword v133, v12, s[4:7], s50 offen sc1
    buffer_load_dword v134, v12, s[4:7], s50 offen sc1
    s_waitcnt lgkmcnt(0)
    s_branch L_VF_C
L_R:
    s_cmp_lg_u32 s23, 0
    s_cbranch_scc1 L_PF
    s_load_dwordx2 s[64:65], s[0:1], 80
    s_mov_b32 s66, 2621440
    s_mov_b32 s67, 0x20000
    s_mul_i32 s25, s20, 10
    s_add_u32 s25, s25, s21
    s_sub_u32 s25, s25, 16
    s_cmp_eq_u32 s21, 16
    s_cselect_b32 s54, 0x10001, 0
    s_lshl_b32 s32, s20, 8
    s_add_u32 s32, s32, 327680
    s_cmp_ge_u32 s25, 20
    s_cselect_b32 s56, 1, 0
    s_mul_i32 s40, s56, 20
    s_sub_u32 s40, s25, s40
    s_mul_i32 s55, s40, 81920
    s_lshl_b32 s40, s56, 21
    s_add_u32 s55, s55, s40
    s_lshl_b32 s56, s56, 13
    v_lshlrev_b32 v2, 4, v1
    v_and_b32 v20, 15, v1
    v_lshrrev_b32 v21, 4, v1
    v_and_b32 v4, 1, v1
    v_mul_u32_u24 v4, 0xaaaa, v4
    v_add_u32 v4, 0x4444, v4
    v_and_b32 v10, 7, v1
    v_lshlrev_b32 v10, 4, v10
    v_lshl_add_u32 v10, v21, 7, v10
    v_bfe_u32 v11, v1, 3, 1
    v_lshl_add_u32 v5, v11, 3, v10
    v_and_b32 v11, 1, v20
    v_lshl_add_u32 v10, v21, 1, v11
    v_mov_b32 v7, 0x05040100
    v_mov_b32 v22, 0x03020706
    v_cmp_eq_u32 vcc, 1, v11
    s_nop 1
    v_cndmask_b32 v7, v7, v22, vcc
    v_mul_u32_u24 v23, 1280, v10
    v_and_b32 v11, 14, v20
    v_lshl_add_u32 v23, v11, 1, v23
    s_lshl_b32 s40, s25, 5
    v_add_u32 v23, s40, v23
    v_bfe_u32 v11, v20, 1, 1
    v_lshl_add_u32 v10, v10, 1, v11
    v_lshlrev_b32 v10, 4, v10
    v_lshrrev_b32 v11, 2, v20
    v_lshl_add_u32 v10, v11, 2, v10
    s_lshr_b32 s42, s25, 3
    s_lshl_b32 s42, s42, 15
    s_and_b32 s41, s25, 7
    s_lshl_b32 s41, s41, 8
    s_add_u32 s41, s41, s42
    v_add_u32 v6, s41, v10
    v_mul_u32_u24 v8, 1280, v20
    v_lshl_add_u32 v8, v21, 3, v8
    v_add_u32 v8, s40, v8
    v_and_b32 v9, 31, v1
    v_lshlrev_b32 v9, 7, v9
    v_and_b32 v0, 7, v1
    v_lshlrev_b32 v0, 7, v0
    v_lshlrev_b32 v3, 8, v1
    v_mov_b32 v12, 0
    v_mov_b32 v14, -1
    v_lshlrev_b32 v13, 2, v21
    v_sub_u32 v13, v20, v13
    v_mov_b32 v24, 0x3f80
    v_mov_b32 v25, 0x3f800000
    s_waitcnt lgkmcnt(0)
    s_mov_b32 s8, s12
    s_mov_b32 s9, s13
    s_mov_b32 s10, 2621440
    s_mov_b32 s11, 0x20000
    s_mov_b32 s12, s14
    s_mov_b32 s13, s15
    s_mov_b32 s14, 10240
    s_mov_b32 s15, 0x20000
    s_add_u32 s4, s4, 0x3fffff
    s_addc_u32 s5, s5, 0
    s_and_b32 s4, s4, 0xffc00000
    buffer_load_dword v15, v23, s[12:15], 0 offen
    v_cmp_eq_u32 vcc, 0, v13
    s_nop 1
    v_cndmask_b32 v16, 0, v24, vcc
    v_cmp_eq_u32 vcc, 1, v13
    s_nop 1
    v_cndmask_b32 v16, v16, v25, vcc
    v_cmp_eq_u32 vcc, 2, v13
    s_nop 1
    v_cndmask_b32 v18, 0, v24, vcc
    v_cmp_eq_u32 vcc, 3, v13
    s_nop 1
    v_cndmask_b32 v18, v18, v25, vcc
    v_mov_b32 v17, 0
    v_mov_b32 v19, 0
    v_mov_b32 v20, 0
    v_mov_b32 v21, v16
    v_mov_b32 v22, 0
    v_mov_b32 v23, v18
    s_add_u32 s58, s20, 0
    s_and_b32 s58, s58, 3
    s_add_u32 s59, s20, 1
    s_and_b32 s59, s59, 3
    s_add_u32 s60, s20, 2
    s_and_b32 s60, s60, 3
    s_add_u32 s61, s20, 3
    s_and_b32 s61, s61, 3
    v_mov_b32 v24, -1
    v_mov_b32 v25, -1
    v_mov_b32 v26, -1
    v_mov_b32 v27, -1
    s_mul_i32 s42, s22, 40
    s_add_u32 s42, s42, s25
    s_cmp_ge_u32 s42, 64
    s_cbranch_scc1 ncl_31
    s_lshr_b32 s40, s42, 1
    s_and_b32 s41, s42, 1
    s_lshl_b32 s41, s41, 13
    s_lshl_b32 s43, s40, 20
    s_add_u32 s43, s43, s41
    s_add_u32 s43, s43, 327680
    buffer_store_dwordx4 v[24:27], v2, s[4:7], s43 offen offset:0 sc1
    buffer_store_dwordx4 v[24:27], v2, s[4:7], s43 offen offset:1024 sc1
    buffer_store_dwordx4 v[24:27], v2, s[4:7], s43 offen offset:2048 sc1
    s_add_u32 s43, s43, 16384
    buffer_store_dwordx4 v[24:27], v2, s[4:7], s43 offen offset:0 sc1
    buffer_store_dwordx4 v[24:27], v2, s[4:7], s43 offen offset:1024 sc1
    buffer_store_dwordx4 v[24:27], v2, s[4:7], s43 offen offset:2048 sc1
    s_lshl_b32 s43, s40, 22
    s_add_u32 s43, s43, s41
    s_add_u32 s43, s43, 39550976
    buffer_store_dwordx4 v[24:27], v2, s[4:7], s43 offen offset:0 sc1
    buffer_store_dwordx4 v[24:27], v2, s[4:7], s43 offen offset:1024 sc1
    buffer_store_dwordx4 v[24:27], v2, s[4:7], s43 offen offset:2048 sc1
    buffer_store_dwordx4 v[24:27], v2, s[4:7], s43 offen offset:3072 sc1
    s_add_u32 s43, s43, 4096
    buffer_store_dwordx4 v[24:27], v2, s[4:7], s43 offen sc1
    s_sub_u32 s43, s42, 20
    s_cmp_lt_u32 s43, 4
    s_cbranch_scc1 ncl_31
    s_lshl_b32 s43, s42, 14
    buffer_store_dwordx4 v[24:27], v2, s[4:7], s43 offen offset:0 sc1
    buffer_store_dwordx4 v[24:27], v2, s[4:7], s43 offen offset:1024 sc1
    buffer_store_dwordx4 v[24:27], v2, s[4:7], s43 offen offset:2048 sc1
    buffer_store_dwordx4 v[24:27], v2, s[4:7], s43 offen offset:3072 sc1
    s_add_u32 s43, s43, 4096
    buffer_store_dwordx4 v[24:27], v2, s[4:7], s43 offen offset:0 sc1
    buffer_store_dwordx4 v[24:27], v2, s[4:7], s43 offen offset:1024 sc1
    buffer_store_dwordx4 v[24:27], v2, s[4:7], s43 offen offset:2048 sc1
    buffer_store_dwordx4 v[24:27], v2, s[4:7], s43 offen offset:3072 sc1
    s_add_u32 s43, s43, 4096
    buffer_store_dwordx4 v[24:27], v2, s[4:7], s43 offen offset:0 sc1
    buffer_store_dwordx4 v[24:27], v2, s[4:7], s43 offen offset:1024 sc1
    buffer_store_dwordx4 v[24:27], v2, s[4:7], s43 offen offset:2048 sc1
    buffer_store_dwordx4 v[24:27], v2, s[4:7], s43 offen offset:3072 sc1
    s_add_u32 s43, s43, 4096
    buffer_store_dwordx4 v[24:27], v2, s[4:7], s43 offen offset:0 sc1
    buffer_store_dwordx4 v[24:27], v2, s[4:7], s43 offen offset:1024 sc1
    buffer_store_dwordx4 v[24:27], v2, s[4:7], s43 offen offset:2048 sc1
    buffer_store_dwordx4 v[24:27], v2, s[4:7], s43 offen offset:3072 sc1
    s_add_u32 s43, s43, 1036288
    buffer_store_dwordx4 v[24:27], v2, s[4:7], s43 offen offset:0 sc1
    buffer_store_dwordx4 v[24:27], v2, s[4:7], s43 offen offset:1024 sc1
    buffer_store_dwordx4 v[24:27], v2, s[4:7], s43 offen offset:2048 sc1
    buffer_store_dwordx4 v[24:27], v2, s[4:7], s43 offen offset:3072 sc1
    s_add_u32 s43, s43, 4096
    buffer_store_dwordx4 v[24:27], v2, s[4:7], s43 offen offset:0 sc1
    buffer_store_dwordx4 v[24:27], v2, s[4:7], s43 offen offset:1024 sc1
    buffer_store_dwordx4 v[24:27], v2, s[4:7], s43 offen offset:2048 sc1
    buffer_store_dwordx4 v[24:27], v2, s[4:7], s43 offen offset:3072 sc1
    s_add_u32 s43, s43, 4096
    buffer_store_dwordx4 v[24:27], v2, s[4:7], s43 offen offset:0 sc1
    buffer_store_dwordx4 v[24:27], v2, s[4:7], s43 offen offset:1024 sc1
    buffer_store_dwordx4 v[24:27], v2, s[4:7], s43 offen offset:2048 sc1
    buffer_store_dwordx4 v[24:27], v2, s[4:7], s43 offen offset:3072 sc1
    s_add_u32 s43, s43, 4096
    buffer_store_dwordx4 v[24:27], v2, s[4:7], s43 offen offset:0 sc1
    buffer_store_dwordx4 v[24:27], v2, s[4:7], s43 offen offset:1024 sc1
    buffer_store_dwordx4 v[24:27], v2, s[4:7], s43 offen offset:2048 sc1
    buffer_store_dwordx4 v[24:27], v2, s[4:7], s43 offen offset:3072 sc1
    s_add_u32 s43, s43, 4096
ncl_31:
    s_lshl_b32 s43, s22, 22
    s_lshl_b32 s41, s25, 12
    s_add_u32 s43, s43, s41
    s_add_u32 s43, s43, 39387136
    buffer_store_dwordx4 v[24:27], v2, s[4:7], s43 offen offset:0 sc1
    buffer_store_dwordx4 v[24:27], v2, s[4:7], s43 offen offset:1024 sc1
    buffer_store_dwordx4 v[24:27], v2, s[4:7], s43 offen offset:2048 sc1
    buffer_store_dwordx4 v[24:27], v2, s[4:7], s43 offen offset:3072 sc1
    s_mov_b32 s45, 1
    s_cmp_lg_u32 s21, 25
    s_cbranch_scc1 nl_29
    s_barrier
    v_lshlrev_b32 v30, 2, v1
    ds_read_b32 v31, v30 offset:16
    ds_read_b32 v32, v30 offset:32
    ds_read_b32 v33, v30 offset:48
    s_waitcnt lgkmcnt(0)
    v_min3_u32 v31, v31, v32, v33
    s_nop 0
    v_readlane_b32 s46, v31, 0
    v_readlane_b32 s47, v31, 1
    v_readlane_b32 s48, v31, 2
    v_readlane_b32 s49, v31, 3
    s_min_u32 s40, s46, s48
    s_min_u32 s41, s47, s49
    s_cmp_lt_u32 s41, s40
    s_cselect_b32 s45, 1, 0
    s_cselect_b32 s46, s47, s46
    s_cselect_b32 s48, s49, s48
    s_xor_b32 s45, s45, s22
    s_lshl_b32 s45, s45, 16
    s_or_b32 s45, s45, 1
    s_cmp_lt_u32 s48, s46
    s_cselect_b32 s46, 1, 0
    s_xor_b32 s46, s46, s20
    s_and_b32 s46, s46, 1
    s_lshl_b32 s46, s46, 24
    s_or_b32 s45, s45, s46
nl_29:
    s_waitcnt vmcnt(0)
    s_sub_u32 s40, s2, s26
    s_and_b32 s42, s40, 1
    s_bfe_u32 s41, s40, 0x10001
    s_lshl_b32 s41, s41, 9
    s_or_b32 s42, s42, s41
    s_bfe_u32 s41, s40, 0x10002
    s_lshl_b32 s41, s41, 18
    s_or_b32 s42, s42, s41
    s_add_u32 s43, s45, 128
    v_mov_b32 v32, 0
    v_mov_b32 v30, s43
    v_mov_b32 v31, s42
    s_mov_b64 exec, 1
    buffer_atomic_add_x2 v[30:31], v32, s[16:19], s28 offen sc0 sc1
    s_waitcnt vmcnt(0)
    v_readfirstlane_b32 s40, v30
    v_readfirstlane_b32 s41, v31
    s_add_u32 s40, s40, s43
    s_add_u32 s41, s41, s42
    s_and_b32 s42, s40, 127
    s_cmp_lg_u32 s42, 112
    s_cbranch_scc1 nla_32
    s_branch allc_35
all_33:
    buffer_load_dwordx2 v[30:31], v32, s[16:19], s28 offen sc1
    s_waitcnt vmcnt(0)
    v_readfirstlane_b32 s40, v30
    v_readfirstlane_b32 s41, v31
allc_35:
    s_bfe_u32 s42, s40, 0x90007
    s_cmp_eq_u32 s42, 256
    s_cbranch_scc1 alld_34
    s_sleep 8
    s_add_u32 s27, s27, 1
    s_cmp_lt_u32 s27, 131072
    s_cbranch_scc1 all_33
    s_branch L_abort
alld_34:
    s_and_b32 s41, s41, 66977535
    s_cselect_b32 s41, 0x80000000, 0
    s_or_b32 s40, s40, s41
    v_mov_b32 v30, s40
    buffer_store_dword v30, v32, s[16:19], s28 offen offset:128 sc1
nla_32:
    s_mov_b64 exec, -1
ws_36:
    v_mov_b32 v30, 0
    buffer_load_dword v31, v30, s[16:19], s28 offen offset:128 sc1
    s_waitcnt vmcnt(0)
wsc_38:
    v_readfirstlane_b32 s40, v31
    s_nop 0
    s_cmp_lt_i32 s40, 0
    s_cbranch_scc1 L_restart
    s_cmp_lg_u32 s40, 0
    s_cbranch_scc1 wsd_37
    s_sleep 4
    s_add_u32 s27, s27, 1
    s_cmp_lt_u32 s27, 131072
    s_cbranch_scc1 ws_36
    s_branch L_abort
wsd_37:
    s_bfe_u32 s41, s40, 0x40010
    s_cmp_ge_u32 s41, 5
    s_cselect_b32 s28, 1, 0
    s_bfe_u32 s41, s40, 0x40018
    s_cmp_ge_u32 s41, 5
    s_cselect_b32 s41, 1, 0
    s_xor_b32 s3, s20, s41
    s_and_b32 s3, s3, 1
    s_lshl_b32 s3, s3, 14
    s_lshl_b32 s40, s23, 8
    s_add_u32 s3, s3, s40
    s_lshr_b32 s40, s20, 1
    s_lshl_b32 s40, s40, 7
    s_add_u32 s3, s3, s40
    s_add_u32 s3, s3, 327680
    v_bfe_u32 v3, v1, 4, 1
    v_xor_b32 v3, s41, v3
    v_lshlrev_b32 v3, 14, v3
    v_lshrrev_b32 v30, 5, v1
    v_lshl_add_u32 v3, v30, 7, v3
    s_lshr_b32 s40, s20, 1
    s_mul_i32 s40, s40, 10
    s_add_u32 s40, s40, s21
    s_add_u32 s40, s40, -4
    s_lshl_b32 s50, s40, 15
    s_lshr_b32 s40, s40, 4
    s_lshl_b32 s40, s40, 14
    s_xor_b32 s40, s40, s3
    s_and_b32 s40, s40, 0x4000
    s_or_b32 s50, s50, s40
    v_add_u32 v11, 16384, v6
    v_add_u32 v5, 4096, v2
    v_add_u32 v9, 81920, v2
    v_add_u32 v10, 86016, v2
    s_cmp_eq_u32 s22, 0
    s_cbranch_scc1 nc_30
    s_mov_b32 s26, 0
    v_min_u32 v15, -2, v15
    s_add_u32 s40, s26, 0
    s_lshr_b32 s41, s40, 2
    s_xor_b32 s41, s41, s40
    s_xor_b32 s41, s41, s28
    s_and_b32 s41, s41, 1
    s_lshl_b32 s41, s41, 13
    s_lshr_b32 s40, s40, 1
    s_lshl_b32 s40, s40, 20
    s_or_b32 s36, s40, s41
    buffer_store_dword v15, v6, s[4:7], s36 offen sc1
    buffer_store_dword v15, v11, s[4:7], s36 offen sc1
    s_waitcnt vmcnt(0)
    s_add_u32 s40, s36, s32
    s_mov_b32 exec_lo, s54
    s_mov_b32 exec_hi, s54
    buffer_store_dword v12, v3, s[4:7], s40 offen sc1
    s_mov_b64 exec, -1
nc_30:
    s_mov_b32 s26, s22
.p2align 6
L_R_loop:
    s_add_u32 s40, s26, 0
    s_xor_b32 s41, s40, s28
    s_and_b32 s41, s41, 1
    s_lshl_b32 s41, s41, 13
    s_lshr_b32 s40, s40, 1
    s_lshl_b32 s40, s40, 22
    s_add_u32 s40, s40, 37748736
    s_or_b32 s37, s40, s41
    s_xor_b32 s38, s37, s56
    s_add_u32 s38, s38, s55
    s_barrier
    s_lshl_b32 s40, s58, 14
    s_add_u32 s40, s40, s38
    buffer_load_dwordx4 a[0:3], v2, s[4:7], s40 offen offset:0 sc1
    buffer_load_dwordx4 a[4:7], v2, s[4:7], s40 offen offset:1024 sc1
    buffer_load_dwordx4 a[8:11], v2, s[4:7], s40 offen offset:2048 sc1
    buffer_load_dwordx4 a[12:15], v2, s[4:7], s40 offen offset:3072 sc1
    s_add_u32 s40, s40, 4096
    buffer_load_dwordx4 a[16:19], v2, s[4:7], s40 offen offset:0 sc1
    buffer_load_dwordx4 a[20:23], v2, s[4:7], s40 offen offset:1024 sc1
    buffer_load_dwordx4 a[24:27], v2, s[4:7], s40 offen offset:2048 sc1
    buffer_load_dwordx4 a[28:31], v2, s[4:7], s40 offen offset:3072 sc1
    s_lshl_b32 s40, s59, 14
    s_add_u32 s40, s40, s38
    buffer_load_dwordx4 a[32:35], v2, s[4:7], s40 offen offset:0 sc1
    buffer_load_dwordx4 a[36:39], v2, s[4:7], s40 offen offset:1024 sc1
    buffer_load_dwordx4 a[40:43], v2, s[4:7], s40 offen offset:2048 sc1
    buffer_load_dwordx4 a[44:47], v2, s[4:7], s40 offen offset:3072 sc1
    s_add_u32 s40, s40, 4096
    buffer_load_dwordx4 a[48:51], v2, s[4:7], s40 offen offset:0 sc1
    buffer_load_dwordx4 a[52:55], v2, s[4:7], s40 offen offset:1024 sc1
    buffer_load_dwordx4 a[56:59], v2, s[4:7], s40 offen offset:2048 sc1
    buffer_load_dwordx4 a[60:63], v2, s[4:7], s40 offen offset:3072 sc1
    s_lshl_b32 s40, s60, 14
    s_add_u32 s40, s40, s38
    buffer_load_dwordx4 a[64:67], v2, s[4:7], s40 offen offset:0 sc1
    buffer_load_dwordx4 a[68:71], v2, s[4:7], s40 offen offset:1024 sc1
    buffer_load_dwordx4 a[72:75], v2, s[4:7], s40 offen offset:2048 sc1
    buffer_load_dwordx4 a[76:79], v2, s[4:7], s40 offen offset:3072 sc1
    s_add_u32 s40, s40, 4096
    buffer_load_dwordx4 a[80:83], v2, s[4:7], s40 offen offset:0 sc1
    buffer_load_dwordx4 a[84:87], v2, s[4:7], s40 offen offset:1024 sc1
    buffer_load_dwordx4 a[88:91], v2, s[4:7], s40 offen offset:2048 sc1
    buffer_load_dwordx4 a[92:95], v2, s[4:7], s40 offen offset:3072 sc1
    s_lshl_b32 s40, s61, 14
    s_add_u32 s40, s40, s38
    buffer_load_dwordx4 a[96:99], v2, s[4:7], s40 offen offset:0 sc1
    buffer_load_dwordx4 a[100:103], v2, s[4:7], s40 offen offset:1024 sc1
    buffer_load_dwordx4 a[104:107], v2, s[4:7], s40 offen offset:2048 sc1
    buffer_load_dwordx4 a[108:111], v2, s[4:7], s40 offen offset:3072 sc1
    s_add_u32 s40, s40, 4096
    buffer_load_dwordx4 a[112:115], v2, s[4:7], s40 offen offset:0 sc1
    buffer_load_dwordx4 a[116:119], v2, s[4:7], s40 offen offset:1024 sc1
    buffer_load_dwordx4 a[120:123], v2, s[4:7], s40 offen offset:2048 sc1
    buffer_load_dwordx4 a[124:127], v2, s[4:7], s40 offen offset:3072 sc1
    s_add_u32 s40, s26, 0
    s_lshr_b32 s41, s40, 2
    s_xor_b32 s41, s41, s40
    s_xor_b32 s41, s41, s28
    s_and_b32 s41, s41, 1
    s_lshl_b32 s41, s41, 13
    s_lshr_b32 s40, s40, 1
    s_lshl_b32 s40, s40, 20
    s_or_b32 s35, s40, s41
    s_add_u32 s40, s26, 1
    s_lshr_b32 s41, s40, 2
    s_xor_b32 s41, s41, s40
    s_xor_b32 s41, s41, s28
    s_and_b32 s41, s41, 1
    s_lshl_b32 s41, s41, 13
    s_lshr_b32 s40, s40, 1
    s_lshl_b32 s40, s40, 20
    s_or_b32 s36, s40, s41
    s_add_u32 s41, s50, s35
    s_and_b32 s42, s3, 0x4000
    s_add_u32 s42, s42, s35
    s_lshl_b32 s40, s58, 15
    s_add_u32 s40, s40, s42
    s_add_u32 s46, s40, 196608
    s_lshl_b32 s40, s58, 10
    s_add_u32 s40, s40, s42
    s_add_u32 s94, s40, 163840
    s_lshl_b32 s40, s58, 11
    s_add_u32 s98, s40, s41
    s_lshl_b32 s40, s59, 15
    s_add_u32 s40, s40, s42
    s_add_u32 s47, s40, 196608
    s_lshl_b32 s40, s59, 10
    s_add_u32 s40, s40, s42
    s_add_u32 s95, s40, 163840
    s_lshl_b32 s40, s59, 11
    s_add_u32 s99, s40, s41
    s_lshl_b32 s40, s60, 15
    s_add_u32 s40, s40, s42
    s_add_u32 s48, s40, 196608
    s_lshl_b32 s40, s60, 10
    s_add_u32 s40, s40, s42
    s_add_u32 s96, s40, 163840
    s_lshl_b32 s40, s60, 11
    s_add_u32 s100, s40, s41
    s_lshl_b32 s40, s61, 15
    s_add_u32 s40, s40, s42
    s_add_u32 s49, s40, 196608
    s_lshl_b32 s40, s61, 10
    s_add_u32 s40, s40, s42
    s_add_u32 s97, s40, 163840
    s_lshl_b32 s40, s61, 11
    s_add_u32 s101, s40, s41
    s_add_u32 s53, s35, s3
    s_add_u32 s53, s53, 1024
    s_mul_i32 s57, s26, 40960
    s_cmp_lg_u32 s26, 63
    s_cselect_b64 s[62:63], -1, 0
    s_cbranch_scc1 nl63_39
    s_add_u32 s40, s38, 65536
    buffer_load_dwordx4 a[128:131], v2, s[4:7], s40 offen offset:0 sc1
    buffer_load_dwordx4 a[132:135], v2, s[4:7], s40 offen offset:1024 sc1
    buffer_load_dwordx4 a[136:139], v2, s[4:7], s40 offen offset:2048 sc1
    buffer_load_dwordx4 a[140:143], v2, s[4:7], s40 offen offset:3072 sc1
    s_add_u32 s40, s40, 4096
    buffer_load_dwordx4 a[144:147], v2, s[4:7], s40 offen offset:0 sc1
    buffer_load_dwordx4 a[148:151], v2, s[4:7], s40 offen offset:1024 sc1
    buffer_load_dwordx4 a[152:155], v2, s[4:7], s40 offen offset:2048 sc1
    buffer_load_dwordx4 a[156:159], v2, s[4:7], s40 offen offset:3072 sc1
    s_add_u32 s43, s57, 20480
    buffer_load_dwordx2 v[36:37], v8, s[8:11], s57 offen
    buffer_load_dwordx2 v[38:39], v8, s[8:11], s43 offen
    s_waitcnt vmcnt(0)
    v_lshlrev_b32 v28, 16, v36
    v_and_b32 v29, 0xffff0000, v36
    v_lshlrev_b32 v30, 16, v37
    v_and_b32 v31, 0xffff0000, v37
    v_lshlrev_b32 v32, 16, v38
    v_and_b32 v33, 0xffff0000, v38
    v_lshlrev_b32 v34, 16, v39
    v_and_b32 v35, 0xffff0000, v39
    v_mfma_f32_16x16x32_bf16 v[28:31], a[128:131], v[16:19], v[28:31]
    s_nop 0
    v_mfma_f32_16x16x32_bf16 v[32:35], a[128:131], v[20:23], v[32:35]
    v_mfma_f32_16x16x32_bf16 v[28:31], a[132:135], v[16:19], v[28:31]
    v_mfma_f32_16x16x32_bf16 v[32:35], a[132:135], v[20:23], v[32:35]
    v_mfma_f32_16x16x32_bf16 v[28:31], a[136:139], v[16:19], v[28:31]
    v_mfma_f32_16x16x32_bf16 v[32:35], a[136:139], v[20:23], v[32:35]
    v_mfma_f32_16x16x32_bf16 v[28:31], a[140:143], v[16:19], v[28:31]
    v_mfma_f32_16x16x32_bf16 v[32:35], a[140:143], v[20:23], v[32:35]
    v_mfma_f32_16x16x32_bf16 v[28:31], a[144:147], v[16:19], v[28:31]
    v_mfma_f32_16x16x32_bf16 v[32:35], a[144:147], v[20:23], v[32:35]
    v_mfma_f32_16x16x32_bf16 v[28:31], a[148:151], v[16:19], v[28:31]
    v_mfma_f32_16x16x32_bf16 v[32:35], a[148:151], v[20:23], v[32:35]
    v_mfma_f32_16x16x32_bf16 v[28:31], a[152:155], v[16:19], v[28:31]
    v_mfma_f32_16x16x32_bf16 v[32:35], a[152:155], v[20:23], v[32:35]
    v_mfma_f32_16x16x32_bf16 v[28:31], a[156:159], v[16:19], v[28:31]
    v_mfma_f32_16x16x32_bf16 v[32:35], a[156:159], v[20:23], v[32:35]
nl63_39:
    s_mov_b32 s34, 0
    s_mov_b32 s29, 0
    s_mov_b32 s30, 0
    s_barrier
    buffer_load_dword v252, v12, s[4:7], s53 offen sc1
    s_nop 15
    buffer_load_dword v253, v12, s[4:7], s53 offen sc1
    s_nop 15
    buffer_load_dword v254, v12, s[4:7], s53 offen sc1
.p2align 6
poll_40:
    s_waitcnt vmcnt(2)
    v_cmp_eq_u32 vcc, -1, v252
    s_cbranch_vccz pd_41
    buffer_load_dword v252, v12, s[4:7], s53 offen sc1
    s_waitcnt vmcnt(2)
    v_cmp_eq_u32 vcc, -1, v253
    s_cbranch_vccz pd_41
    buffer_load_dword v253, v12, s[4:7], s53 offen sc1
    s_waitcnt vmcnt(2)
    v_cmp_eq_u32 vcc, -1, v254
    s_cbranch_vccz pd_41
    buffer_load_dword v254, v12, s[4:7], s53 offen sc1
    s_add_u32 s27, s27, 1
    s_cmp_lt_u32 s27, 131072
    s_cbranch_scc1 poll_40
    s_branch L_abort
.p2align 6
    s_nop 0
    s_nop 0
pd_41:
    s_barrier
rt_42:
    buffer_load_dwordx4 v[120:123], v2, s[4:7], s98 offen offset:0 sc1
    buffer_load_dwordx4 v[124:127], v2, s[4:7], s98 offen offset:1024 sc1
    buffer_load_dwordx4 v[128:131], v2, s[4:7], s99 offen offset:0 sc1
    buffer_load_dwordx4 v[132:135], v2, s[4:7], s99 offen offset:1024 sc1
    buffer_load_dwordx4 v[56:59], v2, s[4:7], s46 offen offset:0 sc1
    buffer_load_dwordx4 v[60:63], v2, s[4:7], s46 offen offset:1024 sc1
    buffer_load_dwordx4 v[64:67], v2, s[4:7], s46 offen offset:2048 sc1
    buffer_load_dwordx4 v[68:71], v2, s[4:7], s46 offen offset:3072 sc1
    buffer_load_dwordx4 v[72:75], v2, s[4:7], s47 offen offset:0 sc1
    buffer_load_dwordx4 v[76:79], v2, s[4:7], s47 offen offset:1024 sc1
    buffer_load_dwordx4 v[80:83], v2, s[4:7], s47 offen offset:2048 sc1
    buffer_load_dwordx4 v[40:43], v2, s[4:7], s94 offen sc1
    buffer_load_dwordx4 v[136:139], v2, s[4:7], s100 offen offset:0 sc1
    buffer_load_dwordx4 v[140:143], v2, s[4:7], s100 offen offset:1024 sc1
    buffer_load_dwordx4 v[84:87], v2, s[4:7], s47 offen offset:3072 sc1
    buffer_load_dwordx4 v[88:91], v2, s[4:7], s48 offen offset:0 sc1
    buffer_load_dwordx4 v[92:95], v2, s[4:7], s48 offen offset:1024 sc1
    buffer_load_dwordx4 v[44:47], v2, s[4:7], s95 offen sc1
    buffer_load_dwordx4 v[144:147], v2, s[4:7], s101 offen offset:0 sc1
    buffer_load_dwordx4 v[148:151], v2, s[4:7], s101 offen offset:1024 sc1
    buffer_load_dwordx4 v[96:99], v2, s[4:7], s48 offen offset:2048 sc1
    buffer_load_dwordx4 v[100:103], v2, s[4:7], s48 offen offset:3072 sc1
    buffer_load_dwordx4 v[104:107], v2, s[4:7], s49 offen offset:0 sc1
    buffer_load_dwordx4 v[48:51], v2, s[4:7], s96 offen sc1
    buffer_load_dwordx4 v[108:111], v2, s[4:7], s49 offen offset:1024 sc1
    buffer_load_dwordx4 v[112:115], v2, s[4:7], s49 offen offset:2048 sc1
    buffer_load_dwordx4 v[116:119], v2, s[4:7], s49 offen offset:3072 sc1
    buffer_load_dwordx4 v[52:55], v2, s[4:7], s97 offen sc1
    v_mov_b32 v24, 0
    v_mov_b32 v25, 0
    v_mov_b32 v26, 0
    v_mov_b32 v27, 0
    v_mov_b32 v13, s30
    s_waitcnt vmcnt(27)
    s_waitcnt vmcnt(26)
    v_max3_u32 v13, v13, v120, v123
    s_waitcnt vmcnt(25)
    v_max3_u32 v13, v13, v124, v127
    s_waitcnt vmcnt(24)
    v_max3_u32 v13, v13, v128, v131
    s_waitcnt vmcnt(23)
    v_max3_u32 v13, v13, v132, v135
    v_smfmac_f32_16x16x64_bf16 v[24:27], v[56:59], a[0:7], v4
    s_waitcnt vmcnt(22)
    v_max3_u32 v13, v13, v56, v59
    v_smfmac_f32_16x16x64_bf16 v[24:27], v[60:63], a[8:15], v4
    s_waitcnt vmcnt(21)
    v_max3_u32 v13, v13, v60, v63
    v_smfmac_f32_16x16x64_bf16 v[24:27], v[64:67], a[16:23], v4
    s_waitcnt vmcnt(20)
    v_max3_u32 v13, v13, v64, v67
    v_smfmac_f32_16x16x64_bf16 v[24:27], v[68:71], a[24:31], v4
    s_waitcnt vmcnt(19)
    v_cmp_eq_u32 vcc, -1, v13
    v_smfmac_f32_16x16x64_bf16 v[24:27], v[72:75], a[32:39], v4
    s_cbranch_vccnz L_R_nf
    s_barrier
    s_mov_b32 s30, -1
L_R_nfb:
    s_waitcnt vmcnt(18)
    v_smfmac_f32_16x16x64_bf16 v[24:27], v[76:79], a[40:47], v4
    s_waitcnt vmcnt(17)
    v_smfmac_f32_16x16x64_bf16 v[24:27], v[80:83], a[48:55], v4
    s_waitcnt vmcnt(16)
    v_smfmac_f32_16x16x64_bf16 v[24:27], v[40:43], v[120:127], v4
    s_waitcnt vmcnt(15)
    s_waitcnt vmcnt(14)
    s_waitcnt vmcnt(13)
    v_smfmac_f32_16x16x64_bf16 v[24:27], v[84:87], a[56:63], v4
    s_waitcnt vmcnt(12)
    v_smfmac_f32_16x16x64_bf16 v[24:27], v[88:91], a[64:71], v4
    s_waitcnt vmcnt(11)
    v_smfmac_f32_16x16x64_bf16 v[24:27], v[92:95], a[72:79], v4
    s_waitcnt vmcnt(10)
    v_smfmac_f32_16x16x64_bf16 v[24:27], v[44:47], v[128:135], v4
    s_waitcnt vmcnt(9)
    s_waitcnt vmcnt(8)
    s_waitcnt vmcnt(7)
    v_smfmac_f32_16x16x64_bf16 v[24:27], v[96:99], a[80:87], v4
    s_waitcnt vmcnt(6)
    v_smfmac_f32_16x16x64_bf16 v[24:27], v[100:103], a[88:95], v4
    s_waitcnt vmcnt(5)
    v_smfmac_f32_16x16x64_bf16 v[24:27], v[104:107], a[96:103], v4
    s_waitcnt vmcnt(4)
    v_smfmac_f32_16x16x64_bf16 v[24:27], v[48:51], v[136:143], v4
    s_waitcnt vmcnt(3)
    v_smfmac_f32_16x16x64_bf16 v[24:27], v[108:111], a[104:111], v4
    s_waitcnt vmcnt(2)
    v_smfmac_f32_16x16x64_bf16 v[24:27], v[112:115], a[112:119], v4
    s_waitcnt vmcnt(1)
    v_smfmac_f32_16x16x64_bf16 v[24:27], v[116:119], a[120:127], v4
    s_waitcnt vmcnt(0)
    v_smfmac_f32_16x16x64_bf16 v[24:27], v[52:55], v[144:151], v4
    s_nop 7
    v_add_f32 v24, v24, v25
    v_add_f32 v25, v26, v27
    v_cvt_pk_bf16_f32 v26, v24, v25
    v_cmp_u_f32 vcc, v24, v25
    s_nop 0
    v_mov_b32_dpp v25, v26 quad_perm:[1,0,3,2] row_mask:0xf bank_mask:0xf
    s_cmp_eq_u64 vcc, 0
    v_perm_b32 v24, v25, v26, v7
bk_45:
    s_cselect_b64 exec, s[62:63], 0
    buffer_store_dword v24, v6, s[4:7], s36 offen sc1
    buffer_store_dword v24, v11, s[4:7], s36 offen sc1
    s_mov_b64 exec, -1
    s_cbranch_scc0 chk_44
    s_barrier
    s_lshl_b32 s40, s58, 14
    s_add_u32 s40, s40, s37
    s_add_u32 s46, s40, 1638400
    s_lshl_b32 s40, s58, 11
    s_add_u32 s40, s40, s37
    s_add_u32 s94, s40, 1703936
    s_lshl_b32 s40, s59, 14
    s_add_u32 s40, s40, s37
    s_add_u32 s47, s40, 1638400
    s_lshl_b32 s40, s59, 11
    s_add_u32 s40, s40, s37
    s_add_u32 s95, s40, 1703936
    s_lshl_b32 s40, s60, 14
    s_add_u32 s40, s40, s37
    s_add_u32 s48, s40, 1638400
    s_lshl_b32 s40, s60, 11
    s_add_u32 s40, s40, s37
    s_add_u32 s96, s40, 1703936
    s_lshl_b32 s40, s61, 14
    s_add_u32 s40, s40, s37
    s_add_u32 s49, s40, 1638400
    s_lshl_b32 s40, s61, 11
    s_add_u32 s40, s40, s37
    s_add_u32 s97, s40, 1703936
    s_cmp_eq_u32 s26, 63
    s_cbranch_scc1 nffn_48
    s_add_u32 s40, s38, 65536
    buffer_load_dwordx4 a[128:131], v2, s[4:7], s40 offen offset:0 sc1
    buffer_load_dwordx4 a[132:135], v2, s[4:7], s40 offen offset:1024 sc1
    buffer_load_dwordx4 a[136:139], v2, s[4:7], s40 offen offset:2048 sc1
    buffer_load_dwordx4 a[140:143], v2, s[4:7], s40 offen offset:3072 sc1
    s_add_u32 s40, s40, 4096
    buffer_load_dwordx4 a[144:147], v2, s[4:7], s40 offen offset:0 sc1
    buffer_load_dwordx4 a[148:151], v2, s[4:7], s40 offen offset:1024 sc1
    buffer_load_dwordx4 a[152:155], v2, s[4:7], s40 offen offset:2048 sc1
    buffer_load_dwordx4 a[156:159], v2, s[4:7], s40 offen offset:3072 sc1
    s_add_u32 s43, s57, 20480
    buffer_load_dwordx2 v[36:37], v8, s[8:11], s57 offen
    buffer_load_dwordx2 v[38:39], v8, s[8:11], s43 offen
    s_waitcnt vmcnt(0)
    v_lshlrev_b32 v28, 16, v36
    v_and_b32 v29, 0xffff0000, v36
    v_lshlrev_b32 v30, 16, v37
    v_and_b32 v31, 0xffff0000, v37
    v_lshlrev_b32 v32, 16, v38
    v_and_b32 v33, 0xffff0000, v38
    v_lshlrev_b32 v34, 16, v39
    v_and_b32 v35, 0xffff0000, v39
    v_mfma_f32_16x16x32_bf16 v[28:31], a[128:131], v[16:19], v[28:31]
    s_nop 0
    v_mfma_f32_16x16x32_bf16 v[32:35], a[128:131], v[20:23], v[32:35]
    v_mfma_f32_16x16x32_bf16 v[28:31], a[132:135], v[16:19], v[28:31]
    v_mfma_f32_16x16x32_bf16 v[32:35], a[132:135], v[20:23], v[32:35]
    v_mfma_f32_16x16x32_bf16 v[28:31], a[136:139], v[16:19], v[28:31]
    v_mfma_f32_16x16x32_bf16 v[32:35], a[136:139], v[20:23], v[32:35]
    v_mfma_f32_16x16x32_bf16 v[28:31], a[140:143], v[16:19], v[28:31]
    v_mfma_f32_16x16x32_bf16 v[32:35], a[140:143], v[20:23], v[32:35]
    v_mfma_f32_16x16x32_bf16 v[28:31], a[144:147], v[16:19], v[28:31]
    v_mfma_f32_16x16x32_bf16 v[32:35], a[144:147], v[20:23], v[32:35]
    v_mfma_f32_16x16x32_bf16 v[28:31], a[148:151], v[16:19], v[28:31]
    v_mfma_f32_16x16x32_bf16 v[32:35], a[148:151], v[20:23], v[32:35]
    v_mfma_f32_16x16x32_bf16 v[28:31], a[152:155], v[16:19], v[28:31]
    v_mfma_f32_16x16x32_bf16 v[32:35], a[152:155], v[20:23], v[32:35]
    v_mfma_f32_16x16x32_bf16 v[28:31], a[156:159], v[16:19], v[28:31]
    v_mfma_f32_16x16x32_bf16 v[32:35], a[156:159], v[20:23], v[32:35]
nffn_48:
    s_add_u32 s43, s53, 1024
    buffer_load_dword v252, v12, s[4:7], s43 offen sc1
    s_nop 15
    buffer_load_dword v253, v12, s[4:7], s43 offen sc1
    s_nop 15
    buffer_load_dword v254, v12, s[4:7], s43 offen sc1
.p2align 6
poll_49:
    s_waitcnt vmcnt(2)
    v_cmp_eq_u32 vcc, -1, v252
    s_cbranch_vccz pd_50
    buffer_load_dword v252, v12, s[4:7], s43 offen sc1
    s_waitcnt vmcnt(2)
    v_cmp_eq_u32 vcc, -1, v253
    s_cbranch_vccz pd_50
    buffer_load_dword v253, v12, s[4:7], s43 offen sc1
    s_waitcnt vmcnt(2)
    v_cmp_eq_u32 vcc, -1, v254
    s_cbranch_vccz pd_50
    buffer_load_dword v254, v12, s[4:7], s43 offen sc1
    s_add_u32 s27, s27, 1
    s_cmp_lt_u32 s27, 131072
    s_cbranch_scc1 poll_49
    s_branch L_abort
.p2align 6
pd_50:
    s_barrier
    buffer_load_dwordx4 v[152:155], v2, s[4:7], s46 offen offset:0 sc1
    buffer_load_dwordx4 v[156:159], v9, s[4:7], s46 offen offset:0 sc1
    buffer_load_dwordx4 v[160:163], v2, s[4:7], s46 offen offset:1024 sc1
    buffer_load_dwordx4 v[164:167], v9, s[4:7], s46 offen offset:1024 sc1
    buffer_load_dwordx4 v[168:171], v2, s[4:7], s46 offen offset:2048 sc1
    buffer_load_dwordx4 v[172:175], v9, s[4:7], s46 offen offset:2048 sc1
    buffer_load_dwordx4 v[176:179], v2, s[4:7], s46 offen offset:3072 sc1
    buffer_load_dwordx4 v[180:183], v9, s[4:7], s46 offen offset:3072 sc1
    buffer_load_dwordx4 v[184:187], v5, s[4:7], s46 offen offset:0 sc1
    buffer_load_dwordx4 v[188:191], v10, s[4:7], s46 offen offset:0 sc1
    buffer_load_dwordx4 v[192:195], v5, s[4:7], s46 offen offset:1024 sc1
    buffer_load_dwordx4 v[196:199], v10, s[4:7], s46 offen offset:1024 sc1
    buffer_load_dwordx4 v[200:203], v5, s[4:7], s46 offen offset:2048 sc1
    buffer_load_dwordx4 v[204:207], v10, s[4:7], s46 offen offset:2048 sc1
    buffer_load_dwordx4 v[208:211], v5, s[4:7], s46 offen offset:3072 sc1
    buffer_load_dwordx4 v[212:215], v10, s[4:7], s46 offen offset:3072 sc1
    buffer_load_dwordx4 v[216:219], v2, s[4:7], s47 offen offset:0 sc1
    buffer_load_dwordx4 v[220:223], v9, s[4:7], s47 offen offset:0 sc1
    buffer_load_dwordx4 v[224:227], v2, s[4:7], s47 offen offset:1024 sc1
    buffer_load_dwordx4 v[228:231], v9, s[4:7], s47 offen offset:1024 sc1
    buffer_load_dwordx4 v[232:235], v2, s[4:7], s47 offen offset:2048 sc1
    buffer_load_dwordx4 v[236:239], v9, s[4:7], s47 offen offset:2048 sc1
    buffer_load_dwordx4 v[240:243], v2, s[4:7], s47 offen offset:3072 sc1
    buffer_load_dwordx4 v[244:247], v9, s[4:7], s47 offen offset:3072 sc1
    buffer_load_dwordx4 v[248:251], v5, s[4:7], s47 offen offset:0 sc1
    buffer_load_dwordx4 v[40:43], v10, s[4:7], s47 offen offset:0 sc1
    buffer_load_dwordx4 v[44:47], v5, s[4:7], s47 offen offset:1024 sc1
    buffer_load_dwordx4 v[48:51], v10, s[4:7], s47 offen offset:1024 sc1
    buffer_load_dwordx4 v[52:55], v5, s[4:7], s47 offen offset:2048 sc1
    buffer_load_dwordx4 v[56:59], v10, s[4:7], s47 offen offset:2048 sc1
    buffer_load_dwordx4 v[60:63], v5, s[4:7], s47 offen offset:3072 sc1
    buffer_load_dwordx4 v[64:67], v10, s[4:7], s47 offen offset:3072 sc1
    s_waitcnt vmcnt(31)
    v_mfma_f32_16x16x32_bf16 v[28:31], a[0:3], v[152:155], v[28:31]
    s_waitcnt vmcnt(30)
    buffer_load_dwordx4 v[152:155], v2, s[4:7], s48 offen offset:0 sc1
    v_mfma_f32_16x16x32_bf16 v[32:35], a[0:3], v[156:159], v[32:35]
    s_waitcnt vmcnt(30)
    buffer_load_dwordx4 v[156:159], v9, s[4:7], s48 offen offset:0 sc1
    v_mfma_f32_16x16x32_bf16 v[28:31], a[4:7], v[160:163], v[28:31]
    s_waitcnt vmcnt(30)
    buffer_load_dwordx4 v[160:163], v2, s[4:7], s48 offen offset:1024 sc1
    v_mfma_f32_16x16x32_bf16 v[32:35], a[4:7], v[164:167], v[32:35]
    s_waitcnt vmcnt(30)
    buffer_load_dwordx4 v[164:167], v9, s[4:7], s48 offen offset:1024 sc1
    v_mfma_f32_16x16x32_bf16 v[28:31], a[8:11], v[168:171], v[28:31]
    s_waitcnt vmcnt(30)
    buffer_load_dwordx4 v[168:171], v2, s[4:7], s48 offen offset:2048 sc1
    v_mfma_f32_16x16x32_bf16 v[32:35], a[8:11], v[172:175], v[32:35]
    s_waitcnt vmcnt(30)
    buffer_load_dwordx4 v[172:175], v9, s[4:7], s48 offen offset:2048 sc1
    v_mfma_f32_16x16x32_bf16 v[28:31], a[12:15], v[176:179], v[28:31]
    s_waitcnt vmcnt(30)
    buffer_load_dwordx4 v[176:179], v2, s[4:7], s48 offen offset:3072 sc1
    v_mfma_f32_16x16x32_bf16 v[32:35], a[12:15], v[180:183], v[32:35]
    s_waitcnt vmcnt(30)
    buffer_load_dwordx4 v[180:183], v9, s[4:7], s48 offen offset:3072 sc1
    v_mfma_f32_16x16x32_bf16 v[28:31], a[16:19], v[184:187], v[28:31]
    s_waitcnt vmcnt(30)
    buffer_load_dwordx4 v[184:187], v5, s[4:7], s48 offen offset:0 sc1
    v_mfma_f32_16x16x32_bf16 v[32:35], a[16:19], v[188:191], v[32:35]
    s_waitcnt vmcnt(30)
    buffer_load_dwordx4 v[188:191], v10, s[4:7], s48 offen offset:0 sc1
    v_mfma_f32_16x16x32_bf16 v[28:31], a[20:23], v[192:195], v[28:31]
    s_waitcnt vmcnt(30)
    buffer_load_dwordx4 v[192:195], v5, s[4:7], s48 offen offset:1024 sc1
    v_mfma_f32_16x16x32_bf16 v[32:35], a[20:23], v[196:199], v[32:35]
    s_waitcnt vmcnt(30)
    buffer_load_dwordx4 v[196:199], v10, s[4:7], s48 offen offset:1024 sc1
    v_mfma_f32_16x16x32_bf16 v[28:31], a[24:27], v[200:203], v[28:31]
    s_waitcnt vmcnt(30)
    buffer_load_dwordx4 v[200:203], v5, s[4:7], s48 offen offset:2048 sc1
    v_mfma_f32_16x16x32_bf16 v[32:35], a[24:27], v[204:207], v[32:35]
    s_waitcnt vmcnt(30)
    buffer_load_dwordx4 v[204:207], v10, s[4:7], s48 offen offset:2048 sc1
    v_mfma_f32_16x16x32_bf16 v[28:31], a[28:31], v[208:211], v[28:31]
    s_waitcnt vmcnt(30)
    buffer_load_dwordx4 v[208:211], v5, s[4:7], s48 offen offset:3072 sc1
    v_mfma_f32_16x16x32_bf16 v[32:35], a[28:31], v[212:215], v[32:35]
    s_waitcnt vmcnt(30)
    buffer_load_dwordx4 v[212:215], v10, s[4:7], s48 offen offset:3072 sc1
    v_mfma_f32_16x16x32_bf16 v[28:31], a[32:35], v[216:219], v[28:31]
    s_waitcnt vmcnt(30)
    buffer_load_dwordx4 v[216:219], v2, s[4:7], s49 offen offset:0 sc1
    v_mfma_f32_16x16x32_bf16 v[32:35], a[32:35], v[220:223], v[32:35]
    s_waitcnt vmcnt(30)
    buffer_load_dwordx4 v[220:223], v9, s[4:7], s49 offen offset:0 sc1
    v_mfma_f32_16x16x32_bf16 v[28:31], a[36:39], v[224:227], v[28:31]
    s_waitcnt vmcnt(30)
    buffer_load_dwordx4 v[224:227], v2, s[4:7], s49 offen offset:1024 sc1
    v_mfma_f32_16x16x32_bf16 v[32:35], a[36:39], v[228:231], v[32:35]
    s_waitcnt vmcnt(30)
    buffer_load_dwordx4 v[228:231], v9, s[4:7], s49 offen offset:1024 sc1
    v_mfma_f32_16x16x32_bf16 v[28:31], a[40:43], v[232:235], v[28:31]
    s_waitcnt vmcnt(30)
    buffer_load_dwordx4 v[232:235], v2, s[4:7], s49 offen offset:2048 sc1
    v_mfma_f32_16x16x32_bf16 v[32:35], a[40:43], v[236:239], v[32:35]
    s_waitcnt vmcnt(30)
    buffer_load_dwordx4 v[236:239], v9, s[4:7], s49 offen offset:2048 sc1
    v_mfma_f32_16x16x32_bf16 v[28:31], a[44:47], v[240:243], v[28:31]
    s_waitcnt vmcnt(30)
    buffer_load_dwordx4 v[240:243], v2, s[4:7], s49 offen offset:3072 sc1
    v_mfma_f32_16x16x32_bf16 v[32:35], a[44:47], v[244:247], v[32:35]
    s_waitcnt vmcnt(30)
    buffer_load_dwordx4 v[244:247], v9, s[4:7], s49 offen offset:3072 sc1
    v_mfma_f32_16x16x32_bf16 v[28:31], a[48:51], v[248:251], v[28:31]
    s_waitcnt vmcnt(30)
    buffer_load_dwordx4 v[248:251], v5, s[4:7], s49 offen offset:0 sc1
    v_mfma_f32_16x16x32_bf16 v[32:35], a[48:51], v[40:43], v[32:35]
    s_waitcnt vmcnt(30)
    buffer_load_dwordx4 v[40:43], v10, s[4:7], s49 offen offset:0 sc1
    v_mfma_f32_16x16x32_bf16 v[28:31], a[52:55], v[44:47], v[28:31]
    s_waitcnt vmcnt(30)
    buffer_load_dwordx4 v[44:47], v5, s[4:7], s49 offen offset:1024 sc1
    v_mfma_f32_16x16x32_bf16 v[32:35], a[52:55], v[48:51], v[32:35]
    s_waitcnt vmcnt(30)
    buffer_load_dwordx4 v[48:51], v10, s[4:7], s49 offen offset:1024 sc1
    v_mfma_f32_16x16x32_bf16 v[28:31], a[56:59], v[52:55], v[28:31]
    s_waitcnt vmcnt(30)
    buffer_load_dwordx4 v[52:55], v5, s[4:7], s49 offen offset:2048 sc1
    v_mfma_f32_16x16x32_bf16 v[32:35], a[56:59], v[56:59], v[32:35]
    s_waitcnt vmcnt(30)
    buffer_load_dwordx4 v[56:59], v10, s[4:7], s49 offen offset:2048 sc1
    v_mfma_f32_16x16x32_bf16 v[28:31], a[60:63], v[60:63], v[28:31]
    s_waitcnt vmcnt(30)
    buffer_load_dwordx4 v[60:63], v5, s[4:7], s49 offen offset:3072 sc1
    v_mfma_f32_16x16x32_bf16 v[32:35], a[60:63], v[64:67], v[32:35]
    s_waitcnt vmcnt(30)
    buffer_load_dwordx4 v[64:67], v10, s[4:7], s49 offen offset:3072 sc1
    v_mfma_f32_16x16x32_bf16 v[28:31], a[64:67], v[152:155], v[28:31]
    s_waitcnt vmcnt(30)
    buffer_load_dwordx4 v[152:155], v2, s[4:7], s94 offen offset:0 sc1
    v_mfma_f32_16x16x32_bf16 v[32:35], a[64:67], v[156:159], v[32:35]
    s_waitcnt vmcnt(30)
    buffer_load_dwordx4 v[156:159], v9, s[4:7], s94 offen offset:0 sc1
    v_mfma_f32_16x16x32_bf16 v[28:31], a[68:71], v[160:163], v[28:31]
    s_waitcnt vmcnt(30)
    buffer_load_dwordx4 v[160:163], v2, s[4:7], s94 offen offset:1024 sc1
    v_mfma_f32_16x16x32_bf16 v[32:35], a[68:71], v[164:167], v[32:35]
    s_waitcnt vmcnt(30)
    buffer_load_dwordx4 v[164:167], v9, s[4:7], s94 offen offset:1024 sc1
    v_mfma_f32_16x16x32_bf16 v[28:31], a[72:75], v[168:171], v[28:31]
    s_waitcnt vmcnt(30)
    buffer_load_dwordx4 v[168:171], v2, s[4:7], s95 offen offset:0 sc1
    v_mfma_f32_16x16x32_bf16 v[32:35], a[72:75], v[172:175], v[32:35]
    s_waitcnt vmcnt(30)
    buffer_load_dwordx4 v[172:175], v9, s[4:7], s95 offen offset:0 sc1
    v_mfma_f32_16x16x32_bf16 v[28:31], a[76:79], v[176:179], v[28:31]
    s_waitcnt vmcnt(30)
    buffer_load_dwordx4 v[176:179], v2, s[4:7], s95 offen offset:1024 sc1
    v_mfma_f32_16x16x32_bf16 v[32:35], a[76:79], v[180:183], v[32:35]
    s_waitcnt vmcnt(30)
    buffer_load_dwordx4 v[180:183], v9, s[4:7], s95 offen offset:1024 sc1
    v_mfma_f32_16x16x32_bf16 v[28:31], a[80:83], v[184:187], v[28:31]
    s_waitcnt vmcnt(30)
    buffer_load_dwordx4 v[184:187], v2, s[4:7], s96 offen offset:0 sc1
    v_mfma_f32_16x16x32_bf16 v[32:35], a[80:83], v[188:191], v[32:35]
    s_waitcnt vmcnt(30)
    buffer_load_dwordx4 v[188:191], v9, s[4:7], s96 offen offset:0 sc1
    v_mfma_f32_16x16x32_bf16 v[28:31], a[84:87], v[192:195], v[28:31]
    s_waitcnt vmcnt(30)
    buffer_load_dwordx4 v[192:195], v2, s[4:7], s96 offen offset:1024 sc1
    v_mfma_f32_16x16x32_bf16 v[32:35], a[84:87], v[196:199], v[32:35]
    s_waitcnt vmcnt(30)
    buffer_load_dwordx4 v[196:199], v9, s[4:7], s96 offen offset:1024 sc1
    v_mfma_f32_16x16x32_bf16 v[28:31], a[88:91], v[200:203], v[28:31]
    s_waitcnt vmcnt(30)
    buffer_load_dwordx4 v[200:203], v2, s[4:7], s97 offen offset:0 sc1
    v_mfma_f32_16x16x32_bf16 v[32:35], a[88:91], v[204:207], v[32:35]
    s_waitcnt vmcnt(30)
    buffer_load_dwordx4 v[204:207], v9, s[4:7], s97 offen offset:0 sc1
    v_mfma_f32_16x16x32_bf16 v[28:31], a[92:95], v[208:211], v[28:31]
    s_waitcnt vmcnt(30)
    buffer_load_dwordx4 v[208:211], v2, s[4:7], s97 offen offset:1024 sc1
    v_mfma_f32_16x16x32_bf16 v[32:35], a[92:95], v[212:215], v[32:35]
    s_waitcnt vmcnt(30)
    buffer_load_dwordx4 v[212:215], v9, s[4:7], s97 offen offset:1024 sc1
    v_mfma_f32_16x16x32_bf16 v[28:31], a[96:99], v[216:219], v[28:31]
    s_waitcnt vmcnt(30)
    s_barrier
    v_mfma_f32_16x16x32_bf16 v[32:35], a[96:99], v[220:223], v[32:35]
    s_waitcnt vmcnt(29)
    v_mfma_f32_16x16x32_bf16 v[28:31], a[100:103], v[224:227], v[28:31]
    s_waitcnt vmcnt(28)
    v_mfma_f32_16x16x32_bf16 v[32:35], a[100:103], v[228:231], v[32:35]
    s_waitcnt vmcnt(27)
    v_mfma_f32_16x16x32_bf16 v[28:31], a[104:107], v[232:235], v[28:31]
    s_waitcnt vmcnt(26)
    v_mfma_f32_16x16x32_bf16 v[32:35], a[104:107], v[236:239], v[32:35]
    s_waitcnt vmcnt(25)
    v_mfma_f32_16x16x32_bf16 v[28:31], a[108:111], v[240:243], v[28:31]
    s_waitcnt vmcnt(24)
    v_mfma_f32_16x16x32_bf16 v[32:35], a[108:111], v[244:247], v[32:35]
    s_waitcnt vmcnt(23)
    v_mfma_f32_16x16x32_bf16 v[28:31], a[112:115], v[248:251], v[28:31]
    s_waitcnt vmcnt(22)
    v_mfma_f32_16x16x32_bf16 v[32:35], a[112:115], v[40:43], v[32:35]
    s_waitcnt vmcnt(21)
    v_mfma_f32_16x16x32_bf16 v[28:31], a[116:119], v[44:47], v[28:31]
    s_waitcnt vmcnt(20)
    v_mfma_f32_16x16x32_bf16 v[32:35], a[116:119], v[48:51], v[32:35]
    s_waitcnt vmcnt(19)
    v_mfma_f32_16x16x32_bf16 v[28:31], a[120:123], v[52:55], v[28:31]
    s_waitcnt vmcnt(18)
    v_mfma_f32_16x16x32_bf16 v[32:35], a[120:123], v[56:59], v[32:35]
    s_waitcnt vmcnt(17)
    v_mfma_f32_16x16x32_bf16 v[28:31], a[124:127], v[60:63], v[28:31]
    s_waitcnt vmcnt(16)
    v_mfma_f32_16x16x32_bf16 v[32:35], a[124:127], v[64:67], v[32:35]
    s_waitcnt vmcnt(15)
    v_mfma_f32_16x16x32_bf16 v[28:31], v[120:123], v[152:155], v[28:31]
    s_waitcnt vmcnt(14)
    v_mfma_f32_16x16x32_bf16 v[32:35], v[120:123], v[156:159], v[32:35]
    s_waitcnt vmcnt(13)
    v_mfma_f32_16x16x32_bf16 v[28:31], v[124:127], v[160:163], v[28:31]
    s_waitcnt vmcnt(12)
    v_mfma_f32_16x16x32_bf16 v[32:35], v[124:127], v[164:167], v[32:35]
    s_waitcnt vmcnt(11)
    v_mfma_f32_16x16x32_bf16 v[28:31], v[128:131], v[168:171], v[28:31]
    s_waitcnt vmcnt(10)
    v_mfma_f32_16x16x32_bf16 v[32:35], v[128:131], v[172:175], v[32:35]
    s_waitcnt vmcnt(9)
    v_mfma_f32_16x16x32_bf16 v[28:31], v[132:135], v[176:179], v[28:31]
    s_waitcnt vmcnt(8)
    v_mfma_f32_16x16x32_bf16 v[32:35], v[132:135], v[180:183], v[32:35]
    s_waitcnt vmcnt(7)
    v_mfma_f32_16x16x32_bf16 v[28:31], v[136:139], v[184:187], v[28:31]
    s_waitcnt vmcnt(6)
    v_mfma_f32_16x16x32_bf16 v[32:35], v[136:139], v[188:191], v[32:35]
    s_waitcnt vmcnt(5)
    v_mfma_f32_16x16x32_bf16 v[28:31], v[140:143], v[192:195], v[28:31]
    s_waitcnt vmcnt(4)
    v_mfma_f32_16x16x32_bf16 v[32:35], v[140:143], v[196:199], v[32:35]
    s_waitcnt vmcnt(3)
    v_mfma_f32_16x16x32_bf16 v[28:31], v[144:147], v[200:203], v[28:31]
    s_waitcnt vmcnt(2)
    v_mfma_f32_16x16x32_bf16 v[32:35], v[144:147], v[204:207], v[32:35]
    s_waitcnt vmcnt(1)
    v_mfma_f32_16x16x32_bf16 v[28:31], v[148:151], v[208:211], v[28:31]
    s_waitcnt vmcnt(0)
    v_mfma_f32_16x16x32_bf16 v[32:35], v[148:151], v[212:215], v[32:35]
    s_nop 7
    v_cmp_u_f32 vcc, v28, v32
    s_cbranch_vccnz slowO_47
okO_46:
    v_cvt_pk_bf16_f32 v42, v28, v29
    v_cvt_pk_bf16_f32 v43, v30, v31
    v_cvt_pk_bf16_f32 v44, v32, v33
    v_cvt_pk_bf16_f32 v45, v34, v35
    s_add_u32 s43, s57, 20480
    buffer_store_dwordx2 v[42:43], v8, s[64:67], s57 offen
    buffer_store_dwordx2 v[44:45], v8, s[64:67], s43 offen
    s_add_u32 s26, s26, 2
    s_cmp_lt_u32 s26, 64
    s_cbranch_scc1 L_R_loop
    s_branch L_end
L_R_nf:
    s_cmp_lg_u32 s30, 0
    s_cbranch_scc1 L_R_nfb
    s_branch bad_43
chk_44:
    s_cmp_lt_u32 s34, 2
    s_cbranch_scc1 bad_43
    v_mov_b32 v13, 0
    v_max3_u32 v13, v13, v40, v41
    v_max3_u32 v13, v13, v42, v43
    v_max3_u32 v13, v13, v44, v45
    v_max3_u32 v13, v13, v46, v47
    v_max3_u32 v13, v13, v48, v49
    v_max3_u32 v13, v13, v50, v51
    v_max3_u32 v13, v13, v52, v53
    v_max3_u32 v13, v13, v54, v55
    v_max3_u32 v13, v13, v56, v57
    v_max3_u32 v13, v13, v58, v59
    v_max3_u32 v13, v13, v60, v61
    v_max3_u32 v13, v13, v62, v63
    v_max3_u32 v13, v13, v64, v65
    v_max3_u32 v13, v13, v66, v67
    v_max3_u32 v13, v13, v68, v69
    v_max3_u32 v13, v13, v70, v71
    v_max3_u32 v13, v13, v72, v73
    v_max3_u32 v13, v13, v74, v75
    v_max3_u32 v13, v13, v76, v77
    v_max3_u32 v13, v13, v78, v79
    v_max3_u32 v13, v13, v80, v81
    v_max3_u32 v13, v13, v82, v83
    v_max3_u32 v13, v13, v84, v85
    v_max3_u32 v13, v13, v86, v87
    v_max3_u32 v13, v13, v88, v89
    v_max3_u32 v13, v13, v90, v91
    v_max3_u32 v13, v13, v92, v93
    v_max3_u32 v13, v13, v94, v95
    v_max3_u32 v13, v13, v96, v97
    v_max3_u32 v13, v13, v98, v99
    v_max3_u32 v13, v13, v100, v101
    v_max3_u32 v13, v13, v102, v103
    v_max3_u32 v13, v13, v104, v105
    v_max3_u32 v13, v13, v106, v107
    v_max3_u32 v13, v13, v108, v109
    v_max3_u32 v13, v13, v110, v111
    v_max3_u32 v13, v13, v112, v113
    v_max3_u32 v13, v13, v114, v115
    v_max3_u32 v13, v13, v116, v117
    v_max3_u32 v13, v13, v118, v119
    v_max3_u32 v13, v13, v120, v121
    v_max3_u32 v13, v13, v122, v123
    v_max3_u32 v13, v13, v124, v125
    v_max3_u32 v13, v13, v126, v127
    v_max3_u32 v13, v13, v128, v129
    v_max3_u32 v13, v13, v130, v131
    v_max3_u32 v13, v13, v132, v133
    v_max3_u32 v13, v13, v134, v135
    v_max3_u32 v13, v13, v136, v137
    v_max3_u32 v13, v13, v138, v139
    v_max3_u32 v13, v13, v140, v141
    v_max3_u32 v13, v13, v142, v143
    v_max3_u32 v13, v13, v144, v145
    v_max3_u32 v13, v13, v146, v147
    v_max3_u32 v13, v13, v148, v149
    v_max3_u32 v13, v13, v150, v151
    v_cmp_eq_u32 vcc, -1, v13
    s_cmp_eq_u32 0, 0
    s_cbranch_vccz bk_45
bad_43:
    s_add_u32 s34, s34, 1
    s_nop 7
    s_add_u32 s27, s27, 1
    s_cmp_lt_u32 s27, 131072
    s_cbranch_scc1 rt_42
    s_branch L_abort
slowO_47:
    s_nop 7
    v_lshlrev_b32 v28, 16, v36
    v_and_b32 v29, 0xffff0000, v36
    v_lshlrev_b32 v30, 16, v37
    v_and_b32 v31, 0xffff0000, v37
    v_lshlrev_b32 v32, 16, v38
    v_and_b32 v33, 0xffff0000, v38
    v_lshlrev_b32 v34, 16, v39
    v_and_b32 v35, 0xffff0000, v39
    v_mfma_f32_16x16x32_bf16 v[28:31], a[128:131], v[16:19], v[28:31]
    s_nop 0
    v_mfma_f32_16x16x32_bf16 v[32:35], a[128:131], v[20:23], v[32:35]
    v_mfma_f32_16x16x32_bf16 v[28:31], a[132:135], v[16:19], v[28:31]
    v_mfma_f32_16x16x32_bf16 v[32:35], a[132:135], v[20:23], v[32:35]
    v_mfma_f32_16x16x32_bf16 v[28:31], a[136:139], v[16:19], v[28:31]
    v_mfma_f32_16x16x32_bf16 v[32:35], a[136:139], v[20:23], v[32:35]
    v_mfma_f32_16x16x32_bf16 v[28:31], a[140:143], v[16:19], v[28:31]
    v_mfma_f32_16x16x32_bf16 v[32:35], a[140:143], v[20:23], v[32:35]
    v_mfma_f32_16x16x32_bf16 v[28:31], a[144:147], v[16:19], v[28:31]
    v_mfma_f32_16x16x32_bf16 v[32:35], a[144:147], v[20:23], v[32:35]
    v_mfma_f32_16x16x32_bf16 v[28:31], a[148:151], v[16:19], v[28:31]
    v_mfma_f32_16x16x32_bf16 v[32:35], a[148:151], v[20:23], v[32:35]
    v_mfma_f32_16x16x32_bf16 v[28:31], a[152:155], v[16:19], v[28:31]
    v_mfma_f32_16x16x32_bf16 v[32:35], a[152:155], v[20:23], v[32:35]
    v_mfma_f32_16x16x32_bf16 v[28:31], a[156:159], v[16:19], v[28:31]
    v_mfma_f32_16x16x32_bf16 v[32:35], a[156:159], v[20:23], v[32:35]
    buffer_load_dwordx4 v[152:155], v2, s[4:7], s46 offen offset:0 sc1
    buffer_load_dwordx4 v[156:159], v9, s[4:7], s46 offen offset:0 sc1
    buffer_load_dwordx4 v[160:163], v2, s[4:7], s46 offen offset:1024 sc1
    buffer_load_dwordx4 v[164:167], v9, s[4:7], s46 offen offset:1024 sc1
    buffer_load_dwordx4 v[168:171], v2, s[4:7], s46 offen offset:2048 sc1
    buffer_load_dwordx4 v[172:175], v9, s[4:7], s46 offen offset:2048 sc1
    buffer_load_dwordx4 v[176:179], v2, s[4:7], s46 offen offset:3072 sc1
    buffer_load_dwordx4 v[180:183], v9, s[4:7], s46 offen offset:3072 sc1
    buffer_load_dwordx4 v[184:187], v5, s[4:7], s46 offen offset:0 sc1
    buffer_load_dwordx4 v[188:191], v10, s[4:7], s46 offen offset:0 sc1
    buffer_load_dwordx4 v[192:195], v5, s[4:7], s46 offen offset:1024 sc1
    buffer_load_dwordx4 v[196:199], v10, s[4:7], s46 offen offset:1024 sc1
    buffer_load_dwordx4 v[200:203], v5, s[4:7], s46 offen offset:2048 sc1
    buffer_load_dwordx4 v[204:207], v10, s[4:7], s46 offen offset:2048 sc1
    buffer_load_dwordx4 v[208:211], v5, s[4:7], s46 offen offset:3072 sc1
    buffer_load_dwordx4 v[212:215], v10, s[4:7], s46 offen offset:3072 sc1
    buffer_load_dwordx4 v[216:219], v2, s[4:7], s47 offen offset:0 sc1
    buffer_load_dwordx4 v[220:223], v9, s[4:7], s47 offen offset:0 sc1
    buffer_load_dwordx4 v[224:227], v2, s[4:7], s47 offen offset:1024 sc1
    buffer_load_dwordx4 v[228:231], v9, s[4:7], s47 offen offset:1024 sc1
    buffer_load_dwordx4 v[232:235], v2, s[4:7], s47 offen offset:2048 sc1
    buffer_load_dwordx4 v[236:239], v9, s[4:7], s47 offen offset:2048 sc1
    buffer_load_dwordx4 v[240:243], v2, s[4:7], s47 offen offset:3072 sc1
    buffer_load_dwordx4 v[244:247], v9, s[4:7], s47 offen offset:3072 sc1
    buffer_load_dwordx4 v[248:251], v5, s[4:7], s47 offen offset:0 sc1
    buffer_load_dwordx4 v[40:43], v10, s[4:7], s47 offen offset:0 sc1
    buffer_load_dwordx4 v[44:47], v5, s[4:7], s47 offen offset:1024 sc1
    buffer_load_dwordx4 v[48:51], v10, s[4:7], s47 offen offset:1024 sc1
    buffer_load_dwordx4 v[52:55], v5, s[4:7], s47 offen offset:2048 sc1
    buffer_load_dwordx4 v[56:59], v10, s[4:7], s47 offen offset:2048 sc1
    buffer_load_dwordx4 v[60:63], v5, s[4:7], s47 offen offset:3072 sc1
    buffer_load_dwordx4 v[64:67], v10, s[4:7], s47 offen offset:3072 sc1
    v_mov_b32 v13, 0
    s_waitcnt vmcnt(31)
    v_mfma_f32_16x16x32_bf16 v[28:31], a[0:3], v[152:155], v[28:31]
    s_waitcnt vmcnt(30)
    v_max3_u32 v13, v13, v152, v153
    v_max3_u32 v13, v13, v154, v155
    buffer_load_dwordx4 v[152:155], v2, s[4:7], s48 offen offset:0 sc1
    v_mfma_f32_16x16x32_bf16 v[32:35], a[0:3], v[156:159], v[32:35]
    s_waitcnt vmcnt(30)
    v_max3_u32 v13, v13, v156, v157
    v_max3_u32 v13, v13, v158, v159
    buffer_load_dwordx4 v[156:159], v9, s[4:7], s48 offen offset:0 sc1
    v_mfma_f32_16x16x32_bf16 v[28:31], a[4:7], v[160:163], v[28:31]
    s_waitcnt vmcnt(30)
    v_max3_u32 v13, v13, v160, v161
    v_max3_u32 v13, v13, v162, v163
    buffer_load_dwordx4 v[160:163], v2, s[4:7], s48 offen offset:1024 sc1
    v_mfma_f32_16x16x32_bf16 v[32:35], a[4:7], v[164:167], v[32:35]
    s_waitcnt vmcnt(30)
    v_max3_u32 v13, v13, v164, v165
    v_max3_u32 v13, v13, v166, v167
    buffer_load_dwordx4 v[164:167], v9, s[4:7], s48 offen offset:1024 sc1
    v_mfma_f32_16x16x32_bf16 v[28:31], a[8:11], v[168:171], v[28:31]
    s_waitcnt vmcnt(30)
    v_max3_u32 v13, v13, v168, v169
    v_max3_u32 v13, v13, v170, v171
    buffer_load_dwordx4 v[168:171], v2, s[4:7], s48 offen offset:2048 sc1
    v_mfma_f32_16x16x32_bf16 v[32:35], a[8:11], v[172:175], v[32:35]
    s_waitcnt vmcnt(30)
    v_max3_u32 v13, v13, v172, v173
    v_max3_u32 v13, v13, v174, v175
    buffer_load_dwordx4 v[172:175], v9, s[4:7], s48 offen offset:2048 sc1
    v_mfma_f32_16x16x32_bf16 v[28:31], a[12:15], v[176:179], v[28:31]
    s_waitcnt vmcnt(30)
    v_max3_u32 v13, v13, v176, v177
    v_max3_u32 v13, v13, v178, v179
    buffer_load_dwordx4 v[176:179], v2, s[4:7], s48 offen offset:3072 sc1
    v_mfma_f32_16x16x32_bf16 v[32:35], a[12:15], v[180:183], v[32:35]
    s_waitcnt vmcnt(30)
    v_max3_u32 v13, v13, v180, v181
    v_max3_u32 v13, v13, v182, v183
    buffer_load_dwordx4 v[180:183], v9, s[4:7], s48 offen offset:3072 sc1
    v_mfma_f32_16x16x32_bf16 v[28:31], a[16:19], v[184:187], v[28:31]
    s_waitcnt vmcnt(30)
    v_max3_u32 v13, v13, v184, v185
    v_max3_u32 v13, v13, v186, v187
    buffer_load_dwordx4 v[184:187], v5, s[4:7], s48 offen offset:0 sc1
    v_mfma_f32_16x16x32_bf16 v[32:35], a[16:19], v[188:191], v[32:35]
    s_waitcnt vmcnt(30)
    v_max3_u32 v13, v13, v188, v189
    v_max3_u32 v13, v13, v190, v191
    buffer_load_dwordx4 v[188:191], v10, s[4:7], s48 offen offset:0 sc1
    v_mfma_f32_16x16x32_bf16 v[28:31], a[20:23], v[192:195], v[28:31]
    s_waitcnt vmcnt(30)
    v_max3_u32 v13, v13, v192, v193
    v_max3_u32 v13, v13, v194, v195
    buffer_load_dwordx4 v[192:195], v5, s[4:7], s48 offen offset:1024 sc1
    v_mfma_f32_16x16x32_bf16 v[32:35], a[20:23], v[196:199], v[32:35]
    s_waitcnt vmcnt(30)
    v_max3_u32 v13, v13, v196, v197
    v_max3_u32 v13, v13, v198, v199
    buffer_load_dwordx4 v[196:199], v10, s[4:7], s48 offen offset:1024 sc1
    v_mfma_f32_16x16x32_bf16 v[28:31], a[24:27], v[200:203], v[28:31]
    s_waitcnt vmcnt(30)
    v_max3_u32 v13, v13, v200, v201
    v_max3_u32 v13, v13, v202, v203
    buffer_load_dwordx4 v[200:203], v5, s[4:7], s48 offen offset:2048 sc1
    v_mfma_f32_16x16x32_bf16 v[32:35], a[24:27], v[204:207], v[32:35]
    s_waitcnt vmcnt(30)
    v_max3_u32 v13, v13, v204, v205
    v_max3_u32 v13, v13, v206, v207
    buffer_load_dwordx4 v[204:207], v10, s[4:7], s48 offen offset:2048 sc1
    v_mfma_f32_16x16x32_bf16 v[28:31], a[28:31], v[208:211], v[28:31]
    s_waitcnt vmcnt(30)
    v_max3_u32 v13, v13, v208, v209
    v_max3_u32 v13, v13, v210, v211
    buffer_load_dwordx4 v[208:211], v5, s[4:7], s48 offen offset:3072 sc1
    v_mfma_f32_16x16x32_bf16 v[32:35], a[28:31], v[212:215], v[32:35]
    s_waitcnt vmcnt(30)
    v_max3_u32 v13, v13, v212, v213
    v_max3_u32 v13, v13, v214, v215
    buffer_load_dwordx4 v[212:215], v10, s[4:7], s48 offen offset:3072 sc1
    v_mfma_f32_16x16x32_bf16 v[28:31], a[32:35], v[216:219], v[28:31]
    s_waitcnt vmcnt(30)
    v_max3_u32 v13, v13, v216, v217
    v_max3_u32 v13, v13, v218, v219
    buffer_load_dwordx4 v[216:219], v2, s[4:7], s49 offen offset:0 sc1
    v_mfma_f32_16x16x32_bf16 v[32:35], a[32:35], v[220:223], v[32:35]
    s_waitcnt vmcnt(30)
    v_max3_u32 v13, v13, v220, v221
    v_max3_u32 v13, v13, v222, v223
    buffer_load_dwordx4 v[220:223], v9, s[4:7], s49 offen offset:0 sc1
    v_mfma_f32_16x16x32_bf16 v[28:31], a[36:39], v[224:227], v[28:31]
    s_waitcnt vmcnt(30)
    v_max3_u32 v13, v13, v224, v225
    v_max3_u32 v13, v13, v226, v227
    buffer_load_dwordx4 v[224:227], v2, s[4:7], s49 offen offset:1024 sc1
    v_mfma_f32_16x16x32_bf16 v[32:35], a[36:39], v[228:231], v[32:35]
    s_waitcnt vmcnt(30)
    v_max3_u32 v13, v13, v228, v229
    v_max3_u32 v13, v13, v230, v231
    buffer_load_dwordx4 v[228:231], v9, s[4:7], s49 offen offset:1024 sc1
    v_mfma_f32_16x16x32_bf16 v[28:31], a[40:43], v[232:235], v[28:31]
    s_waitcnt vmcnt(30)
    v_max3_u32 v13, v13, v232, v233
    v_max3_u32 v13, v13, v234, v235
    buffer_load_dwordx4 v[232:235], v2, s[4:7], s49 offen offset:2048 sc1
    v_mfma_f32_16x16x32_bf16 v[32:35], a[40:43], v[236:239], v[32:35]
    s_waitcnt vmcnt(30)
    v_max3_u32 v13, v13, v236, v237
    v_max3_u32 v13, v13, v238, v239
    buffer_load_dwordx4 v[236:239], v9, s[4:7], s49 offen offset:2048 sc1
    v_mfma_f32_16x16x32_bf16 v[28:31], a[44:47], v[240:243], v[28:31]
    s_waitcnt vmcnt(30)
    v_max3_u32 v13, v13, v240, v241
    v_max3_u32 v13, v13, v242, v243
    buffer_load_dwordx4 v[240:243], v2, s[4:7], s49 offen offset:3072 sc1
    v_mfma_f32_16x16x32_bf16 v[32:35], a[44:47], v[244:247], v[32:35]
    s_waitcnt vmcnt(30)
    v_max3_u32 v13, v13, v244, v245
    v_max3_u32 v13, v13, v246, v247
    buffer_load_dwordx4 v[244:247], v9, s[4:7], s49 offen offset:3072 sc1
    v_mfma_f32_16x16x32_bf16 v[28:31], a[48:51], v[248:251], v[28:31]
    s_waitcnt vmcnt(30)
    v_max3_u32 v13, v13, v248, v249
    v_max3_u32 v13, v13, v250, v251
    buffer_load_dwordx4 v[248:251], v5, s[4:7], s49 offen offset:0 sc1
    v_mfma_f32_16x16x32_bf16 v[32:35], a[48:51], v[40:43], v[32:35]
    s_waitcnt vmcnt(30)
    v_max3_u32 v13, v13, v40, v41
    v_max3_u32 v13, v13, v42, v43
    buffer_load_dwordx4 v[40:43], v10, s[4:7], s49 offen offset:0 sc1
    v_mfma_f32_16x16x32_bf16 v[28:31], a[52:55], v[44:47], v[28:31]
    s_waitcnt vmcnt(30)
    v_max3_u32 v13, v13, v44, v45
    v_max3_u32 v13, v13, v46, v47
    buffer_load_dwordx4 v[44:47], v5, s[4:7], s49 offen offset:1024 sc1
    v_mfma_f32_16x16x32_bf16 v[32:35], a[52:55], v[48:51], v[32:35]
    s_waitcnt vmcnt(30)
    v_max3_u32 v13, v13, v48, v49
    v_max3_u32 v13, v13, v50, v51
    buffer_load_dwordx4 v[48:51], v10, s[4:7], s49 offen offset:1024 sc1
    v_mfma_f32_16x16x32_bf16 v[28:31], a[56:59], v[52:55], v[28:31]
    s_waitcnt vmcnt(30)
    v_max3_u32 v13, v13, v52, v53
    v_max3_u32 v13, v13, v54, v55
    buffer_load_dwordx4 v[52:55], v5, s[4:7], s49 offen offset:2048 sc1
    v_mfma_f32_16x16x32_bf16 v[32:35], a[56:59], v[56:59], v[32:35]
    s_waitcnt vmcnt(30)
    v_max3_u32 v13, v13, v56, v57
    v_max3_u32 v13, v13, v58, v59
    buffer_load_dwordx4 v[56:59], v10, s[4:7], s49 offen offset:2048 sc1
    v_mfma_f32_16x16x32_bf16 v[28:31], a[60:63], v[60:63], v[28:31]
    s_waitcnt vmcnt(30)
    v_max3_u32 v13, v13, v60, v61
    v_max3_u32 v13, v13, v62, v63
    buffer_load_dwordx4 v[60:63], v5, s[4:7], s49 offen offset:3072 sc1
    v_mfma_f32_16x16x32_bf16 v[32:35], a[60:63], v[64:67], v[32:35]
    s_waitcnt vmcnt(30)
    v_max3_u32 v13, v13, v64, v65
    v_max3_u32 v13, v13, v66, v67
    buffer_load_dwordx4 v[64:67], v10, s[4:7], s49 offen offset:3072 sc1
    v_mfma_f32_16x16x32_bf16 v[28:31], a[64:67], v[152:155], v[28:31]
    s_waitcnt vmcnt(30)
    v_max3_u32 v13, v13, v152, v153
    v_max3_u32 v13, v13, v154, v155
    buffer_load_dwordx4 v[152:155], v2, s[4:7], s94 offen offset:0 sc1
    v_mfma_f32_16x16x32_bf16 v[32:35], a[64:67], v[156:159], v[32:35]
    s_waitcnt vmcnt(30)
    v_max3_u32 v13, v13, v156, v157
    v_max3_u32 v13, v13, v158, v159
    buffer_load_dwordx4 v[156:159], v9, s[4:7], s94 offen offset:0 sc1
    v_mfma_f32_16x16x32_bf16 v[28:31], a[68:71], v[160:163], v[28:31]
    s_waitcnt vmcnt(30)
    v_max3_u32 v13, v13, v160, v161
    v_max3_u32 v13, v13, v162, v163
    buffer_load_dwordx4 v[160:163], v2, s[4:7], s94 offen offset:1024 sc1
    v_mfma_f32_16x16x32_bf16 v[32:35], a[68:71], v[164:167], v[32:35]
    s_waitcnt vmcnt(30)
    v_max3_u32 v13, v13, v164, v165
    v_max3_u32 v13, v13, v166, v167
    buffer_load_dwordx4 v[164:167], v9, s[4:7], s94 offen offset:1024 sc1
    v_mfma_f32_16x16x32_bf16 v[28:31], a[72:75], v[168:171], v[28:31]
    s_waitcnt vmcnt(30)
    v_max3_u32 v13, v13, v168, v169
    v_max3_u32 v13, v13, v170, v171
    buffer_load_dwordx4 v[168:171], v2, s[4:7], s95 offen offset:0 sc1
    v_mfma_f32_16x16x32_bf16 v[32:35], a[72:75], v[172:175], v[32:35]
    s_waitcnt vmcnt(30)
    v_max3_u32 v13, v13, v172, v173
    v_max3_u32 v13, v13, v174, v175
    buffer_load_dwordx4 v[172:175], v9, s[4:7], s95 offen offset:0 sc1
    v_mfma_f32_16x16x32_bf16 v[28:31], a[76:79], v[176:179], v[28:31]
    s_waitcnt vmcnt(30)
    v_max3_u32 v13, v13, v176, v177
    v_max3_u32 v13, v13, v178, v179
    buffer_load_dwordx4 v[176:179], v2, s[4:7], s95 offen offset:1024 sc1
    v_mfma_f32_16x16x32_bf16 v[32:35], a[76:79], v[180:183], v[32:35]
    s_waitcnt vmcnt(30)
    v_max3_u32 v13, v13, v180, v181
    v_max3_u32 v13, v13, v182, v183
    buffer_load_dwordx4 v[180:183], v9, s[4:7], s95 offen offset:1024 sc1
    v_mfma_f32_16x16x32_bf16 v[28:31], a[80:83], v[184:187], v[28:31]
    s_waitcnt vmcnt(30)
    v_max3_u32 v13, v13, v184, v185
    v_max3_u32 v13, v13, v186, v187
    buffer_load_dwordx4 v[184:187], v2, s[4:7], s96 offen offset:0 sc1
    v_mfma_f32_16x16x32_bf16 v[32:35], a[80:83], v[188:191], v[32:35]
    s_waitcnt vmcnt(30)
    v_max3_u32 v13, v13, v188, v189
    v_max3_u32 v13, v13, v190, v191
    buffer_load_dwordx4 v[188:191], v9, s[4:7], s96 offen offset:0 sc1
    v_mfma_f32_16x16x32_bf16 v[28:31], a[84:87], v[192:195], v[28:31]
    s_waitcnt vmcnt(30)
    v_max3_u32 v13, v13, v192, v193
    v_max3_u32 v13, v13, v194, v195
    buffer_load_dwordx4 v[192:195], v2, s[4:7], s96 offen offset:1024 sc1
    v_mfma_f32_16x16x32_bf16 v[32:35], a[84:87], v[196:199], v[32:35]
    s_waitcnt vmcnt(30)
    v_max3_u32 v13, v13, v196, v197
    v_max3_u32 v13, v13, v198, v199
    buffer_load_dwordx4 v[196:199], v9, s[4:7], s96 offen offset:1024 sc1
    v_mfma_f32_16x16x32_bf16 v[28:31], a[88:91], v[200:203], v[28:31]
    s_waitcnt vmcnt(30)
    v_max3_u32 v13, v13, v200, v201
    v_max3_u32 v13, v13, v202, v203
    buffer_load_dwordx4 v[200:203], v2, s[4:7], s97 offen offset:0 sc1
    v_mfma_f32_16x16x32_bf16 v[32:35], a[88:91], v[204:207], v[32:35]
    s_waitcnt vmcnt(30)
    v_max3_u32 v13, v13, v204, v205
    v_max3_u32 v13, v13, v206, v207
    buffer_load_dwordx4 v[204:207], v9, s[4:7], s97 offen offset:0 sc1
    v_mfma_f32_16x16x32_bf16 v[28:31], a[92:95], v[208:211], v[28:31]
    s_waitcnt vmcnt(30)
    v_max3_u32 v13, v13, v208, v209
    v_max3_u32 v13, v13, v210, v211
    buffer_load_dwordx4 v[208:211], v2, s[4:7], s97 offen offset:1024 sc1
    v_mfma_f32_16x16x32_bf16 v[32:35], a[92:95], v[212:215], v[32:35]
    s_waitcnt vmcnt(30)
    v_max3_u32 v13, v13, v212, v213
    v_max3_u32 v13, v13, v214, v215
    buffer_load_dwordx4 v[212:215], v9, s[4:7], s97 offen offset:1024 sc1
    v_mfma_f32_16x16x32_bf16 v[28:31], a[96:99], v[216:219], v[28:31]
    s_waitcnt vmcnt(30)
    v_max3_u32 v13, v13, v216, v217
    v_max3_u32 v13, v13, v218, v219
    v_mfma_f32_16x16x32_bf16 v[32:35], a[96:99], v[220:223], v[32:35]
    s_waitcnt vmcnt(29)
    v_max3_u32 v13, v13, v220, v221
    v_max3_u32 v13, v13, v222, v223
    v_mfma_f32_16x16x32_bf16 v[28:31], a[100:103], v[224:227], v[28:31]
    s_waitcnt vmcnt(28)
    v_max3_u32 v13, v13, v224, v225
    v_max3_u32 v13, v13, v226, v227
    v_mfma_f32_16x16x32_bf16 v[32:35], a[100:103], v[228:231], v[32:35]
    s_waitcnt vmcnt(27)
    v_max3_u32 v13, v13, v228, v229
    v_max3_u32 v13, v13, v230, v231
    v_mfma_f32_16x16x32_bf16 v[28:31], a[104:107], v[232:235], v[28:31]
    s_waitcnt vmcnt(26)
    v_max3_u32 v13, v13, v232, v233
    v_max3_u32 v13, v13, v234, v235
    v_mfma_f32_16x16x32_bf16 v[32:35], a[104:107], v[236:239], v[32:35]
    s_waitcnt vmcnt(25)
    v_max3_u32 v13, v13, v236, v237
    v_max3_u32 v13, v13, v238, v239
    v_mfma_f32_16x16x32_bf16 v[28:31], a[108:111], v[240:243], v[28:31]
    s_waitcnt vmcnt(24)
    v_max3_u32 v13, v13, v240, v241
    v_max3_u32 v13, v13, v242, v243
    v_mfma_f32_16x16x32_bf16 v[32:35], a[108:111], v[244:247], v[32:35]
    s_waitcnt vmcnt(23)
    v_max3_u32 v13, v13, v244, v245
    v_max3_u32 v13, v13, v246, v247
    v_mfma_f32_16x16x32_bf16 v[28:31], a[112:115], v[248:251], v[28:31]
    s_waitcnt vmcnt(22)
    v_max3_u32 v13, v13, v248, v249
    v_max3_u32 v13, v13, v250, v251
    v_mfma_f32_16x16x32_bf16 v[32:35], a[112:115], v[40:43], v[32:35]
    s_waitcnt vmcnt(21)
    v_max3_u32 v13, v13, v40, v41
    v_max3_u32 v13, v13, v42, v43
    v_mfma_f32_16x16x32_bf16 v[28:31], a[116:119], v[44:47], v[28:31]
    s_waitcnt vmcnt(20)
    v_max3_u32 v13, v13, v44, v45
    v_max3_u32 v13, v13, v46, v47
    v_mfma_f32_16x16x32_bf16 v[32:35], a[116:119], v[48:51], v[32:35]
    s_waitcnt vmcnt(19)
    v_max3_u32 v13, v13, v48, v49
    v_max3_u32 v13, v13, v50, v51
    v_mfma_f32_16x16x32_bf16 v[28:31], a[120:123], v[52:55], v[28:31]
    s_waitcnt vmcnt(18)
    v_max3_u32 v13, v13, v52, v53
    v_max3_u32 v13, v13, v54, v55
    v_mfma_f32_16x16x32_bf16 v[32:35], a[120:123], v[56:59], v[32:35]
    s_waitcnt vmcnt(17)
    v_max3_u32 v13, v13, v56, v57
    v_max3_u32 v13, v13, v58, v59
    v_mfma_f32_16x16x32_bf16 v[28:31], a[124:127], v[60:63], v[28:31]
    s_waitcnt vmcnt(16)
    v_max3_u32 v13, v13, v60, v61
    v_max3_u32 v13, v13, v62, v63
    v_mfma_f32_16x16x32_bf16 v[32:35], a[124:127], v[64:67], v[32:35]
    s_waitcnt vmcnt(15)
    v_max3_u32 v13, v13, v64, v65
    v_max3_u32 v13, v13, v66, v67
    v_mfma_f32_16x16x32_bf16 v[28:31], v[120:123], v[152:155], v[28:31]
    s_waitcnt vmcnt(14)
    v_max3_u32 v13, v13, v152, v153
    v_max3_u32 v13, v13, v154, v155
    v_mfma_f32_16x16x32_bf16 v[32:35], v[120:123], v[156:159], v[32:35]
    s_waitcnt vmcnt(13)
    v_max3_u32 v13, v13, v156, v157
    v_max3_u32 v13, v13, v158, v159
    v_mfma_f32_16x16x32_bf16 v[28:31], v[124:127], v[160:163], v[28:31]
    s_waitcnt vmcnt(12)
    v_max3_u32 v13, v13, v160, v161
    v_max3_u32 v13, v13, v162, v163
    v_mfma_f32_16x16x32_bf16 v[32:35], v[124:127], v[164:167], v[32:35]
    s_waitcnt vmcnt(11)
    v_max3_u32 v13, v13, v164, v165
    v_max3_u32 v13, v13, v166, v167
    v_mfma_f32_16x16x32_bf16 v[28:31], v[128:131], v[168:171], v[28:31]
    s_waitcnt vmcnt(10)
    v_max3_u32 v13, v13, v168, v169
    v_max3_u32 v13, v13, v170, v171
    v_mfma_f32_16x16x32_bf16 v[32:35], v[128:131], v[172:175], v[32:35]
    s_waitcnt vmcnt(9)
    v_max3_u32 v13, v13, v172, v173
    v_max3_u32 v13, v13, v174, v175
    v_mfma_f32_16x16x32_bf16 v[28:31], v[132:135], v[176:179], v[28:31]
    s_waitcnt vmcnt(8)
    v_max3_u32 v13, v13, v176, v177
    v_max3_u32 v13, v13, v178, v179
    v_mfma_f32_16x16x32_bf16 v[32:35], v[132:135], v[180:183], v[32:35]
    s_waitcnt vmcnt(7)
    v_max3_u32 v13, v13, v180, v181
    v_max3_u32 v13, v13, v182, v183
    v_mfma_f32_16x16x32_bf16 v[28:31], v[136:139], v[184:187], v[28:31]
    s_waitcnt vmcnt(6)
    v_max3_u32 v13, v13, v184, v185
    v_max3_u32 v13, v13, v186, v187
    v_mfma_f32_16x16x32_bf16 v[32:35], v[136:139], v[188:191], v[32:35]
    s_waitcnt vmcnt(5)
    v_max3_u32 v13, v13, v188, v189
    v_max3_u32 v13, v13, v190, v191
    v_mfma_f32_16x16x32_bf16 v[28:31], v[140:143], v[192:195], v[28:31]
    s_waitcnt vmcnt(4)
    v_max3_u32 v13, v13, v192, v193
    v_max3_u32 v13, v13, v194, v195
    v_mfma_f32_16x16x32_bf16 v[32:35], v[140:143], v[196:199], v[32:35]
    s_waitcnt vmcnt(3)
    v_max3_u32 v13, v13, v196, v197
    v_max3_u32 v13, v13, v198, v199
    v_mfma_f32_16x16x32_bf16 v[28:31], v[144:147], v[200:203], v[28:31]
    s_waitcnt vmcnt(2)
    v_max3_u32 v13, v13, v200, v201
    v_max3_u32 v13, v13, v202, v203
    v_mfma_f32_16x16x32_bf16 v[32:35], v[144:147], v[204:207], v[32:35]
    s_waitcnt vmcnt(1)
    v_max3_u32 v13, v13, v204, v205
    v_max3_u32 v13, v13, v206, v207
    v_mfma_f32_16x16x32_bf16 v[28:31], v[148:151], v[208:211], v[28:31]
    s_waitcnt vmcnt(0)
    v_max3_u32 v13, v13, v208, v209
    v_max3_u32 v13, v13, v210, v211
    v_mfma_f32_16x16x32_bf16 v[32:35], v[148:151], v[212:215], v[32:35]
    v_max3_u32 v13, v13, v212, v213
    v_max3_u32 v13, v13, v214, v215
    s_nop 7
    v_cmp_eq_u32 vcc, -1, v13
    s_cbranch_vccz okO_46
    s_add_u32 s27, s27, 1
    s_cmp_lt_u32 s27, 131072
    s_cbranch_scc1 slowO_47
    s_branch L_abort
L_PF:
    s_waitcnt lgkmcnt(0)
    s_mov_b32 s8, s12
    s_mov_b32 s9, s13
    s_mov_b32 s10, 0
    s_mov_b32 s11, 0x20000
    s_mov_b32 s12, s14
    s_mov_b32 s13, s15
    s_mov_b32 s14, 0
    s_mov_b32 s15, 0x20000
    s_add_u32 s4, s4, 0x3fffff
    s_addc_u32 s5, s5, 0
    s_and_b32 s4, s4, 0xffc00000
    s_cmp_ge_u32 s21, 24
    s_cbranch_scc1 npf_51
    s_load_dwordx2 s[8:9], s[0:1], 16
    s_mov_b32 s10, 7864320
    s_mov_b32 s11, 0x20000
    s_load_dwordx2 s[12:13], s[0:1], 24
    s_mov_b32 s14, 7864320
    s_mov_b32 s15, 0x20000
    s_load_dwordx2 s[44:45], s[0:1], 32
    s_mov_b32 s46, 7864320
    s_mov_b32 s47, 0x20000
    s_load_dwordx2 s[48:49], s[0:1], 40
    s_mov_b32 s50, 7864320
    s_mov_b32 s51, 0x20000
    s_sub_u32 s40, s21, 16
    s_sub_u32 s41, s23, 1
    s_lshl_b32 s52, s22, 1
    s_xor_b32 s53, s20, s52
    s_lshl_b32 s53, s53, 2
    v_lshlrev_b32 v2, 4, v1
    s_mul_i32 s42, s40, 49152
    s_lshl_b32 s43, s41, 10
    s_add_u32 s42, s42, s43
    s_mul_i32 s43, s20, 3072
    s_add_u32 s42, s42, s43
    s_add_u32 s43, s42, 0
    v_add_u32 v4, s43, v2
    s_add_u32 s43, s42, 12288
    v_add_u32 v5, s43, v2
    s_add_u32 s43, s42, 24576
    v_add_u32 v6, s43, v2
    s_add_u32 s43, s42, 36864
    v_add_u32 v7, s43, v2
    s_lshl_b32 s42, s20, 3
    s_add_u32 s42, s42, s40
    s_mul_i32 s42, s42, 245760
    s_mul_i32 s43, s41, 6656
    s_add_u32 s42, s42, s43
    v_add_u32 v8, s42, v2
    v_add_u32 v9, 4096, v8
    s_waitcnt lgkmcnt(0)
    s_add_u32 s54, s53, 2
    s_cmp_ge_u32 s54, 20
    s_cselect_b32 s55, 20, 0
    s_sub_u32 s54, s54, s55
    s_mul_i32 s54, s54, 393216
    buffer_load_dwordx4 v[32:35], v4, s[8:11], s54 offen offset:0
    s_waitcnt vmcnt(4)
    buffer_load_dwordx4 v[36:39], v5, s[8:11], s54 offen offset:0
    s_waitcnt vmcnt(4)
    buffer_load_dwordx4 v[40:43], v6, s[8:11], s54 offen offset:0
    s_waitcnt vmcnt(4)
    buffer_load_dwordx4 v[44:47], v7, s[8:11], s54 offen offset:0
    s_waitcnt vmcnt(4)
    s_add_u32 s54, s53, 5
    s_cmp_ge_u32 s54, 20
    s_cselect_b32 s55, 20, 0
    s_sub_u32 s54, s54, s55
    s_mul_i32 s54, s54, 393216
    buffer_load_dwordx4 v[48:51], v4, s[44:47], s54 offen offset:0
    s_waitcnt vmcnt(4)
    buffer_load_dwordx4 v[52:55], v5, s[44:47], s54 offen offset:0
    s_waitcnt vmcnt(4)
    buffer_load_dwordx4 v[56:59], v6, s[44:47], s54 offen offset:0
    s_waitcnt vmcnt(4)
    buffer_load_dwordx4 v[60:63], v7, s[44:47], s54 offen offset:0
    s_waitcnt vmcnt(4)
    s_add_u32 s54, s53, 3
    s_cmp_ge_u32 s54, 20
    s_cselect_b32 s55, 20, 0
    s_sub_u32 s54, s54, s55
    s_mul_i32 s54, s54, 393216
    buffer_load_dwordx4 v[64:67], v4, s[12:15], s54 offen offset:0
    s_waitcnt vmcnt(4)
    buffer_load_dwordx4 v[68:71], v5, s[12:15], s54 offen offset:0
    s_waitcnt vmcnt(4)
    buffer_load_dwordx4 v[72:75], v6, s[12:15], s54 offen offset:0
    s_waitcnt vmcnt(4)
    buffer_load_dwordx4 v[76:79], v7, s[12:15], s54 offen offset:0
    s_waitcnt vmcnt(4)
    s_add_u32 s54, s53, 8
    s_cmp_ge_u32 s54, 20
    s_cselect_b32 s55, 20, 0
    s_sub_u32 s54, s54, s55
    s_mul_i32 s54, s54, 393216
    buffer_load_dwordx4 v[80:83], v4, s[44:47], s54 offen offset:0
    s_waitcnt vmcnt(4)
    buffer_load_dwordx4 v[84:87], v5, s[44:47], s54 offen offset:0
    s_waitcnt vmcnt(4)
    buffer_load_dwordx4 v[88:91], v6, s[44:47], s54 offen offset:0
    s_waitcnt vmcnt(4)
    buffer_load_dwordx4 v[92:95], v7, s[44:47], s54 offen offset:0
    s_waitcnt vmcnt(4)
    s_add_u32 s54, s53, 5
    s_cmp_ge_u32 s54, 20
    s_cselect_b32 s55, 20, 0
    s_sub_u32 s54, s54, s55
    s_mul_i32 s54, s54, 393216
    buffer_load_dwordx4 v[32:35], v4, s[8:11], s54 offen offset:0
    s_waitcnt vmcnt(4)
    buffer_load_dwordx4 v[36:39], v5, s[8:11], s54 offen offset:0
    s_waitcnt vmcnt(4)
    buffer_load_dwordx4 v[40:43], v6, s[8:11], s54 offen offset:0
    s_waitcnt vmcnt(4)
    buffer_load_dwordx4 v[44:47], v7, s[8:11], s54 offen offset:0
    s_waitcnt vmcnt(4)
    s_add_u32 s54, s53, 11
    s_cmp_ge_u32 s54, 20
    s_cselect_b32 s55, 20, 0
    s_sub_u32 s54, s54, s55
    s_mul_i32 s54, s54, 393216
    buffer_load_dwordx4 v[48:51], v4, s[44:47], s54 offen offset:0
    s_waitcnt vmcnt(4)
    buffer_load_dwordx4 v[52:55], v5, s[44:47], s54 offen offset:0
    s_waitcnt vmcnt(4)
    buffer_load_dwordx4 v[56:59], v6, s[44:47], s54 offen offset:0
    s_waitcnt vmcnt(4)
    buffer_load_dwordx4 v[60:63], v7, s[44:47], s54 offen offset:0
    s_waitcnt vmcnt(4)
    s_add_u32 s54, s53, 6
    s_cmp_ge_u32 s54, 20
    s_cselect_b32 s55, 20, 0
    s_sub_u32 s54, s54, s55
    s_mul_i32 s54, s54, 393216
    buffer_load_dwordx4 v[64:67], v4, s[12:15], s54 offen offset:0
    s_waitcnt vmcnt(4)
    buffer_load_dwordx4 v[68:71], v5, s[12:15], s54 offen offset:0
    s_waitcnt vmcnt(4)
    buffer_load_dwordx4 v[72:75], v6, s[12:15], s54 offen offset:0
    s_waitcnt vmcnt(4)
    buffer_load_dwordx4 v[76:79], v7, s[12:15], s54 offen offset:0
    s_waitcnt vmcnt(4)
    s_add_u32 s54, s53, 14
    s_cmp_ge_u32 s54, 20
    s_cselect_b32 s55, 20, 0
    s_sub_u32 s54, s54, s55
    s_mul_i32 s54, s54, 393216
    buffer_load_dwordx4 v[80:83], v4, s[44:47], s54 offen offset:0
    s_waitcnt vmcnt(4)
    buffer_load_dwordx4 v[84:87], v5, s[44:47], s54 offen offset:0
    s_waitcnt vmcnt(4)
    buffer_load_dwordx4 v[88:91], v6, s[44:47], s54 offen offset:0
    s_waitcnt vmcnt(4)
    buffer_load_dwordx4 v[92:95], v7, s[44:47], s54 offen offset:0
    s_waitcnt vmcnt(4)
    s_add_u32 s54, s53, 8
    s_cmp_ge_u32 s54, 20
    s_cselect_b32 s55, 20, 0
    s_sub_u32 s54, s54, s55
    s_mul_i32 s54, s54, 393216
    buffer_load_dwordx4 v[32:35], v4, s[8:11], s54 offen offset:0
    s_waitcnt vmcnt(4)
    buffer_load_dwordx4 v[36:39], v5, s[8:11], s54 offen offset:0
    s_waitcnt vmcnt(4)
    buffer_load_dwordx4 v[40:43], v6, s[8:11], s54 offen offset:0
    s_waitcnt vmcnt(4)
    buffer_load_dwordx4 v[44:47], v7, s[8:11], s54 offen offset:0
    s_waitcnt vmcnt(4)
    s_add_u32 s54, s53, 17
    s_cmp_ge_u32 s54, 20
    s_cselect_b32 s55, 20, 0
    s_sub_u32 s54, s54, s55
    s_mul_i32 s54, s54, 393216
    buffer_load_dwordx4 v[48:51], v4, s[44:47], s54 offen offset:0
    s_waitcnt vmcnt(4)
    buffer_load_dwordx4 v[52:55], v5, s[44:47], s54 offen offset:0
    s_waitcnt vmcnt(4)
    buffer_load_dwordx4 v[56:59], v6, s[44:47], s54 offen offset:0
    s_waitcnt vmcnt(4)
    buffer_load_dwordx4 v[60:63], v7, s[44:47], s54 offen offset:0
    s_waitcnt vmcnt(4)
    s_add_u32 s54, s53, 9
    s_cmp_ge_u32 s54, 20
    s_cselect_b32 s55, 20, 0
    s_sub_u32 s54, s54, s55
    s_mul_i32 s54, s54, 393216
    buffer_load_dwordx4 v[64:67], v4, s[12:15], s54 offen offset:0
    s_waitcnt vmcnt(4)
    buffer_load_dwordx4 v[68:71], v5, s[12:15], s54 offen offset:0
    s_waitcnt vmcnt(4)
    buffer_load_dwordx4 v[72:75], v6, s[12:15], s54 offen offset:0
    s_waitcnt vmcnt(4)
    buffer_load_dwordx4 v[76:79], v7, s[12:15], s54 offen offset:0
    s_waitcnt vmcnt(4)
    s_mul_i32 s54, s52, 61440
    s_add_u32 s54, s54, 20480
    buffer_load_dwordx4 v[80:83], v8, s[48:51], s54 offen offset:0
    s_waitcnt vmcnt(4)
    buffer_load_dwordx4 v[84:87], v8, s[48:51], s54 offen offset:1024
    s_waitcnt vmcnt(4)
    buffer_load_dwordx4 v[88:91], v8, s[48:51], s54 offen offset:2048
    s_waitcnt vmcnt(4)
    buffer_load_dwordx4 v[92:95], v8, s[48:51], s54 offen offset:3072
    s_waitcnt vmcnt(4)
    buffer_load_dwordx4 v[32:35], v9, s[48:51], s54 offen offset:0
    s_waitcnt vmcnt(4)
    buffer_load_dwordx4 v[36:39], v9, s[48:51], s54 offen offset:1024
    s_waitcnt vmcnt(4)
    buffer_load_dwordx4 v[40:43], v9, s[48:51], s54 offen offset:2048
    s_waitcnt vmcnt(4)
    s_add_u32 s54, s53, 11
    s_cmp_ge_u32 s54, 20
    s_cselect_b32 s55, 20, 0
    s_sub_u32 s54, s54, s55
    s_mul_i32 s54, s54, 393216
    buffer_load_dwordx4 v[44:47], v4, s[8:11], s54 offen offset:0
    s_waitcnt vmcnt(4)
    buffer_load_dwordx4 v[48:51], v5, s[8:11], s54 offen offset:0
    s_waitcnt vmcnt(4)
    buffer_load_dwordx4 v[52:55], v6, s[8:11], s54 offen offset:0
    s_waitcnt vmcnt(4)
    buffer_load_dwordx4 v[56:59], v7, s[8:11], s54 offen offset:0
    s_waitcnt vmcnt(4)
    s_add_u32 s54, s53, 12
    s_cmp_ge_u32 s54, 20
    s_cselect_b32 s55, 20, 0
    s_sub_u32 s54, s54, s55
    s_mul_i32 s54, s54, 393216
    buffer_load_dwordx4 v[60:63], v4, s[12:15], s54 offen offset:0
    s_waitcnt vmcnt(4)
    buffer_load_dwordx4 v[64:67], v5, s[12:15], s54 offen offset:0
    s_waitcnt vmcnt(4)
    buffer_load_dwordx4 v[68:71], v6, s[12:15], s54 offen offset:0
    s_waitcnt vmcnt(4)
    buffer_load_dwordx4 v[72:75], v7, s[12:15], s54 offen offset:0
    s_waitcnt vmcnt(4)
    s_mul_i32 s54, s52, 61440
    s_add_u32 s54, s54, 81920
    buffer_load_dwordx4 v[76:79], v8, s[48:51], s54 offen offset:0
    s_waitcnt vmcnt(4)
    buffer_load_dwordx4 v[80:83], v8, s[48:51], s54 offen offset:1024
    s_waitcnt vmcnt(4)
    buffer_load_dwordx4 v[84:87], v8, s[48:51], s54 offen offset:2048
    s_waitcnt vmcnt(4)
    buffer_load_dwordx4 v[88:91], v8, s[48:51], s54 offen offset:3072
    s_waitcnt vmcnt(4)
    buffer_load_dwordx4 v[92:95], v9, s[48:51], s54 offen offset:0
    s_waitcnt vmcnt(4)
    buffer_load_dwordx4 v[32:35], v9, s[48:51], s54 offen offset:1024
    s_waitcnt vmcnt(4)
    buffer_load_dwordx4 v[36:39], v9, s[48:51], s54 offen offset:2048
    s_waitcnt vmcnt(4)
    s_add_u32 s54, s53, 14
    s_cmp_ge_u32 s54, 20
    s_cselect_b32 s55, 20, 0
    s_sub_u32 s54, s54, s55
    s_mul_i32 s54, s54, 393216
    buffer_load_dwordx4 v[40:43], v4, s[8:11], s54 offen offset:0
    s_waitcnt vmcnt(4)
    buffer_load_dwordx4 v[44:47], v5, s[8:11], s54 offen offset:0
    s_waitcnt vmcnt(4)
    buffer_load_dwordx4 v[48:51], v6, s[8:11], s54 offen offset:0
    s_waitcnt vmcnt(4)
    buffer_load_dwordx4 v[52:55], v7, s[8:11], s54 offen offset:0
    s_waitcnt vmcnt(4)
    s_add_u32 s54, s53, 15
    s_cmp_ge_u32 s54, 20
    s_cselect_b32 s55, 20, 0
    s_sub_u32 s54, s54, s55
    s_mul_i32 s54, s54, 393216
    buffer_load_dwordx4 v[56:59], v4, s[12:15], s54 offen offset:0
    s_waitcnt vmcnt(4)
    buffer_load_dwordx4 v[60:63], v5, s[12:15], s54 offen offset:0
    s_waitcnt vmcnt(4)
    buffer_load_dwordx4 v[64:67], v6, s[12:15], s54 offen offset:0
    s_waitcnt vmcnt(4)
    buffer_load_dwordx4 v[68:71], v7, s[12:15], s54 offen offset:0
    s_waitcnt vmcnt(4)
    s_mul_i32 s54, s52, -61440
    s_add_u32 s54, s54, 143360
    buffer_load_dwordx4 v[72:75], v8, s[48:51], s54 offen offset:0
    s_waitcnt vmcnt(4)
    buffer_load_dwordx4 v[76:79], v8, s[48:51], s54 offen offset:1024
    s_waitcnt vmcnt(4)
    buffer_load_dwordx4 v[80:83], v8, s[48:51], s54 offen offset:2048
    s_waitcnt vmcnt(4)
    buffer_load_dwordx4 v[84:87], v8, s[48:51], s54 offen offset:3072
    s_waitcnt vmcnt(4)
    buffer_load_dwordx4 v[88:91], v9, s[48:51], s54 offen offset:0
    s_waitcnt vmcnt(4)
    buffer_load_dwordx4 v[92:95], v9, s[48:51], s54 offen offset:1024
    s_waitcnt vmcnt(4)
    buffer_load_dwordx4 v[32:35], v9, s[48:51], s54 offen offset:2048
    s_waitcnt vmcnt(4)
    s_add_u32 s54, s53, 17
    s_cmp_ge_u32 s54, 20
    s_cselect_b32 s55, 20, 0
    s_sub_u32 s54, s54, s55
    s_mul_i32 s54, s54, 393216
    buffer_load_dwordx4 v[36:39], v4, s[8:11], s54 offen offset:0
    s_waitcnt vmcnt(4)
    buffer_load_dwordx4 v[40:43], v5, s[8:11], s54 offen offset:0
    s_waitcnt vmcnt(4)
    buffer_load_dwordx4 v[44:47], v6, s[8:11], s54 offen offset:0
    s_waitcnt vmcnt(4)
    buffer_load_dwordx4 v[48:51], v7, s[8:11], s54 offen offset:0
    s_waitcnt vmcnt(4)
    s_mul_i32 s54, s52, -61440
    s_add_u32 s54, s54, 204800
    buffer_load_dwordx4 v[52:55], v8, s[48:51], s54 offen offset:0
    s_waitcnt vmcnt(4)
    buffer_load_dwordx4 v[56:59], v8, s[48:51], s54 offen offset:1024
    s_waitcnt vmcnt(4)
    buffer_load_dwordx4 v[60:63], v8, s[48:51], s54 offen offset:2048
    s_waitcnt vmcnt(4)
    buffer_load_dwordx4 v[64:67], v8, s[48:51], s54 offen offset:3072
    s_waitcnt vmcnt(4)
    buffer_load_dwordx4 v[68:71], v9, s[48:51], s54 offen offset:0
    s_waitcnt vmcnt(4)
    buffer_load_dwordx4 v[72:75], v9, s[48:51], s54 offen offset:1024
    s_waitcnt vmcnt(4)
    buffer_load_dwordx4 v[76:79], v9, s[48:51], s54 offen offset:2048
    s_waitcnt vmcnt(4)
    s_add_u32 s54, s53, 18
    s_cmp_ge_u32 s54, 20
    s_cselect_b32 s55, 20, 0
    s_sub_u32 s54, s54, s55
    s_mul_i32 s54, s54, 393216
    buffer_load_dwordx4 v[80:83], v4, s[12:15], s54 offen offset:0
    s_waitcnt vmcnt(4)
    buffer_load_dwordx4 v[84:87], v5, s[12:15], s54 offen offset:0
    s_waitcnt vmcnt(4)
    buffer_load_dwordx4 v[88:91], v6, s[12:15], s54 offen offset:0
    s_waitcnt vmcnt(4)
    buffer_load_dwordx4 v[92:95], v7, s[12:15], s54 offen offset:0
    s_waitcnt vmcnt(4)
npf_51:
    s_cmp_lg_u32 s21, 25
    s_cbranch_scc1 ncal_52
    s_and_b32 s40, s23, 1
    s_lshl_b32 s40, s40, 20
    s_lshr_b32 s41, s23, 1
    s_lshl_b32 s41, s41, 3
    s_and_b32 s42, s2, 7
    s_add_u32 s41, s41, s42
    s_lshl_b32 s41, s41, 7
    s_add_u32 s40, s40, s41
    s_add_u32 s40, s40, 360448
    v_lshrrev_b32 v2, 3, v1
    v_lshlrev_b32 v2, 11, v2
    v_and_b32 v3, 7, v1
    v_lshl_add_u32 v2, v3, 4, v2
    v_mov_b32 v12, 0
    s_add_u32 s41, s40, 16384
    buffer_store_dwordx4 v[0:3], v2, s[4:7], s40 offen sc1
    buffer_store_dwordx4 v[0:3], v2, s[4:7], s41 offen sc1
    s_mov_b32 s42, 0
    s_mov_b32 s46, -1
    s_mov_b32 s47, -1
    s_mov_b32 s48, -1
    s_mov_b32 s49, -1
    s_waitcnt vmcnt(0)
cal_53:
    s_add_u32 s41, s40, 0
    s_memtime s[50:51]
    s_waitcnt lgkmcnt(0)
    buffer_load_dword v4, v12, s[4:7], s41 offen sc1
    s_waitcnt vmcnt(0)
    s_memtime s[52:53]
    s_waitcnt lgkmcnt(0)
    s_sub_u32 s52, s52, s50
    s_min_u32 s46, s46, s52
    s_add_u32 s41, s40, 8192
    s_memtime s[50:51]
    s_waitcnt lgkmcnt(0)
    buffer_load_dword v4, v12, s[4:7], s41 offen sc1
    s_waitcnt vmcnt(0)
    s_memtime s[52:53]
    s_waitcnt lgkmcnt(0)
    s_sub_u32 s52, s52, s50
    s_min_u32 s47, s47, s52
    s_add_u32 s41, s40, 16384
    s_memtime s[50:51]
    s_waitcnt lgkmcnt(0)
    buffer_load_dword v4, v12, s[4:7], s41 offen sc1
    s_waitcnt vmcnt(0)
    s_memtime s[52:53]
    s_waitcnt lgkmcnt(0)
    s_sub_u32 s52, s52, s50
    s_min_u32 s48, s48, s52
    s_add_u32 s41, s40, 24576
    s_memtime s[50:51]
    s_waitcnt lgkmcnt(0)
    buffer_load_dword v4, v12, s[4:7], s41 offen sc1
    s_waitcnt vmcnt(0)
    s_memtime s[52:53]
    s_waitcnt lgkmcnt(0)
    s_sub_u32 s52, s52, s50
    s_min_u32 s49, s49, s52
    s_add_u32 s40, s40, 2048
    s_add_u32 s42, s42, 1
    s_cmp_lt_u32 s42, 3
    s_cbranch_scc1 cal_53
    v_mov_b32 v4, s46
    v_mov_b32 v5, s47
    v_mov_b32 v6, s48
    v_mov_b32 v7, s49
    s_lshl_b32 s40, s23, 4
    v_mov_b32 v2, s40
    ds_write_b128 v2, v[4:7]
    s_waitcnt lgkmcnt(0)
    s_barrier
ncal_52:
ws_54:
    v_mov_b32 v30, 0
    buffer_load_dword v31, v30, s[16:19], s28 offen offset:128 sc1
    s_waitcnt vmcnt(0)
wsc_56:
    v_readfirstlane_b32 s40, v31
    s_nop 0
    s_cmp_lt_i32 s40, 0
    s_cbranch_scc1 L_restart
    s_cmp_lg_u32 s40, 0
    s_cbranch_scc1 wsd_55
    s_sleep 4
    s_add_u32 s27, s27, 1
    s_cmp_lt_u32 s27, 131072
    s_cbranch_scc1 ws_54
    s_branch L_abort
wsd_55:
    s_bfe_u32 s41, s40, 0x40010
    s_cmp_ge_u32 s41, 5
    s_cselect_b32 s28, 1, 0
    s_bfe_u32 s41, s40, 0x40018
    s_cmp_ge_u32 s41, 5
    s_cselect_b32 s41, 1, 0
    s_xor_b32 s3, s20, s41
    s_and_b32 s3, s3, 1
    s_lshl_b32 s3, s3, 14
    s_lshl_b32 s40, s23, 8
    s_add_u32 s3, s3, s40
    s_lshr_b32 s40, s20, 1
    s_lshl_b32 s40, s40, 7
    s_add_u32 s3, s3, s40
    s_add_u32 s3, s3, 327680
    v_bfe_u32 v3, v1, 4, 1
    v_xor_b32 v3, s41, v3
    v_lshlrev_b32 v3, 14, v3
    v_lshrrev_b32 v30, 5, v1
    v_lshl_add_u32 v3, v30, 7, v3
    s_lshl_b32 s40, s21, 2
    s_add_u32 s40, s40, s23
    s_cmp_eq_u32 s40, 66
    s_cselect_b32 s30, 0x10001, 0
    s_mov_b32 s31, s30
    s_lshl_b32 s33, s20, 8
    s_add_u32 s33, s33, 327680
    v_and_b32 v9, 31, v1
    v_lshlrev_b32 v9, 7, v9
    v_and_b32 v11, 7, v1
    v_lshlrev_b32 v11, 7, v11
    v_mov_b32 v12, 0
    s_mov_b32 s26, s22
    s_add_u32 s32, s3, 1024
    s_mul_i32 s25, s20, 10
    s_add_u32 s25, s25, s21
    s_sub_u32 s25, s25, 16
    v_lshlrev_b32 v2, 4, v1
    v_mov_b32 v4, -1
    v_mov_b32 v5, -1
    v_mov_b32 v6, -1
    v_mov_b32 v7, -1
    s_lshr_b32 s40, s20, 1
    s_mul_i32 s40, s40, 10
    s_add_u32 s40, s40, s21
    s_add_u32 s40, s40, -4
    s_lshl_b32 s38, s40, 15
    s_lshr_b32 s40, s40, 4
    s_lshl_b32 s40, s40, 14
    s_xor_b32 s40, s40, s3
    s_and_b32 s40, s40, 0x4000
    s_or_b32 s38, s38, s40
    s_and_b32 s40, s23, 1
    s_lshl_b32 s40, s40, 12
    s_add_u32 s38, s38, s40
    s_lshr_b32 s39, s25, 2
    s_add_u32 s39, s39, 100
    s_lshl_b32 s39, s39, 14
    s_and_b32 s40, s25, 3
    s_lshl_b32 s40, s40, 11
    s_add_u32 s39, s39, s40
    s_lshr_b32 s40, s25, 3
    s_lshl_b32 s40, s40, 15
    s_and_b32 s41, s25, 7
    s_lshl_b32 s42, s41, 8
    s_add_u32 s42, s42, s40
    s_lshl_b32 s43, s41, 9
    s_add_u32 s43, s43, s40
    s_add_u32 s43, s43, 163328
    v_and_b32 v8, 255, v2
    v_add_u32 v8, s42, v8
    v_add_u32 v10, s43, v2
    v_cmp_gt_u32 vcc, 32, v1
    s_nop 1
    v_cndmask_b32 v8, v10, v8, vcc
.p2align 6
L_PF_loop:
    s_add_u32 s40, s26, 0
    s_xor_b32 s41, s40, s28
    s_and_b32 s41, s41, 1
    s_lshl_b32 s41, s41, 13
    s_lshr_b32 s40, s40, 1
    s_lshl_b32 s40, s40, 22
    s_add_u32 s40, s40, 37748736
    s_or_b32 s36, s40, s41
    s_add_u32 s36, s36, 1802240
    s_add_u32 s34, s36, 4096
    v_mov_b32 v25, 0
    s_cmp_lg_u32 s23, 3
    s_cbranch_scc1 n3_58
    buffer_load_dword v25, v11, s[4:7], s34 offen sc1
    s_cmp_lg_u32 s26, 63
    s_cbranch_scc1 n3_58
    buffer_load_dword v25, v11, s[4:7], s34 offen sc1
.p2align 6
poll_59:
    s_waitcnt vmcnt(0)
    v_cmp_eq_u32 vcc, -1, v25
    s_cbranch_vccz pd_60
    s_sleep 2
    buffer_load_dword v25, v11, s[4:7], s34 offen sc1
    s_add_u32 s27, s27, 1
    s_cmp_lt_u32 s27, 131072
    s_cbranch_scc1 poll_59
    s_branch L_abort
.p2align 6
pd_60:
n3_58:
    s_cmp_lg_u32 s23, 1
    s_cbranch_scc1 nv_57
    buffer_load_dword v24, v9, s[4:7], s36 offen sc1
.p2align 6
poll_61:
    s_waitcnt vmcnt(0)
    v_cmp_eq_u32 vcc, -1, v24
    s_cbranch_vccz pd_62
    s_sleep 2
    buffer_load_dword v24, v9, s[4:7], s36 offen sc1
    s_add_u32 s27, s27, 1
    s_cmp_lt_u32 s27, 131072
    s_cbranch_scc1 poll_61
    s_branch L_abort
.p2align 6
pd_62:
nv_57:
    s_add_u32 s40, s26, 0
    s_lshr_b32 s41, s40, 2
    s_xor_b32 s41, s41, s40
    s_xor_b32 s41, s41, s28
    s_and_b32 s41, s41, 1
    s_lshl_b32 s41, s41, 13
    s_lshr_b32 s40, s40, 1
    s_lshl_b32 s40, s40, 20
    s_or_b32 s35, s40, s41
    s_add_u32 s40, s26, 1
    s_lshr_b32 s41, s40, 2
    s_xor_b32 s41, s41, s40
    s_xor_b32 s41, s41, s28
    s_and_b32 s41, s41, 1
    s_lshl_b32 s41, s41, 13
    s_lshr_b32 s40, s40, 1
    s_lshl_b32 s40, s40, 20
    s_or_b32 s37, s40, s41
    s_add_u32 s35, s35, s32
    s_add_u32 s37, s37, s33
    s_barrier
    s_barrier
    buffer_load_dword v20, v12, s[4:7], s35 offen sc1
    s_nop 15
    buffer_load_dword v21, v12, s[4:7], s35 offen sc1
    s_nop 15
    buffer_load_dword v22, v12, s[4:7], s35 offen sc1
.p2align 6
poll_63:
    s_waitcnt vmcnt(2)
    v_cmp_eq_u32 vcc, -1, v20
    s_cbranch_vccz pd_64
    buffer_load_dword v20, v12, s[4:7], s35 offen sc1
    s_waitcnt vmcnt(2)
    v_cmp_eq_u32 vcc, -1, v21
    s_cbranch_vccz pd_64
    buffer_load_dword v21, v12, s[4:7], s35 offen sc1
    s_waitcnt vmcnt(2)
    v_cmp_eq_u32 vcc, -1, v22
    s_cbranch_vccz pd_64
    buffer_load_dword v22, v12, s[4:7], s35 offen sc1
    s_add_u32 s27, s27, 1
    s_cmp_lt_u32 s27, 131072
    s_cbranch_scc1 poll_63
    s_branch L_abort
.p2align 6
pd_64:
    s_barrier
    s_add_u32 s35, s35, 1024
    s_mov_b64 exec, s[30:31]
    s_barrier
    buffer_store_dword v12, v3, s[4:7], s37 offen sc1
    s_mov_b64 exec, -1
    v_cmp_eq_u32 vcc, -1, v25
    s_cbranch_vccz n4_65
    buffer_load_dword v25, v11, s[4:7], s34 offen sc1
.p2align 6
poll_66:
    s_waitcnt vmcnt(0)
    v_cmp_eq_u32 vcc, -1, v25
    s_cbranch_vccz pd_67
    s_sleep 2
    buffer_load_dword v25, v11, s[4:7], s34 offen sc1
    s_add_u32 s27, s27, 1
    s_cmp_lt_u32 s27, 131072
    s_cbranch_scc1 poll_66
    s_branch L_abort
.p2align 6
pd_67:
n4_65:
    s_barrier
    s_cmp_ge_u32 s26, 60
    s_cbranch_scc1 c3_70
    s_add_u32 s40, s26, 4
    s_lshr_b32 s41, s40, 2
    s_xor_b32 s41, s41, s40
    s_xor_b32 s41, s41, s28
    s_and_b32 s41, s41, 1
    s_lshl_b32 s41, s41, 13
    s_lshr_b32 s40, s40, 1
    s_lshl_b32 s40, s40, 20
    s_or_b32 s36, s40, s41
    s_cmp_eq_u32 s23, 1
    s_cbranch_scc1 c1_68
    s_add_u32 s36, s36, s38
    buffer_store_dwordx4 v[4:7], v2, s[4:7], s36 offen offset:0 sc1
    buffer_store_dwordx4 v[4:7], v2, s[4:7], s36 offen offset:1024 sc1
    buffer_store_dwordx4 v[4:7], v2, s[4:7], s36 offen offset:2048 sc1
    buffer_store_dwordx4 v[4:7], v2, s[4:7], s36 offen offset:3072 sc1
    s_branch c2_69
c1_68:
    buffer_store_dwordx4 v[4:7], v8, s[4:7], s36 offen sc1
    s_add_u32 s36, s36, 16384
    buffer_store_dwordx4 v[4:7], v8, s[4:7], s36 offen sc1
    s_add_u32 s40, s26, 4
    s_xor_b32 s41, s40, s28
    s_and_b32 s41, s41, 1
    s_lshl_b32 s41, s41, 13
    s_lshr_b32 s40, s40, 1
    s_lshl_b32 s40, s40, 22
    s_add_u32 s40, s40, 37748736
    s_or_b32 s36, s40, s41
    s_add_u32 s36, s36, s39
    buffer_store_dwordx4 v[4:7], v2, s[4:7], s36 offen offset:0 sc1
    buffer_store_dwordx4 v[4:7], v2, s[4:7], s36 offen offset:1024 sc1
c2_69:
    s_waitcnt vmcnt(0)
c3_70:
    buffer_load_dword v20, v12, s[4:7], s35 offen sc1
    s_nop 15
    buffer_load_dword v21, v12, s[4:7], s35 offen sc1
    s_nop 15
    buffer_load_dword v22, v12, s[4:7], s35 offen sc1
.p2align 6
poll_71:
    s_waitcnt vmcnt(2)
    v_cmp_eq_u32 vcc, -1, v20
    s_cbranch_vccz pd_72
    buffer_load_dword v20, v12, s[4:7], s35 offen sc1
    s_waitcnt vmcnt(2)
    v_cmp_eq_u32 vcc, -1, v21
    s_cbranch_vccz pd_72
    buffer_load_dword v21, v12, s[4:7], s35 offen sc1
    s_waitcnt vmcnt(2)
    v_cmp_eq_u32 vcc, -1, v22
    s_cbranch_vccz pd_72
    buffer_load_dword v22, v12, s[4:7], s35 offen sc1
    s_add_u32 s27, s27, 1
    s_cmp_lt_u32 s27, 131072
    s_cbranch_scc1 poll_71
    s_branch L_abort
.p2align 6
pd_72:
    s_barrier
    s_barrier
    s_add_u32 s26, s26, 2
    s_cmp_lt_u32 s26, 64
    s_cbranch_scc1 L_PF_loop
    s_branch L_end
L_hot_end:
L_LN:
    s_and_b32 s40, s2, 7
    s_lshl_b32 s40, s40, 2
    s_add_u32 s40, s40, s21
    s_sub_u32 s40, s40, 28
    s_lshl_b32 s40, s40, 2
    s_add_u32 s42, s40, s23
    v_and_b32 v2, 15, v1
    v_lshrrev_b32 v3, 4, v1
    v_mul_u32_u24 v2, 1280, v2
    v_lshl_add_u32 v2, v3, 4, v2
    s_mul_i32 s43, s42, 20480
    s_waitcnt lgkmcnt(0)
    s_mov_b32 s8, s12
    s_mov_b32 s9, s13
    s_mov_b32 s10, 2621440
    s_mov_b32 s11, 0x20000
    s_mov_b32 s12, s14
    s_mov_b32 s13, s15
    s_mov_b32 s14, 10240
    s_mov_b32 s15, 0x20000
    s_add_u32 s4, s4, 0x3fffff
    s_addc_u32 s5, s5, 0
    s_and_b32 s4, s4, 0xffc00000
    buffer_load_dwordx4 v[8:11], v2, s[8:11], s43 offen offset:0
    buffer_load_dwordx4 v[12:15], v2, s[8:11], s43 offen offset:64
    buffer_load_dwordx4 v[16:19], v2, s[8:11], s43 offen offset:128
    buffer_load_dwordx4 v[20:23], v2, s[8:11], s43 offen offset:192
    buffer_load_dwordx4 v[24:27], v2, s[8:11], s43 offen offset:256
    buffer_load_dwordx4 v[28:31], v2, s[8:11], s43 offen offset:320
    buffer_load_dwordx4 v[32:35], v2, s[8:11], s43 offen offset:384
    buffer_load_dwordx4 v[36:39], v2, s[8:11], s43 offen offset:448
    buffer_load_dwordx4 v[40:43], v2, s[8:11], s43 offen offset:512
    buffer_load_dwordx4 v[44:47], v2, s[8:11], s43 offen offset:576
    buffer_load_dwordx4 v[48:51], v2, s[8:11], s43 offen offset:640
    buffer_load_dwordx4 v[52:55], v2, s[8:11], s43 offen offset:704
    buffer_load_dwordx4 v[56:59], v2, s[8:11], s43 offen offset:768
    buffer_load_dwordx4 v[60:63], v2, s[8:11], s43 offen offset:832
    buffer_load_dwordx4 v[64:67], v2, s[8:11], s43 offen offset:896
    buffer_load_dwordx4 v[68:71], v2, s[8:11], s43 offen offset:960
    buffer_load_dwordx4 v[72:75], v2, s[8:11], s43 offen offset:1024
    buffer_load_dwordx4 v[76:79], v2, s[8:11], s43 offen offset:1088
    buffer_load_dwordx4 v[80:83], v2, s[8:11], s43 offen offset:1152
    buffer_load_dwordx4 v[84:87], v2, s[8:11], s43 offen offset:1216
    v_mov_b64 v[4:5], 0
    s_mov_b32 s44, 0xffff0000
    s_waitcnt vmcnt(19)
    v_lshlrev_b32 v88, 16, v8
    v_and_b32 v89, s44, v8
    v_pk_add_f32 v[4:5], v[4:5], v[88:89]
    v_lshlrev_b32 v90, 16, v9
    v_and_b32 v91, s44, v9
    v_pk_add_f32 v[4:5], v[4:5], v[90:91]
    v_lshlrev_b32 v92, 16, v10
    v_and_b32 v93, s44, v10
    v_pk_add_f32 v[4:5], v[4:5], v[92:93]
    v_lshlrev_b32 v94, 16, v11
    v_and_b32 v95, s44, v11
    v_pk_add_f32 v[4:5], v[4:5], v[94:95]
    s_waitcnt vmcnt(18)
    v_lshlrev_b32 v96, 16, v12
    v_and_b32 v97, s44, v12
    v_pk_add_f32 v[4:5], v[4:5], v[96:97]
    v_lshlrev_b32 v98, 16, v13
    v_and_b32 v99, s44, v13
    v_pk_add_f32 v[4:5], v[4:5], v[98:99]
    v_lshlrev_b32 v100, 16, v14
    v_and_b32 v101, s44, v14
    v_pk_add_f32 v[4:5], v[4:5], v[100:101]
    v_lshlrev_b32 v102, 16, v15
    v_and_b32 v103, s44, v15
    v_pk_add_f32 v[4:5], v[4:5], v[102:103]
    s_waitcnt vmcnt(17)
    v_lshlrev_b32 v104, 16, v16
    v_and_b32 v105, s44, v16
    v_pk_add_f32 v[4:5], v[4:5], v[104:105]
    v_lshlrev_b32 v106, 16, v17
    v_and_b32 v107, s44, v17
    v_pk_add_f32 v[4:5], v[4:5], v[106:107]
    v_lshlrev_b32 v108, 16, v18
    v_and_b32 v109, s44, v18
    v_pk_add_f32 v[4:5], v[4:5], v[108:109]
    v_lshlrev_b32 v110, 16, v19
    v_and_b32 v111, s44, v19
    v_pk_add_f32 v[4:5], v[4:5], v[110:111]
    s_waitcnt vmcnt(16)
    v_lshlrev_b32 v112, 16, v20
    v_and_b32 v113, s44, v20
    v_pk_add_f32 v[4:5], v[4:5], v[112:113]
    v_lshlrev_b32 v114, 16, v21
    v_and_b32 v115, s44, v21
    v_pk_add_f32 v[4:5], v[4:5], v[114:115]
    v_lshlrev_b32 v116, 16, v22
    v_and_b32 v117, s44, v22
    v_pk_add_f32 v[4:5], v[4:5], v[116:117]
    v_lshlrev_b32 v118, 16, v23
    v_and_b32 v119, s44, v23
    v_pk_add_f32 v[4:5], v[4:5], v[118:119]
    s_waitcnt vmcnt(15)
    v_lshlrev_b32 v120, 16, v24
    v_and_b32 v121, s44, v24
    v_pk_add_f32 v[4:5], v[4:5], v[120:121]
    v_lshlrev_b32 v122, 16, v25
    v_and_b32 v123, s44, v25
    v_pk_add_f32 v[4:5], v[4:5], v[122:123]
    v_lshlrev_b32 v124, 16, v26
    v_and_b32 v125, s44, v26
    v_pk_add_f32 v[4:5], v[4:5], v[124:125]
    v_lshlrev_b32 v126, 16, v27
    v_and_b32 v127, s44, v27
    v_pk_add_f32 v[4:5], v[4:5], v[126:127]
    s_waitcnt vmcnt(14)
    v_lshlrev_b32 v128, 16, v28
    v_and_b32 v129, s44, v28
    v_pk_add_f32 v[4:5], v[4:5], v[128:129]
    v_lshlrev_b32 v130, 16, v29
    v_and_b32 v131, s44, v29
    v_pk_add_f32 v[4:5], v[4:5], v[130:131]
    v_lshlrev_b32 v132, 16, v30
    v_and_b32 v133, s44, v30
    v_pk_add_f32 v[4:5], v[4:5], v[132:133]
    v_lshlrev_b32 v134, 16, v31
    v_and_b32 v135, s44, v31
    v_pk_add_f32 v[4:5], v[4:5], v[134:135]
    s_waitcnt vmcnt(13)
    v_lshlrev_b32 v136, 16, v32
    v_and_b32 v137, s44, v32
    v_pk_add_f32 v[4:5], v[4:5], v[136:137]
    v_lshlrev_b32 v138, 16, v33
    v_and_b32 v139, s44, v33
    v_pk_add_f32 v[4:5], v[4:5], v[138:139]
    v_lshlrev_b32 v140, 16, v34
    v_and_b32 v141, s44, v34
    v_pk_add_f32 v[4:5], v[4:5], v[140:141]
    v_lshlrev_b32 v142, 16, v35
    v_and_b32 v143, s44, v35
    v_pk_add_f32 v[4:5], v[4:5], v[142:143]
    s_waitcnt vmcnt(12)
    v_lshlrev_b32 v144, 16, v36
    v_and_b32 v145, s44, v36
    v_pk_add_f32 v[4:5], v[4:5], v[144:145]
    v_lshlrev_b32 v146, 16, v37
    v_and_b32 v147, s44, v37
    v_pk_add_f32 v[4:5], v[4:5], v[146:147]
    v_lshlrev_b32 v148, 16, v38
    v_and_b32 v149, s44, v38
    v_pk_add_f32 v[4:5], v[4:5], v[148:149]
    v_lshlrev_b32 v150, 16, v39
    v_and_b32 v151, s44, v39
    v_pk_add_f32 v[4:5], v[4:5], v[150:151]
    s_waitcnt vmcnt(11)
    v_lshlrev_b32 v152, 16, v40
    v_and_b32 v153, s44, v40
    v_pk_add_f32 v[4:5], v[4:5], v[152:153]
    v_lshlrev_b32 v154, 16, v41
    v_and_b32 v155, s44, v41
    v_pk_add_f32 v[4:5], v[4:5], v[154:155]
    v_lshlrev_b32 v156, 16, v42
    v_and_b32 v157, s44, v42
    v_pk_add_f32 v[4:5], v[4:5], v[156:157]
    v_lshlrev_b32 v158, 16, v43
    v_and_b32 v159, s44, v43
    v_pk_add_f32 v[4:5], v[4:5], v[158:159]
    s_waitcnt vmcnt(10)
    v_lshlrev_b32 v160, 16, v44
    v_and_b32 v161, s44, v44
    v_pk_add_f32 v[4:5], v[4:5], v[160:161]
    v_lshlrev_b32 v162, 16, v45
    v_and_b32 v163, s44, v45
    v_pk_add_f32 v[4:5], v[4:5], v[162:163]
    v_lshlrev_b32 v164, 16, v46
    v_and_b32 v165, s44, v46
    v_pk_add_f32 v[4:5], v[4:5], v[164:165]
    v_lshlrev_b32 v166, 16, v47
    v_and_b32 v167, s44, v47
    v_pk_add_f32 v[4:5], v[4:5], v[166:167]
    s_waitcnt vmcnt(9)
    v_lshlrev_b32 v168, 16, v48
    v_and_b32 v169, s44, v48
    v_pk_add_f32 v[4:5], v[4:5], v[168:169]
    v_lshlrev_b32 v170, 16, v49
    v_and_b32 v171, s44, v49
    v_pk_add_f32 v[4:5], v[4:5], v[170:171]
    v_lshlrev_b32 v172, 16, v50
    v_and_b32 v173, s44, v50
    v_pk_add_f32 v[4:5], v[4:5], v[172:173]
    v_lshlrev_b32 v174, 16, v51
    v_and_b32 v175, s44, v51
    v_pk_add_f32 v[4:5], v[4:5], v[174:175]
    s_waitcnt vmcnt(8)
    v_lshlrev_b32 v176, 16, v52
    v_and_b32 v177, s44, v52
    v_pk_add_f32 v[4:5], v[4:5], v[176:177]
    v_lshlrev_b32 v178, 16, v53
    v_and_b32 v179, s44, v53
    v_pk_add_f32 v[4:5], v[4:5], v[178:179]
    v_lshlrev_b32 v180, 16, v54
    v_and_b32 v181, s44, v54
    v_pk_add_f32 v[4:5], v[4:5], v[180:181]
    v_lshlrev_b32 v182, 16, v55
    v_and_b32 v183, s44, v55
    v_pk_add_f32 v[4:5], v[4:5], v[182:183]
    s_waitcnt vmcnt(7)
    v_lshlrev_b32 v184, 16, v56
    v_and_b32 v185, s44, v56
    v_pk_add_f32 v[4:5], v[4:5], v[184:185]
    v_lshlrev_b32 v186, 16, v57
    v_and_b32 v187, s44, v57
    v_pk_add_f32 v[4:5], v[4:5], v[186:187]
    v_lshlrev_b32 v188, 16, v58
    v_and_b32 v189, s44, v58
    v_pk_add_f32 v[4:5], v[4:5], v[188:189]
    v_lshlrev_b32 v190, 16, v59
    v_and_b32 v191, s44, v59
    v_pk_add_f32 v[4:5], v[4:5], v[190:191]
    s_waitcnt vmcnt(6)
    v_lshlrev_b32 v192, 16, v60
    v_and_b32 v193, s44, v60
    v_pk_add_f32 v[4:5], v[4:5], v[192:193]
    v_lshlrev_b32 v194, 16, v61
    v_and_b32 v195, s44, v61
    v_pk_add_f32 v[4:5], v[4:5], v[194:195]
    v_lshlrev_b32 v196, 16, v62
    v_and_b32 v197, s44, v62
    v_pk_add_f32 v[4:5], v[4:5], v[196:197]
    v_lshlrev_b32 v198, 16, v63
    v_and_b32 v199, s44, v63
    v_pk_add_f32 v[4:5], v[4:5], v[198:199]
    s_waitcnt vmcnt(5)
    v_lshlrev_b32 v200, 16, v64
    v_and_b32 v201, s44, v64
    v_pk_add_f32 v[4:5], v[4:5], v[200:201]
    v_lshlrev_b32 v202, 16, v65
    v_and_b32 v203, s44, v65
    v_pk_add_f32 v[4:5], v[4:5], v[202:203]
    v_lshlrev_b32 v204, 16, v66
    v_and_b32 v205, s44, v66
    v_pk_add_f32 v[4:5], v[4:5], v[204:205]
    v_lshlrev_b32 v206, 16, v67
    v_and_b32 v207, s44, v67
    v_pk_add_f32 v[4:5], v[4:5], v[206:207]
    s_waitcnt vmcnt(4)
    v_lshlrev_b32 v208, 16, v68
    v_and_b32 v209, s44, v68
    v_pk_add_f32 v[4:5], v[4:5], v[208:209]
    v_lshlrev_b32 v210, 16, v69
    v_and_b32 v211, s44, v69
    v_pk_add_f32 v[4:5], v[4:5], v[210:211]
    v_lshlrev_b32 v212, 16, v70
    v_and_b32 v213, s44, v70
    v_pk_add_f32 v[4:5], v[4:5], v[212:213]
    v_lshlrev_b32 v214, 16, v71
    v_and_b32 v215, s44, v71
    v_pk_add_f32 v[4:5], v[4:5], v[214:215]
    s_waitcnt vmcnt(3)
    v_lshlrev_b32 v216, 16, v72
    v_and_b32 v217, s44, v72
    v_pk_add_f32 v[4:5], v[4:5], v[216:217]
    v_lshlrev_b32 v218, 16, v73
    v_and_b32 v219, s44, v73
    v_pk_add_f32 v[4:5], v[4:5], v[218:219]
    v_lshlrev_b32 v220, 16, v74
    v_and_b32 v221, s44, v74
    v_pk_add_f32 v[4:5], v[4:5], v[220:221]
    v_lshlrev_b32 v222, 16, v75
    v_and_b32 v223, s44, v75
    v_pk_add_f32 v[4:5], v[4:5], v[222:223]
    s_waitcnt vmcnt(2)
    v_lshlrev_b32 v224, 16, v76
    v_and_b32 v225, s44, v76
    v_pk_add_f32 v[4:5], v[4:5], v[224:225]
    v_lshlrev_b32 v226, 16, v77
    v_and_b32 v227, s44, v77
    v_pk_add_f32 v[4:5], v[4:5], v[226:227]
    v_lshlrev_b32 v228, 16, v78
    v_and_b32 v229, s44, v78
    v_pk_add_f32 v[4:5], v[4:5], v[228:229]
    v_lshlrev_b32 v230, 16, v79
    v_and_b32 v231, s44, v79
    v_pk_add_f32 v[4:5], v[4:5], v[230:231]
    s_waitcnt vmcnt(1)
    v_lshlrev_b32 v232, 16, v80
    v_and_b32 v233, s44, v80
    v_pk_add_f32 v[4:5], v[4:5], v[232:233]
    v_lshlrev_b32 v234, 16, v81
    v_and_b32 v235, s44, v81
    v_pk_add_f32 v[4:5], v[4:5], v[234:235]
    v_lshlrev_b32 v236, 16, v82
    v_and_b32 v237, s44, v82
    v_pk_add_f32 v[4:5], v[4:5], v[236:237]
    v_lshlrev_b32 v238, 16, v83
    v_and_b32 v239, s44, v83
    v_pk_add_f32 v[4:5], v[4:5], v[238:239]
    s_waitcnt vmcnt(0)
    v_lshlrev_b32 v240, 16, v84
    v_and_b32 v241, s44, v84
    v_pk_add_f32 v[4:5], v[4:5], v[240:241]
    v_lshlrev_b32 v242, 16, v85
    v_and_b32 v243, s44, v85
    v_pk_add_f32 v[4:5], v[4:5], v[242:243]
    v_lshlrev_b32 v244, 16, v86
    v_and_b32 v245, s44, v86
    v_pk_add_f32 v[4:5], v[4:5], v[244:245]
    v_lshlrev_b32 v246, 16, v87
    v_and_b32 v247, s44, v87
    v_pk_add_f32 v[4:5], v[4:5], v[246:247]
    v_add_f32 v4, v4, v5
    v_mov_b32 v5, v4
    s_nop 1
    v_permlane16_swap_b32 v4, v5
    v_add_f32 v4, v4, v5
    v_mov_b32 v5, v4
    s_nop 1
    v_permlane32_swap_b32 v4, v5
    v_add_f32 v4, v4, v5
    v_mul_f32 v4, 986500301, v4
    v_mov_b64 v[6:7], 0
    v_pk_add_f32 v[248:249], v[88:89], v[4:5] op_sel_hi:[1,0] neg_lo:[0,1] neg_hi:[0,1]
    v_pk_fma_f32 v[6:7], v[248:249], v[248:249], v[6:7]
    v_pk_add_f32 v[248:249], v[90:91], v[4:5] op_sel_hi:[1,0] neg_lo:[0,1] neg_hi:[0,1]
    v_pk_fma_f32 v[6:7], v[248:249], v[248:249], v[6:7]
    v_pk_add_f32 v[248:249], v[92:93], v[4:5] op_sel_hi:[1,0] neg_lo:[0,1] neg_hi:[0,1]
    v_pk_fma_f32 v[6:7], v[248:249], v[248:249], v[6:7]
    v_pk_add_f32 v[248:249], v[94:95], v[4:5] op_sel_hi:[1,0] neg_lo:[0,1] neg_hi:[0,1]
    v_pk_fma_f32 v[6:7], v[248:249], v[248:249], v[6:7]
    v_pk_add_f32 v[248:249], v[96:97], v[4:5] op_sel_hi:[1,0] neg_lo:[0,1] neg_hi:[0,1]
    v_pk_fma_f32 v[6:7], v[248:249], v[248:249], v[6:7]
    v_pk_add_f32 v[248:249], v[98:99], v[4:5] op_sel_hi:[1,0] neg_lo:[0,1] neg_hi:[0,1]
    v_pk_fma_f32 v[6:7], v[248:249], v[248:249], v[6:7]
    v_pk_add_f32 v[248:249], v[100:101], v[4:5] op_sel_hi:[1,0] neg_lo:[0,1] neg_hi:[0,1]
    v_pk_fma_f32 v[6:7], v[248:249], v[248:249], v[6:7]
    v_pk_add_f32 v[248:249], v[102:103], v[4:5] op_sel_hi:[1,0] neg_lo:[0,1] neg_hi:[0,1]
    v_pk_fma_f32 v[6:7], v[248:249], v[248:249], v[6:7]
    v_pk_add_f32 v[248:249], v[104:105], v[4:5] op_sel_hi:[1,0] neg_lo:[0,1] neg_hi:[0,1]
    v_pk_fma_f32 v[6:7], v[248:249], v[248:249], v[6:7]
    v_pk_add_f32 v[248:249], v[106:107], v[4:5] op_sel_hi:[1,0] neg_lo:[0,1] neg_hi:[0,1]
    v_pk_fma_f32 v[6:7], v[248:249], v[248:249], v[6:7]
    v_pk_add_f32 v[248:249], v[108:109], v[4:5] op_sel_hi:[1,0] neg_lo:[0,1] neg_hi:[0,1]
    v_pk_fma_f32 v[6:7], v[248:249], v[248:249], v[6:7]
    v_pk_add_f32 v[248:249], v[110:111], v[4:5] op_sel_hi:[1,0] neg_lo:[0,1] neg_hi:[0,1]
    v_pk_fma_f32 v[6:7], v[248:249], v[248:249], v[6:7]
    v_pk_add_f32 v[248:249], v[112:113], v[4:5] op_sel_hi:[1,0] neg_lo:[0,1] neg_hi:[0,1]
    v_pk_fma_f32 v[6:7], v[248:249], v[248:249], v[6:7]
    v_pk_add_f32 v[248:249], v[114:115], v[4:5] op_sel_hi:[1,0] neg_lo:[0,1] neg_hi:[0,1]
    v_pk_fma_f32 v[6:7], v[248:249], v[248:249], v[6:7]
    v_pk_add_f32 v[248:249], v[116:117], v[4:5] op_sel_hi:[1,0] neg_lo:[0,1] neg_hi:[0,1]
    v_pk_fma_f32 v[6:7], v[248:249], v[248:249], v[6:7]
    v_pk_add_f32 v[248:249], v[118:119], v[4:5] op_sel_hi:[1,0] neg_lo:[0,1] neg_hi:[0,1]
    v_pk_fma_f32 v[6:7], v[248:249], v[248:249], v[6:7]
    v_pk_add_f32 v[248:249], v[120:121], v[4:5] op_sel_hi:[1,0] neg_lo:[0,1] neg_hi:[0,1]
    v_pk_fma_f32 v[6:7], v[248:249], v[248:249], v[6:7]
    v_pk_add_f32 v[248:249], v[122:123], v[4:5] op_sel_hi:[1,0] neg_lo:[0,1] neg_hi:[0,1]
    v_pk_fma_f32 v[6:7], v[248:249], v[248:249], v[6:7]
    v_pk_add_f32 v[248:249], v[124:125], v[4:5] op_sel_hi:[1,0] neg_lo:[0,1] neg_hi:[0,1]
    v_pk_fma_f32 v[6:7], v[248:249], v[248:249], v[6:7]
    v_pk_add_f32 v[248:249], v[126:127], v[4:5] op_sel_hi:[1,0] neg_lo:[0,1] neg_hi:[0,1]
    v_pk_fma_f32 v[6:7], v[248:249], v[248:249], v[6:7]
    v_pk_add_f32 v[248:249], v[128:129], v[4:5] op_sel_hi:[1,0] neg_lo:[0,1] neg_hi:[0,1]
    v_pk_fma_f32 v[6:7], v[248:249], v[248:249], v[6:7]
    v_pk_add_f32 v[248:249], v[130:131], v[4:5] op_sel_hi:[1,0] neg_lo:[0,1] neg_hi:[0,1]
    v_pk_fma_f32 v[6:7], v[248:249], v[248:249], v[6:7]
    v_pk_add_f32 v[248:249], v[132:133], v[4:5] op_sel_hi:[1,0] neg_lo:[0,1] neg_hi:[0,1]
    v_pk_fma_f32 v[6:7], v[248:249], v[248:249], v[6:7]
    v_pk_add_f32 v[248:249], v[134:135], v[4:5] op_sel_hi:[1,0] neg_lo:[0,1] neg_hi:[0,1]
    v_pk_fma_f32 v[6:7], v[248:249], v[248:249], v[6:7]
    v_pk_add_f32 v[248:249], v[136:137], v[4:5] op_sel_hi:[1,0] neg_lo:[0,1] neg_hi:[0,1]
    v_pk_fma_f32 v[6:7], v[248:249], v[248:249], v[6:7]
    v_pk_add_f32 v[248:249], v[138:139], v[4:5] op_sel_hi:[1,0] neg_lo:[0,1] neg_hi:[0,1]
    v_pk_fma_f32 v[6:7], v[248:249], v[248:249], v[6:7]
    v_pk_add_f32 v[248:249], v[140:141], v[4:5] op_sel_hi:[1,0] neg_lo:[0,1] neg_hi:[0,1]
    v_pk_fma_f32 v[6:7], v[248:249], v[248:249], v[6:7]
    v_pk_add_f32 v[248:249], v[142:143], v[4:5] op_sel_hi:[1,0] neg_lo:[0,1] neg_hi:[0,1]
    v_pk_fma_f32 v[6:7], v[248:249], v[248:249], v[6:7]
    v_pk_add_f32 v[248:249], v[144:145], v[4:5] op_sel_hi:[1,0] neg_lo:[0,1] neg_hi:[0,1]
    v_pk_fma_f32 v[6:7], v[248:249], v[248:249], v[6:7]
    v_pk_add_f32 v[248:249], v[146:147], v[4:5] op_sel_hi:[1,0] neg_lo:[0,1] neg_hi:[0,1]
    v_pk_fma_f32 v[6:7], v[248:249], v[248:249], v[6:7]
    v_pk_add_f32 v[248:249], v[148:149], v[4:5] op_sel_hi:[1,0] neg_lo:[0,1] neg_hi:[0,1]
    v_pk_fma_f32 v[6:7], v[248:249], v[248:249], v[6:7]
    v_pk_add_f32 v[248:249], v[150:151], v[4:5] op_sel_hi:[1,0] neg_lo:[0,1] neg_hi:[0,1]
    v_pk_fma_f32 v[6:7], v[248:249], v[248:249], v[6:7]
    v_pk_add_f32 v[248:249], v[152:153], v[4:5] op_sel_hi:[1,0] neg_lo:[0,1] neg_hi:[0,1]
    v_pk_fma_f32 v[6:7], v[248:249], v[248:249], v[6:7]
    v_pk_add_f32 v[248:249], v[154:155], v[4:5] op_sel_hi:[1,0] neg_lo:[0,1] neg_hi:[0,1]
    v_pk_fma_f32 v[6:7], v[248:249], v[248:249], v[6:7]
    v_pk_add_f32 v[248:249], v[156:157], v[4:5] op_sel_hi:[1,0] neg_lo:[0,1] neg_hi:[0,1]
    v_pk_fma_f32 v[6:7], v[248:249], v[248:249], v[6:7]
    v_pk_add_f32 v[248:249], v[158:159], v[4:5] op_sel_hi:[1,0] neg_lo:[0,1] neg_hi:[0,1]
    v_pk_fma_f32 v[6:7], v[248:249], v[248:249], v[6:7]
    v_pk_add_f32 v[248:249], v[160:161], v[4:5] op_sel_hi:[1,0] neg_lo:[0,1] neg_hi:[0,1]
    v_pk_fma_f32 v[6:7], v[248:249], v[248:249], v[6:7]
    v_pk_add_f32 v[248:249], v[162:163], v[4:5] op_sel_hi:[1,0] neg_lo:[0,1] neg_hi:[0,1]
    v_pk_fma_f32 v[6:7], v[248:249], v[248:249], v[6:7]
    v_pk_add_f32 v[248:249], v[164:165], v[4:5] op_sel_hi:[1,0] neg_lo:[0,1] neg_hi:[0,1]
    v_pk_fma_f32 v[6:7], v[248:249], v[248:249], v[6:7]
    v_pk_add_f32 v[248:249], v[166:167], v[4:5] op_sel_hi:[1,0] neg_lo:[0,1] neg_hi:[0,1]
    v_pk_fma_f32 v[6:7], v[248:249], v[248:249], v[6:7]
    v_pk_add_f32 v[248:249], v[168:169], v[4:5] op_sel_hi:[1,0] neg_lo:[0,1] neg_hi:[0,1]
    v_pk_fma_f32 v[6:7], v[248:249], v[248:249], v[6:7]
    v_pk_add_f32 v[248:249], v[170:171], v[4:5] op_sel_hi:[1,0] neg_lo:[0,1] neg_hi:[0,1]
    v_pk_fma_f32 v[6:7], v[248:249], v[248:249], v[6:7]
    v_pk_add_f32 v[248:249], v[172:173], v[4:5] op_sel_hi:[1,0] neg_lo:[0,1] neg_hi:[0,1]
    v_pk_fma_f32 v[6:7], v[248:249], v[248:249], v[6:7]
    v_pk_add_f32 v[248:249], v[174:175], v[4:5] op_sel_hi:[1,0] neg_lo:[0,1] neg_hi:[0,1]
    v_pk_fma_f32 v[6:7], v[248:249], v[248:249], v[6:7]
    v_pk_add_f32 v[248:249], v[176:177], v[4:5] op_sel_hi:[1,0] neg_lo:[0,1] neg_hi:[0,1]
    v_pk_fma_f32 v[6:7], v[248:249], v[248:249], v[6:7]
    v_pk_add_f32 v[248:249], v[178:179], v[4:5] op_sel_hi:[1,0] neg_lo:[0,1] neg_hi:[0,1]
    v_pk_fma_f32 v[6:7], v[248:249], v[248:249], v[6:7]
    v_pk_add_f32 v[248:249], v[180:181], v[4:5] op_sel_hi:[1,0] neg_lo:[0,1] neg_hi:[0,1]
    v_pk_fma_f32 v[6:7], v[248:249], v[248:249], v[6:7]
    v_pk_add_f32 v[248:249], v[182:183], v[4:5] op_sel_hi:[1,0] neg_lo:[0,1] neg_hi:[0,1]
    v_pk_fma_f32 v[6:7], v[248:249], v[248:249], v[6:7]
    v_pk_add_f32 v[248:249], v[184:185], v[4:5] op_sel_hi:[1,0] neg_lo:[0,1] neg_hi:[0,1]
    v_pk_fma_f32 v[6:7], v[248:249], v[248:249], v[6:7]
    v_pk_add_f32 v[248:249], v[186:187], v[4:5] op_sel_hi:[1,0] neg_lo:[0,1] neg_hi:[0,1]
    v_pk_fma_f32 v[6:7], v[248:249], v[248:249], v[6:7]
    v_pk_add_f32 v[248:249], v[188:189], v[4:5] op_sel_hi:[1,0] neg_lo:[0,1] neg_hi:[0,1]
    v_pk_fma_f32 v[6:7], v[248:249], v[248:249], v[6:7]
    v_pk_add_f32 v[248:249], v[190:191], v[4:5] op_sel_hi:[1,0] neg_lo:[0,1] neg_hi:[0,1]
    v_pk_fma_f32 v[6:7], v[248:249], v[248:249], v[6:7]
    v_pk_add_f32 v[248:249], v[192:193], v[4:5] op_sel_hi:[1,0] neg_lo:[0,1] neg_hi:[0,1]
    v_pk_fma_f32 v[6:7], v[248:249], v[248:249], v[6:7]
    v_pk_add_f32 v[248:249], v[194:195], v[4:5] op_sel_hi:[1,0] neg_lo:[0,1] neg_hi:[0,1]
    v_pk_fma_f32 v[6:7], v[248:249], v[248:249], v[6:7]
    v_pk_add_f32 v[248:249], v[196:197], v[4:5] op_sel_hi:[1,0] neg_lo:[0,1] neg_hi:[0,1]
    v_pk_fma_f32 v[6:7], v[248:249], v[248:249], v[6:7]
    v_pk_add_f32 v[248:249], v[198:199], v[4:5] op_sel_hi:[1,0] neg_lo:[0,1] neg_hi:[0,1]
    v_pk_fma_f32 v[6:7], v[248:249], v[248:249], v[6:7]
    v_pk_add_f32 v[248:249], v[200:201], v[4:5] op_sel_hi:[1,0] neg_lo:[0,1] neg_hi:[0,1]
    v_pk_fma_f32 v[6:7], v[248:249], v[248:249], v[6:7]
    v_pk_add_f32 v[248:249], v[202:203], v[4:5] op_sel_hi:[1,0] neg_lo:[0,1] neg_hi:[0,1]
    v_pk_fma_f32 v[6:7], v[248:249], v[248:249], v[6:7]
    v_pk_add_f32 v[248:249], v[204:205], v[4:5] op_sel_hi:[1,0] neg_lo:[0,1] neg_hi:[0,1]
    v_pk_fma_f32 v[6:7], v[248:249], v[248:249], v[6:7]
    v_pk_add_f32 v[248:249], v[206:207], v[4:5] op_sel_hi:[1,0] neg_lo:[0,1] neg_hi:[0,1]
    v_pk_fma_f32 v[6:7], v[248:249], v[248:249], v[6:7]
    v_pk_add_f32 v[248:249], v[208:209], v[4:5] op_sel_hi:[1,0] neg_lo:[0,1] neg_hi:[0,1]
    v_pk_fma_f32 v[6:7], v[248:249], v[248:249], v[6:7]
    v_pk_add_f32 v[248:249], v[210:211], v[4:5] op_sel_hi:[1,0] neg_lo:[0,1] neg_hi:[0,1]
    v_pk_fma_f32 v[6:7], v[248:249], v[248:249], v[6:7]
    v_pk_add_f32 v[248:249], v[212:213], v[4:5] op_sel_hi:[1,0] neg_lo:[0,1] neg_hi:[0,1]
    v_pk_fma_f32 v[6:7], v[248:249], v[248:249], v[6:7]
    v_pk_add_f32 v[248:249], v[214:215], v[4:5] op_sel_hi:[1,0] neg_lo:[0,1] neg_hi:[0,1]
    v_pk_fma_f32 v[6:7], v[248:249], v[248:249], v[6:7]
    v_pk_add_f32 v[248:249], v[216:217], v[4:5] op_sel_hi:[1,0] neg_lo:[0,1] neg_hi:[0,1]
    v_pk_fma_f32 v[6:7], v[248:249], v[248:249], v[6:7]
    v_pk_add_f32 v[248:249], v[218:219], v[4:5] op_sel_hi:[1,0] neg_lo:[0,1] neg_hi:[0,1]
    v_pk_fma_f32 v[6:7], v[248:249], v[248:249], v[6:7]
    v_pk_add_f32 v[248:249], v[220:221], v[4:5] op_sel_hi:[1,0] neg_lo:[0,1] neg_hi:[0,1]
    v_pk_fma_f32 v[6:7], v[248:249], v[248:249], v[6:7]
    v_pk_add_f32 v[248:249], v[222:223], v[4:5] op_sel_hi:[1,0] neg_lo:[0,1] neg_hi:[0,1]
    v_pk_fma_f32 v[6:7], v[248:249], v[248:249], v[6:7]
    v_pk_add_f32 v[248:249], v[224:225], v[4:5] op_sel_hi:[1,0] neg_lo:[0,1] neg_hi:[0,1]
    v_pk_fma_f32 v[6:7], v[248:249], v[248:249], v[6:7]
    v_pk_add_f32 v[248:249], v[226:227], v[4:5] op_sel_hi:[1,0] neg_lo:[0,1] neg_hi:[0,1]
    v_pk_fma_f32 v[6:7], v[248:249], v[248:249], v[6:7]
    v_pk_add_f32 v[248:249], v[228:229], v[4:5] op_sel_hi:[1,0] neg_lo:[0,1] neg_hi:[0,1]
    v_pk_fma_f32 v[6:7], v[248:249], v[248:249], v[6:7]
    v_pk_add_f32 v[248:249], v[230:231], v[4:5] op_sel_hi:[1,0] neg_lo:[0,1] neg_hi:[0,1]
    v_pk_fma_f32 v[6:7], v[248:249], v[248:249], v[6:7]
    v_pk_add_f32 v[248:249], v[232:233], v[4:5] op_sel_hi:[1,0] neg_lo:[0,1] neg_hi:[0,1]
    v_pk_fma_f32 v[6:7], v[248:249], v[248:249], v[6:7]
    v_pk_add_f32 v[248:249], v[234:235], v[4:5] op_sel_hi:[1,0] neg_lo:[0,1] neg_hi:[0,1]
    v_pk_fma_f32 v[6:7], v[248:249], v[248:249], v[6:7]
    v_pk_add_f32 v[248:249], v[236:237], v[4:5] op_sel_hi:[1,0] neg_lo:[0,1] neg_hi:[0,1]
    v_pk_fma_f32 v[6:7], v[248:249], v[248:249], v[6:7]
    v_pk_add_f32 v[248:249], v[238:239], v[4:5] op_sel_hi:[1,0] neg_lo:[0,1] neg_hi:[0,1]
    v_pk_fma_f32 v[6:7], v[248:249], v[248:249], v[6:7]
    v_pk_add_f32 v[248:249], v[240:241], v[4:5] op_sel_hi:[1,0] neg_lo:[0,1] neg_hi:[0,1]
    v_pk_fma_f32 v[6:7], v[248:249], v[248:249], v[6:7]
    v_pk_add_f32 v[248:249], v[242:243], v[4:5] op_sel_hi:[1,0] neg_lo:[0,1] neg_hi:[0,1]
    v_pk_fma_f32 v[6:7], v[248:249], v[248:249], v[6:7]
    v_pk_add_f32 v[248:249], v[244:245], v[4:5] op_sel_hi:[1,0] neg_lo:[0,1] neg_hi:[0,1]
    v_pk_fma_f32 v[6:7], v[248:249], v[248:249], v[6:7]
    v_pk_add_f32 v[248:249], v[246:247], v[4:5] op_sel_hi:[1,0] neg_lo:[0,1] neg_hi:[0,1]
    v_pk_fma_f32 v[6:7], v[248:249], v[248:249], v[6:7]
    v_add_f32 v6, v6, v7
    v_mov_b32 v7, v6
    s_nop 1
    v_permlane16_swap_b32 v6, v7
    v_add_f32 v6, v6, v7
    v_mov_b32 v7, v6
    s_nop 1
    v_permlane32_swap_b32 v6, v7
    v_add_f32 v6, v6, v7
    v_mul_f32 v6, 986500301, v6
    v_cvt_pk_bf16_f32 v6, v4, v6
    v_lshlrev_b32 v4, 16, v6
    v_and_b32 v6, s44, v6
    v_add_f32 v6, 925353388, v6
    v_cvt_pk_bf16_f32 v6, v6, v6
    v_lshlrev_b32 v6, 16, v6
    v_sqrt_f32 v6, v6
    s_nop 0
    v_cvt_pk_bf16_f32 v6, v6, v6
    v_lshlrev_b32 v6, 16, v6
    v_rcp_f32 v6, v6
    s_lshr_b32 s40, s42, 1
    s_lshl_b32 s40, s40, 16
    s_and_b32 s41, s42, 1
    s_lshl_b32 s41, s41, 10
    s_add_u32 s40, s40, s41
    s_add_u32 s40, s40, 180355072
    v_lshlrev_b32 v2, 4, v1
    v_add_u32 v3, 40960, v2
    v_pk_add_f32 v[88:89], v[88:89], v[4:5] op_sel_hi:[1,0] neg_lo:[0,1] neg_hi:[0,1]
    v_cvt_pk_bf16_f32 v89, v88, v89
    v_lshlrev_b32 v88, 16, v89
    v_and_b32 v89, s44, v89
    v_pk_mul_f32 v[88:89], v[88:89], v[6:7] op_sel_hi:[1,0]
    v_cvt_pk_bf16_f32 v8, v88, v89
    v_pk_add_f32 v[90:91], v[90:91], v[4:5] op_sel_hi:[1,0] neg_lo:[0,1] neg_hi:[0,1]
    v_cvt_pk_bf16_f32 v91, v90, v91
    v_lshlrev_b32 v90, 16, v91
    v_and_b32 v91, s44, v91
    v_pk_mul_f32 v[90:91], v[90:91], v[6:7] op_sel_hi:[1,0]
    v_cvt_pk_bf16_f32 v9, v90, v91
    v_pk_add_f32 v[92:93], v[92:93], v[4:5] op_sel_hi:[1,0] neg_lo:[0,1] neg_hi:[0,1]
    v_cvt_pk_bf16_f32 v93, v92, v93
    v_lshlrev_b32 v92, 16, v93
    v_and_b32 v93, s44, v93
    v_pk_mul_f32 v[92:93], v[92:93], v[6:7] op_sel_hi:[1,0]
    v_cvt_pk_bf16_f32 v10, v92, v93
    v_pk_add_f32 v[94:95], v[94:95], v[4:5] op_sel_hi:[1,0] neg_lo:[0,1] neg_hi:[0,1]
    v_cvt_pk_bf16_f32 v95, v94, v95
    v_lshlrev_b32 v94, 16, v95
    v_and_b32 v95, s44, v95
    v_pk_mul_f32 v[94:95], v[94:95], v[6:7] op_sel_hi:[1,0]
    v_cvt_pk_bf16_f32 v11, v94, v95
    buffer_store_dwordx4 v[8:11], v2, s[4:7], s40 offen offset:0 sc1
    buffer_store_dwordx4 v[8:11], v3, s[4:7], s40 offen offset:0 sc1
    v_pk_add_f32 v[96:97], v[96:97], v[4:5] op_sel_hi:[1,0] neg_lo:[0,1] neg_hi:[0,1]
    v_cvt_pk_bf16_f32 v97, v96, v97
    v_lshlrev_b32 v96, 16, v97
    v_and_b32 v97, s44, v97
    v_pk_mul_f32 v[96:97], v[96:97], v[6:7] op_sel_hi:[1,0]
    v_cvt_pk_bf16_f32 v12, v96, v97
    v_pk_add_f32 v[98:99], v[98:99], v[4:5] op_sel_hi:[1,0] neg_lo:[0,1] neg_hi:[0,1]
    v_cvt_pk_bf16_f32 v99, v98, v99
    v_lshlrev_b32 v98, 16, v99
    v_and_b32 v99, s44, v99
    v_pk_mul_f32 v[98:99], v[98:99], v[6:7] op_sel_hi:[1,0]
    v_cvt_pk_bf16_f32 v13, v98, v99
    v_pk_add_f32 v[100:101], v[100:101], v[4:5] op_sel_hi:[1,0] neg_lo:[0,1] neg_hi:[0,1]
    v_cvt_pk_bf16_f32 v101, v100, v101
    v_lshlrev_b32 v100, 16, v101
    v_and_b32 v101, s44, v101
    v_pk_mul_f32 v[100:101], v[100:101], v[6:7] op_sel_hi:[1,0]
    v_cvt_pk_bf16_f32 v14, v100, v101
    v_pk_add_f32 v[102:103], v[102:103], v[4:5] op_sel_hi:[1,0] neg_lo:[0,1] neg_hi:[0,1]
    v_cvt_pk_bf16_f32 v103, v102, v103
    v_lshlrev_b32 v102, 16, v103
    v_and_b32 v103, s44, v103
    v_pk_mul_f32 v[102:103], v[102:103], v[6:7] op_sel_hi:[1,0]
    v_cvt_pk_bf16_f32 v15, v102, v103
    buffer_store_dwordx4 v[12:15], v2, s[4:7], s40 offen offset:2048 sc1
    buffer_store_dwordx4 v[12:15], v3, s[4:7], s40 offen offset:2048 sc1
    s_add_u32 s40, s40, 4096
    v_pk_add_f32 v[104:105], v[104:105], v[4:5] op_sel_hi:[1,0] neg_lo:[0,1] neg_hi:[0,1]
    v_cvt_pk_bf16_f32 v105, v104, v105
    v_lshlrev_b32 v104, 16, v105
    v_and_b32 v105, s44, v105
    v_pk_mul_f32 v[104:105], v[104:105], v[6:7] op_sel_hi:[1,0]
    v_cvt_pk_bf16_f32 v16, v104, v105
    v_pk_add_f32 v[106:107], v[106:107], v[4:5] op_sel_hi:[1,0] neg_lo:[0,1] neg_hi:[0,1]
    v_cvt_pk_bf16_f32 v107, v106, v107
    v_lshlrev_b32 v106, 16, v107
    v_and_b32 v107, s44, v107
    v_pk_mul_f32 v[106:107], v[106:107], v[6:7] op_sel_hi:[1,0]
    v_cvt_pk_bf16_f32 v17, v106, v107
    v_pk_add_f32 v[108:109], v[108:109], v[4:5] op_sel_hi:[1,0] neg_lo:[0,1] neg_hi:[0,1]
    v_cvt_pk_bf16_f32 v109, v108, v109
    v_lshlrev_b32 v108, 16, v109
    v_and_b32 v109, s44, v109
    v_pk_mul_f32 v[108:109], v[108:109], v[6:7] op_sel_hi:[1,0]
    v_cvt_pk_bf16_f32 v18, v108, v109
    v_pk_add_f32 v[110:111], v[110:111], v[4:5] op_sel_hi:[1,0] neg_lo:[0,1] neg_hi:[0,1]
    v_cvt_pk_bf16_f32 v111, v110, v111
    v_lshlrev_b32 v110, 16, v111
    v_and_b32 v111, s44, v111
    v_pk_mul_f32 v[110:111], v[110:111], v[6:7] op_sel_hi:[1,0]
    v_cvt_pk_bf16_f32 v19, v110, v111
    buffer_store_dwordx4 v[16:19], v2, s[4:7], s40 offen offset:0 sc1
    buffer_store_dwordx4 v[16:19], v3, s[4:7], s40 offen offset:0 sc1
    v_pk_add_f32 v[112:113], v[112:113], v[4:5] op_sel_hi:[1,0] neg_lo:[0,1] neg_hi:[0,1]
    v_cvt_pk_bf16_f32 v113, v112, v113
    v_lshlrev_b32 v112, 16, v113
    v_and_b32 v113, s44, v113
    v_pk_mul_f32 v[112:113], v[112:113], v[6:7] op_sel_hi:[1,0]
    v_cvt_pk_bf16_f32 v20, v112, v113
    v_pk_add_f32 v[114:115], v[114:115], v[4:5] op_sel_hi:[1,0] neg_lo:[0,1] neg_hi:[0,1]
    v_cvt_pk_bf16_f32 v115, v114, v115
    v_lshlrev_b32 v114, 16, v115
    v_and_b32 v115, s44, v115
    v_pk_mul_f32 v[114:115], v[114:115], v[6:7] op_sel_hi:[1,0]
    v_cvt_pk_bf16_f32 v21, v114, v115
    v_pk_add_f32 v[116:117], v[116:117], v[4:5] op_sel_hi:[1,0] neg_lo:[0,1] neg_hi:[0,1]
    v_cvt_pk_bf16_f32 v117, v116, v117
    v_lshlrev_b32 v116, 16, v117
    v_and_b32 v117, s44, v117
    v_pk_mul_f32 v[116:117], v[116:117], v[6:7] op_sel_hi:[1,0]
    v_cvt_pk_bf16_f32 v22, v116, v117
    v_pk_add_f32 v[118:119], v[118:119], v[4:5] op_sel_hi:[1,0] neg_lo:[0,1] neg_hi:[0,1]
    v_cvt_pk_bf16_f32 v119, v118, v119
    v_lshlrev_b32 v118, 16, v119
    v_and_b32 v119, s44, v119
    v_pk_mul_f32 v[118:119], v[118:119], v[6:7] op_sel_hi:[1,0]
    v_cvt_pk_bf16_f32 v23, v118, v119
    buffer_store_dwordx4 v[20:23], v2, s[4:7], s40 offen offset:2048 sc1
    buffer_store_dwordx4 v[20:23], v3, s[4:7], s40 offen offset:2048 sc1
    s_add_u32 s40, s40, 4096
    v_pk_add_f32 v[120:121], v[120:121], v[4:5] op_sel_hi:[1,0] neg_lo:[0,1] neg_hi:[0,1]
    v_cvt_pk_bf16_f32 v121, v120, v121
    v_lshlrev_b32 v120, 16, v121
    v_and_b32 v121, s44, v121
    v_pk_mul_f32 v[120:121], v[120:121], v[6:7] op_sel_hi:[1,0]
    v_cvt_pk_bf16_f32 v24, v120, v121
    v_pk_add_f32 v[122:123], v[122:123], v[4:5] op_sel_hi:[1,0] neg_lo:[0,1] neg_hi:[0,1]
    v_cvt_pk_bf16_f32 v123, v122, v123
    v_lshlrev_b32 v122, 16, v123
    v_and_b32 v123, s44, v123
    v_pk_mul_f32 v[122:123], v[122:123], v[6:7] op_sel_hi:[1,0]
    v_cvt_pk_bf16_f32 v25, v122, v123
    v_pk_add_f32 v[124:125], v[124:125], v[4:5] op_sel_hi:[1,0] neg_lo:[0,1] neg_hi:[0,1]
    v_cvt_pk_bf16_f32 v125, v124, v125
    v_lshlrev_b32 v124, 16, v125
    v_and_b32 v125, s44, v125
    v_pk_mul_f32 v[124:125], v[124:125], v[6:7] op_sel_hi:[1,0]
    v_cvt_pk_bf16_f32 v26, v124, v125
    v_pk_add_f32 v[126:127], v[126:127], v[4:5] op_sel_hi:[1,0] neg_lo:[0,1] neg_hi:[0,1]
    v_cvt_pk_bf16_f32 v127, v126, v127
    v_lshlrev_b32 v126, 16, v127
    v_and_b32 v127, s44, v127
    v_pk_mul_f32 v[126:127], v[126:127], v[6:7] op_sel_hi:[1,0]
    v_cvt_pk_bf16_f32 v27, v126, v127
    buffer_store_dwordx4 v[24:27], v2, s[4:7], s40 offen offset:0 sc1
    buffer_store_dwordx4 v[24:27], v3, s[4:7], s40 offen offset:0 sc1
    v_pk_add_f32 v[128:129], v[128:129], v[4:5] op_sel_hi:[1,0] neg_lo:[0,1] neg_hi:[0,1]
    v_cvt_pk_bf16_f32 v129, v128, v129
    v_lshlrev_b32 v128, 16, v129
    v_and_b32 v129, s44, v129
    v_pk_mul_f32 v[128:129], v[128:129], v[6:7] op_sel_hi:[1,0]
    v_cvt_pk_bf16_f32 v28, v128, v129
    v_pk_add_f32 v[130:131], v[130:131], v[4:5] op_sel_hi:[1,0] neg_lo:[0,1] neg_hi:[0,1]
    v_cvt_pk_bf16_f32 v131, v130, v131
    v_lshlrev_b32 v130, 16, v131
    v_and_b32 v131, s44, v131
    v_pk_mul_f32 v[130:131], v[130:131], v[6:7] op_sel_hi:[1,0]
    v_cvt_pk_bf16_f32 v29, v130, v131
    v_pk_add_f32 v[132:133], v[132:133], v[4:5] op_sel_hi:[1,0] neg_lo:[0,1] neg_hi:[0,1]
    v_cvt_pk_bf16_f32 v133, v132, v133
    v_lshlrev_b32 v132, 16, v133
    v_and_b32 v133, s44, v133
    v_pk_mul_f32 v[132:133], v[132:133], v[6:7] op_sel_hi:[1,0]
    v_cvt_pk_bf16_f32 v30, v132, v133
    v_pk_add_f32 v[134:135], v[134:135], v[4:5] op_sel_hi:[1,0] neg_lo:[0,1] neg_hi:[0,1]
    v_cvt_pk_bf16_f32 v135, v134, v135
    v_lshlrev_b32 v134, 16, v135
    v_and_b32 v135, s44, v135
    v_pk_mul_f32 v[134:135], v[134:135], v[6:7] op_sel_hi:[1,0]
    v_cvt_pk_bf16_f32 v31, v134, v135
    buffer_store_dwordx4 v[28:31], v2, s[4:7], s40 offen offset:2048 sc1
    buffer_store_dwordx4 v[28:31], v3, s[4:7], s40 offen offset:2048 sc1
    s_add_u32 s40, s40, 4096
    v_pk_add_f32 v[136:137], v[136:137], v[4:5] op_sel_hi:[1,0] neg_lo:[0,1] neg_hi:[0,1]
    v_cvt_pk_bf16_f32 v137, v136, v137
    v_lshlrev_b32 v136, 16, v137
    v_and_b32 v137, s44, v137
    v_pk_mul_f32 v[136:137], v[136:137], v[6:7] op_sel_hi:[1,0]
    v_cvt_pk_bf16_f32 v32, v136, v137
    v_pk_add_f32 v[138:139], v[138:139], v[4:5] op_sel_hi:[1,0] neg_lo:[0,1] neg_hi:[0,1]
    v_cvt_pk_bf16_f32 v139, v138, v139
    v_lshlrev_b32 v138, 16, v139
    v_and_b32 v139, s44, v139
    v_pk_mul_f32 v[138:139], v[138:139], v[6:7] op_sel_hi:[1,0]
    v_cvt_pk_bf16_f32 v33, v138, v139
    v_pk_add_f32 v[140:141], v[140:141], v[4:5] op_sel_hi:[1,0] neg_lo:[0,1] neg_hi:[0,1]
    v_cvt_pk_bf16_f32 v141, v140, v141
    v_lshlrev_b32 v140, 16, v141
    v_and_b32 v141, s44, v141
    v_pk_mul_f32 v[140:141], v[140:141], v[6:7] op_sel_hi:[1,0]
    v_cvt_pk_bf16_f32 v34, v140, v141
    v_pk_add_f32 v[142:143], v[142:143], v[4:5] op_sel_hi:[1,0] neg_lo:[0,1] neg_hi:[0,1]
    v_cvt_pk_bf16_f32 v143, v142, v143
    v_lshlrev_b32 v142, 16, v143
    v_and_b32 v143, s44, v143
    v_pk_mul_f32 v[142:143], v[142:143], v[6:7] op_sel_hi:[1,0]
    v_cvt_pk_bf16_f32 v35, v142, v143
    buffer_store_dwordx4 v[32:35], v2, s[4:7], s40 offen offset:0 sc1
    buffer_store_dwordx4 v[32:35], v3, s[4:7], s40 offen offset:0 sc1
    v_pk_add_f32 v[144:145], v[144:145], v[4:5] op_sel_hi:[1,0] neg_lo:[0,1] neg_hi:[0,1]
    v_cvt_pk_bf16_f32 v145, v144, v145
    v_lshlrev_b32 v144, 16, v145
    v_and_b32 v145, s44, v145
    v_pk_mul_f32 v[144:145], v[144:145], v[6:7] op_sel_hi:[1,0]
    v_cvt_pk_bf16_f32 v36, v144, v145
    v_pk_add_f32 v[146:147], v[146:147], v[4:5] op_sel_hi:[1,0] neg_lo:[0,1] neg_hi:[0,1]
    v_cvt_pk_bf16_f32 v147, v146, v147
    v_lshlrev_b32 v146, 16, v147
    v_and_b32 v147, s44, v147
    v_pk_mul_f32 v[146:147], v[146:147], v[6:7] op_sel_hi:[1,0]
    v_cvt_pk_bf16_f32 v37, v146, v147
    v_pk_add_f32 v[148:149], v[148:149], v[4:5] op_sel_hi:[1,0] neg_lo:[0,1] neg_hi:[0,1]
    v_cvt_pk_bf16_f32 v149, v148, v149
    v_lshlrev_b32 v148, 16, v149
    v_and_b32 v149, s44, v149
    v_pk_mul_f32 v[148:149], v[148:149], v[6:7] op_sel_hi:[1,0]
    v_cvt_pk_bf16_f32 v38, v148, v149
    v_pk_add_f32 v[150:151], v[150:151], v[4:5] op_sel_hi:[1,0] neg_lo:[0,1] neg_hi:[0,1]
    v_cvt_pk_bf16_f32 v151, v150, v151
    v_lshlrev_b32 v150, 16, v151
    v_and_b32 v151, s44, v151
    v_pk_mul_f32 v[150:151], v[150:151], v[6:7] op_sel_hi:[1,0]
    v_cvt_pk_bf16_f32 v39, v150, v151
    buffer_store_dwordx4 v[36:39], v2, s[4:7], s40 offen offset:2048 sc1
    buffer_store_dwordx4 v[36:39], v3, s[4:7], s40 offen offset:2048 sc1
    s_add_u32 s40, s40, 4096
    v_pk_add_f32 v[152:153], v[152:153], v[4:5] op_sel_hi:[1,0] neg_lo:[0,1] neg_hi:[0,1]
    v_cvt_pk_bf16_f32 v153, v152, v153
    v_lshlrev_b32 v152, 16, v153
    v_and_b32 v153, s44, v153
    v_pk_mul_f32 v[152:153], v[152:153], v[6:7] op_sel_hi:[1,0]
    v_cvt_pk_bf16_f32 v40, v152, v153
    v_pk_add_f32 v[154:155], v[154:155], v[4:5] op_sel_hi:[1,0] neg_lo:[0,1] neg_hi:[0,1]
    v_cvt_pk_bf16_f32 v155, v154, v155
    v_lshlrev_b32 v154, 16, v155
    v_and_b32 v155, s44, v155
    v_pk_mul_f32 v[154:155], v[154:155], v[6:7] op_sel_hi:[1,0]
    v_cvt_pk_bf16_f32 v41, v154, v155
    v_pk_add_f32 v[156:157], v[156:157], v[4:5] op_sel_hi:[1,0] neg_lo:[0,1] neg_hi:[0,1]
    v_cvt_pk_bf16_f32 v157, v156, v157
    v_lshlrev_b32 v156, 16, v157
    v_and_b32 v157, s44, v157
    v_pk_mul_f32 v[156:157], v[156:157], v[6:7] op_sel_hi:[1,0]
    v_cvt_pk_bf16_f32 v42, v156, v157
    v_pk_add_f32 v[158:159], v[158:159], v[4:5] op_sel_hi:[1,0] neg_lo:[0,1] neg_hi:[0,1]
    v_cvt_pk_bf16_f32 v159, v158, v159
    v_lshlrev_b32 v158, 16, v159
    v_and_b32 v159, s44, v159
    v_pk_mul_f32 v[158:159], v[158:159], v[6:7] op_sel_hi:[1,0]
    v_cvt_pk_bf16_f32 v43, v158, v159
    buffer_store_dwordx4 v[40:43], v2, s[4:7], s40 offen offset:0 sc1
    buffer_store_dwordx4 v[40:43], v3, s[4:7], s40 offen offset:0 sc1
    v_pk_add_f32 v[160:161], v[160:161], v[4:5] op_sel_hi:[1,0] neg_lo:[0,1] neg_hi:[0,1]
    v_cvt_pk_bf16_f32 v161, v160, v161
    v_lshlrev_b32 v160, 16, v161
    v_and_b32 v161, s44, v161
    v_pk_mul_f32 v[160:161], v[160:161], v[6:7] op_sel_hi:[1,0]
    v_cvt_pk_bf16_f32 v44, v160, v161
    v_pk_add_f32 v[162:163], v[162:163], v[4:5] op_sel_hi:[1,0] neg_lo:[0,1] neg_hi:[0,1]
    v_cvt_pk_bf16_f32 v163, v162, v163
    v_lshlrev_b32 v162, 16, v163
    v_and_b32 v163, s44, v163
    v_pk_mul_f32 v[162:163], v[162:163], v[6:7] op_sel_hi:[1,0]
    v_cvt_pk_bf16_f32 v45, v162, v163
    v_pk_add_f32 v[164:165], v[164:165], v[4:5] op_sel_hi:[1,0] neg_lo:[0,1] neg_hi:[0,1]
    v_cvt_pk_bf16_f32 v165, v164, v165
    v_lshlrev_b32 v164, 16, v165
    v_and_b32 v165, s44, v165
    v_pk_mul_f32 v[164:165], v[164:165], v[6:7] op_sel_hi:[1,0]
    v_cvt_pk_bf16_f32 v46, v164, v165
    v_pk_add_f32 v[166:167], v[166:167], v[4:5] op_sel_hi:[1,0] neg_lo:[0,1] neg_hi:[0,1]
    v_cvt_pk_bf16_f32 v167, v166, v167
    v_lshlrev_b32 v166, 16, v167
    v_and_b32 v167, s44, v167
    v_pk_mul_f32 v[166:167], v[166:167], v[6:7] op_sel_hi:[1,0]
    v_cvt_pk_bf16_f32 v47, v166, v167
    buffer_store_dwordx4 v[44:47], v2, s[4:7], s40 offen offset:2048 sc1
    buffer_store_dwordx4 v[44:47], v3, s[4:7], s40 offen offset:2048 sc1
    s_add_u32 s40, s40, 4096
    v_pk_add_f32 v[168:169], v[168:169], v[4:5] op_sel_hi:[1,0] neg_lo:[0,1] neg_hi:[0,1]
    v_cvt_pk_bf16_f32 v169, v168, v169
    v_lshlrev_b32 v168, 16, v169
    v_and_b32 v169, s44, v169
    v_pk_mul_f32 v[168:169], v[168:169], v[6:7] op_sel_hi:[1,0]
    v_cvt_pk_bf16_f32 v48, v168, v169
    v_pk_add_f32 v[170:171], v[170:171], v[4:5] op_sel_hi:[1,0] neg_lo:[0,1] neg_hi:[0,1]
    v_cvt_pk_bf16_f32 v171, v170, v171
    v_lshlrev_b32 v170, 16, v171
    v_and_b32 v171, s44, v171
    v_pk_mul_f32 v[170:171], v[170:171], v[6:7] op_sel_hi:[1,0]
    v_cvt_pk_bf16_f32 v49, v170, v171
    v_pk_add_f32 v[172:173], v[172:173], v[4:5] op_sel_hi:[1,0] neg_lo:[0,1] neg_hi:[0,1]
    v_cvt_pk_bf16_f32 v173, v172, v173
    v_lshlrev_b32 v172, 16, v173
    v_and_b32 v173, s44, v173
    v_pk_mul_f32 v[172:173], v[172:173], v[6:7] op_sel_hi:[1,0]
    v_cvt_pk_bf16_f32 v50, v172, v173
    v_pk_add_f32 v[174:175], v[174:175], v[4:5] op_sel_hi:[1,0] neg_lo:[0,1] neg_hi:[0,1]
    v_cvt_pk_bf16_f32 v175, v174, v175
    v_lshlrev_b32 v174, 16, v175
    v_and_b32 v175, s44, v175
    v_pk_mul_f32 v[174:175], v[174:175], v[6:7] op_sel_hi:[1,0]
    v_cvt_pk_bf16_f32 v51, v174, v175
    buffer_store_dwordx4 v[48:51], v2, s[4:7], s40 offen offset:0 sc1
    buffer_store_dwordx4 v[48:51], v3, s[4:7], s40 offen offset:0 sc1
    v_pk_add_f32 v[176:177], v[176:177], v[4:5] op_sel_hi:[1,0] neg_lo:[0,1] neg_hi:[0,1]
    v_cvt_pk_bf16_f32 v177, v176, v177
    v_lshlrev_b32 v176, 16, v177
    v_and_b32 v177, s44, v177
    v_pk_mul_f32 v[176:177], v[176:177], v[6:7] op_sel_hi:[1,0]
    v_cvt_pk_bf16_f32 v52, v176, v177
    v_pk_add_f32 v[178:179], v[178:179], v[4:5] op_sel_hi:[1,0] neg_lo:[0,1] neg_hi:[0,1]
    v_cvt_pk_bf16_f32 v179, v178, v179
    v_lshlrev_b32 v178, 16, v179
    v_and_b32 v179, s44, v179
    v_pk_mul_f32 v[178:179], v[178:179], v[6:7] op_sel_hi:[1,0]
    v_cvt_pk_bf16_f32 v53, v178, v179
    v_pk_add_f32 v[180:181], v[180:181], v[4:5] op_sel_hi:[1,0] neg_lo:[0,1] neg_hi:[0,1]
    v_cvt_pk_bf16_f32 v181, v180, v181
    v_lshlrev_b32 v180, 16, v181
    v_and_b32 v181, s44, v181
    v_pk_mul_f32 v[180:181], v[180:181], v[6:7] op_sel_hi:[1,0]
    v_cvt_pk_bf16_f32 v54, v180, v181
    v_pk_add_f32 v[182:183], v[182:183], v[4:5] op_sel_hi:[1,0] neg_lo:[0,1] neg_hi:[0,1]
    v_cvt_pk_bf16_f32 v183, v182, v183
    v_lshlrev_b32 v182, 16, v183
    v_and_b32 v183, s44, v183
    v_pk_mul_f32 v[182:183], v[182:183], v[6:7] op_sel_hi:[1,0]
    v_cvt_pk_bf16_f32 v55, v182, v183
    buffer_store_dwordx4 v[52:55], v2, s[4:7], s40 offen offset:2048 sc1
    buffer_store_dwordx4 v[52:55], v3, s[4:7], s40 offen offset:2048 sc1
    s_add_u32 s40, s40, 4096
    v_pk_add_f32 v[184:185], v[184:185], v[4:5] op_sel_hi:[1,0] neg_lo:[0,1] neg_hi:[0,1]
    v_cvt_pk_bf16_f32 v185, v184, v185
    v_lshlrev_b32 v184, 16, v185
    v_and_b32 v185, s44, v185
    v_pk_mul_f32 v[184:185], v[184:185], v[6:7] op_sel_hi:[1,0]
    v_cvt_pk_bf16_f32 v56, v184, v185
    v_pk_add_f32 v[186:187], v[186:187], v[4:5] op_sel_hi:[1,0] neg_lo:[0,1] neg_hi:[0,1]
    v_cvt_pk_bf16_f32 v187, v186, v187
    v_lshlrev_b32 v186, 16, v187
    v_and_b32 v187, s44, v187
    v_pk_mul_f32 v[186:187], v[186:187], v[6:7] op_sel_hi:[1,0]
    v_cvt_pk_bf16_f32 v57, v186, v187
    v_pk_add_f32 v[188:189], v[188:189], v[4:5] op_sel_hi:[1,0] neg_lo:[0,1] neg_hi:[0,1]
    v_cvt_pk_bf16_f32 v189, v188, v189
    v_lshlrev_b32 v188, 16, v189
    v_and_b32 v189, s44, v189
    v_pk_mul_f32 v[188:189], v[188:189], v[6:7] op_sel_hi:[1,0]
    v_cvt_pk_bf16_f32 v58, v188, v189
    v_pk_add_f32 v[190:191], v[190:191], v[4:5] op_sel_hi:[1,0] neg_lo:[0,1] neg_hi:[0,1]
    v_cvt_pk_bf16_f32 v191, v190, v191
    v_lshlrev_b32 v190, 16, v191
    v_and_b32 v191, s44, v191
    v_pk_mul_f32 v[190:191], v[190:191], v[6:7] op_sel_hi:[1,0]
    v_cvt_pk_bf16_f32 v59, v190, v191
    buffer_store_dwordx4 v[56:59], v2, s[4:7], s40 offen offset:0 sc1
    v_pk_add_f32 v[192:193], v[192:193], v[4:5] op_sel_hi:[1,0] neg_lo:[0,1] neg_hi:[0,1]
    v_cvt_pk_bf16_f32 v193, v192, v193
    v_lshlrev_b32 v192, 16, v193
    v_and_b32 v193, s44, v193
    v_pk_mul_f32 v[192:193], v[192:193], v[6:7] op_sel_hi:[1,0]
    v_cvt_pk_bf16_f32 v60, v192, v193
    v_pk_add_f32 v[194:195], v[194:195], v[4:5] op_sel_hi:[1,0] neg_lo:[0,1] neg_hi:[0,1]
    v_cvt_pk_bf16_f32 v195, v194, v195
    v_lshlrev_b32 v194, 16, v195
    v_and_b32 v195, s44, v195
    v_pk_mul_f32 v[194:195], v[194:195], v[6:7] op_sel_hi:[1,0]
    v_cvt_pk_bf16_f32 v61, v194, v195
    v_pk_add_f32 v[196:197], v[196:197], v[4:5] op_sel_hi:[1,0] neg_lo:[0,1] neg_hi:[0,1]
    v_cvt_pk_bf16_f32 v197, v196, v197
    v_lshlrev_b32 v196, 16, v197
    v_and_b32 v197, s44, v197
    v_pk_mul_f32 v[196:197], v[196:197], v[6:7] op_sel_hi:[1,0]
    v_cvt_pk_bf16_f32 v62, v196, v197
    v_pk_add_f32 v[198:199], v[198:199], v[4:5] op_sel_hi:[1,0] neg_lo:[0,1] neg_hi:[0,1]
    v_cvt_pk_bf16_f32 v199, v198, v199
    v_lshlrev_b32 v198, 16, v199
    v_and_b32 v199, s44, v199
    v_pk_mul_f32 v[198:199], v[198:199], v[6:7] op_sel_hi:[1,0]
    v_cvt_pk_bf16_f32 v63, v198, v199
    buffer_store_dwordx4 v[60:63], v2, s[4:7], s40 offen offset:2048 sc1
    s_add_u32 s40, s40, 4096
    v_pk_add_f32 v[200:201], v[200:201], v[4:5] op_sel_hi:[1,0] neg_lo:[0,1] neg_hi:[0,1]
    v_cvt_pk_bf16_f32 v201, v200, v201
    v_lshlrev_b32 v200, 16, v201
    v_and_b32 v201, s44, v201
    v_pk_mul_f32 v[200:201], v[200:201], v[6:7] op_sel_hi:[1,0]
    v_cvt_pk_bf16_f32 v64, v200, v201
    v_pk_add_f32 v[202:203], v[202:203], v[4:5] op_sel_hi:[1,0] neg_lo:[0,1] neg_hi:[0,1]
    v_cvt_pk_bf16_f32 v203, v202, v203
    v_lshlrev_b32 v202, 16, v203
    v_and_b32 v203, s44, v203
    v_pk_mul_f32 v[202:203], v[202:203], v[6:7] op_sel_hi:[1,0]
    v_cvt_pk_bf16_f32 v65, v202, v203
    v_pk_add_f32 v[204:205], v[204:205], v[4:5] op_sel_hi:[1,0] neg_lo:[0,1] neg_hi:[0,1]
    v_cvt_pk_bf16_f32 v205, v204, v205
    v_lshlrev_b32 v204, 16, v205
    v_and_b32 v205, s44, v205
    v_pk_mul_f32 v[204:205], v[204:205], v[6:7] op_sel_hi:[1,0]
    v_cvt_pk_bf16_f32 v66, v204, v205
    v_pk_add_f32 v[206:207], v[206:207], v[4:5] op_sel_hi:[1,0] neg_lo:[0,1] neg_hi:[0,1]
    v_cvt_pk_bf16_f32 v207, v206, v207
    v_lshlrev_b32 v206, 16, v207
    v_and_b32 v207, s44, v207
    v_pk_mul_f32 v[206:207], v[206:207], v[6:7] op_sel_hi:[1,0]
    v_cvt_pk_bf16_f32 v67, v206, v207
    buffer_store_dwordx4 v[64:67], v2, s[4:7], s40 offen offset:0 sc1
    v_pk_add_f32 v[208:209], v[208:209], v[4:5] op_sel_hi:[1,0] neg_lo:[0,1] neg_hi:[0,1]
    v_cvt_pk_bf16_f32 v209, v208, v209
    v_lshlrev_b32 v208, 16, v209
    v_and_b32 v209, s44, v209
    v_pk_mul_f32 v[208:209], v[208:209], v[6:7] op_sel_hi:[1,0]
    v_cvt_pk_bf16_f32 v68, v208, v209
    v_pk_add_f32 v[210:211], v[210:211], v[4:5] op_sel_hi:[1,0] neg_lo:[0,1] neg_hi:[0,1]
    v_cvt_pk_bf16_f32 v211, v210, v211
    v_lshlrev_b32 v210, 16, v211
    v_and_b32 v211, s44, v211
    v_pk_mul_f32 v[210:211], v[210:211], v[6:7] op_sel_hi:[1,0]
    v_cvt_pk_bf16_f32 v69, v210, v211
    v_pk_add_f32 v[212:213], v[212:213], v[4:5] op_sel_hi:[1,0] neg_lo:[0,1] neg_hi:[0,1]
    v_cvt_pk_bf16_f32 v213, v212, v213
    v_lshlrev_b32 v212, 16, v213
    v_and_b32 v213, s44, v213
    v_pk_mul_f32 v[212:213], v[212:213], v[6:7] op_sel_hi:[1,0]
    v_cvt_pk_bf16_f32 v70, v212, v213
    v_pk_add_f32 v[214:215], v[214:215], v[4:5] op_sel_hi:[1,0] neg_lo:[0,1] neg_hi:[0,1]
    v_cvt_pk_bf16_f32 v215, v214, v215
    v_lshlrev_b32 v214, 16, v215
    v_and_b32 v215, s44, v215
    v_pk_mul_f32 v[214:215], v[214:215], v[6:7] op_sel_hi:[1,0]
    v_cvt_pk_bf16_f32 v71, v214, v215
    buffer_store_dwordx4 v[68:71], v2, s[4:7], s40 offen offset:2048 sc1
    s_add_u32 s40, s40, 4096
    v_pk_add_f32 v[216:217], v[216:217], v[4:5] op_sel_hi:[1,0] neg_lo:[0,1] neg_hi:[0,1]
    v_cvt_pk_bf16_f32 v217, v216, v217
    v_lshlrev_b32 v216, 16, v217
    v_and_b32 v217, s44, v217
    v_pk_mul_f32 v[216:217], v[216:217], v[6:7] op_sel_hi:[1,0]
    v_cvt_pk_bf16_f32 v72, v216, v217
    v_pk_add_f32 v[218:219], v[218:219], v[4:5] op_sel_hi:[1,0] neg_lo:[0,1] neg_hi:[0,1]
    v_cvt_pk_bf16_f32 v219, v218, v219
    v_lshlrev_b32 v218, 16, v219
    v_and_b32 v219, s44, v219
    v_pk_mul_f32 v[218:219], v[218:219], v[6:7] op_sel_hi:[1,0]
    v_cvt_pk_bf16_f32 v73, v218, v219
    v_pk_add_f32 v[220:221], v[220:221], v[4:5] op_sel_hi:[1,0] neg_lo:[0,1] neg_hi:[0,1]
    v_cvt_pk_bf16_f32 v221, v220, v221
    v_lshlrev_b32 v220, 16, v221
    v_and_b32 v221, s44, v221
    v_pk_mul_f32 v[220:221], v[220:221], v[6:7] op_sel_hi:[1,0]
    v_cvt_pk_bf16_f32 v74, v220, v221
    v_pk_add_f32 v[222:223], v[222:223], v[4:5] op_sel_hi:[1,0] neg_lo:[0,1] neg_hi:[0,1]
    v_cvt_pk_bf16_f32 v223, v222, v223
    v_lshlrev_b32 v222, 16, v223
    v_and_b32 v223, s44, v223
    v_pk_mul_f32 v[222:223], v[222:223], v[6:7] op_sel_hi:[1,0]
    v_cvt_pk_bf16_f32 v75, v222, v223
    buffer_store_dwordx4 v[72:75], v2, s[4:7], s40 offen offset:0 sc1
    v_pk_add_f32 v[224:225], v[224:225], v[4:5] op_sel_hi:[1,0] neg_lo:[0,1] neg_hi:[0,1]
    v_cvt_pk_bf16_f32 v225, v224, v225
    v_lshlrev_b32 v224, 16, v225
    v_and_b32 v225, s44, v225
    v_pk_mul_f32 v[224:225], v[224:225], v[6:7] op_sel_hi:[1,0]
    v_cvt_pk_bf16_f32 v76, v224, v225
    v_pk_add_f32 v[226:227], v[226:227], v[4:5] op_sel_hi:[1,0] neg_lo:[0,1] neg_hi:[0,1]
    v_cvt_pk_bf16_f32 v227, v226, v227
    v_lshlrev_b32 v226, 16, v227
    v_and_b32 v227, s44, v227
    v_pk_mul_f32 v[226:227], v[226:227], v[6:7] op_sel_hi:[1,0]
    v_cvt_pk_bf16_f32 v77, v226, v227
    v_pk_add_f32 v[228:229], v[228:229], v[4:5] op_sel_hi:[1,0] neg_lo:[0,1] neg_hi:[0,1]
    v_cvt_pk_bf16_f32 v229, v228, v229
    v_lshlrev_b32 v228, 16, v229
    v_and_b32 v229, s44, v229
    v_pk_mul_f32 v[228:229], v[228:229], v[6:7] op_sel_hi:[1,0]
    v_cvt_pk_bf16_f32 v78, v228, v229
    v_pk_add_f32 v[230:231], v[230:231], v[4:5] op_sel_hi:[1,0] neg_lo:[0,1] neg_hi:[0,1]
    v_cvt_pk_bf16_f32 v231, v230, v231
    v_lshlrev_b32 v230, 16, v231
    v_and_b32 v231, s44, v231
    v_pk_mul_f32 v[230:231], v[230:231], v[6:7] op_sel_hi:[1,0]
    v_cvt_pk_bf16_f32 v79, v230, v231
    buffer_store_dwordx4 v[76:79], v2, s[4:7], s40 offen offset:2048 sc1
    s_add_u32 s40, s40, 4096
    v_pk_add_f32 v[232:233], v[232:233], v[4:5] op_sel_hi:[1,0] neg_lo:[0,1] neg_hi:[0,1]
    v_cvt_pk_bf16_f32 v233, v232, v233
    v_lshlrev_b32 v232, 16, v233
    v_and_b32 v233, s44, v233
    v_pk_mul_f32 v[232:233], v[232:233], v[6:7] op_sel_hi:[1,0]
    v_cvt_pk_bf16_f32 v80, v232, v233
    v_pk_add_f32 v[234:235], v[234:235], v[4:5] op_sel_hi:[1,0] neg_lo:[0,1] neg_hi:[0,1]
    v_cvt_pk_bf16_f32 v235, v234, v235
    v_lshlrev_b32 v234, 16, v235
    v_and_b32 v235, s44, v235
    v_pk_mul_f32 v[234:235], v[234:235], v[6:7] op_sel_hi:[1,0]
    v_cvt_pk_bf16_f32 v81, v234, v235
    v_pk_add_f32 v[236:237], v[236:237], v[4:5] op_sel_hi:[1,0] neg_lo:[0,1] neg_hi:[0,1]
    v_cvt_pk_bf16_f32 v237, v236, v237
    v_lshlrev_b32 v236, 16, v237
    v_and_b32 v237, s44, v237
    v_pk_mul_f32 v[236:237], v[236:237], v[6:7] op_sel_hi:[1,0]
    v_cvt_pk_bf16_f32 v82, v236, v237
    v_pk_add_f32 v[238:239], v[238:239], v[4:5] op_sel_hi:[1,0] neg_lo:[0,1] neg_hi:[0,1]
    v_cvt_pk_bf16_f32 v239, v238, v239
    v_lshlrev_b32 v238, 16, v239
    v_and_b32 v239, s44, v239
    v_pk_mul_f32 v[238:239], v[238:239], v[6:7] op_sel_hi:[1,0]
    v_cvt_pk_bf16_f32 v83, v238, v239
    buffer_store_dwordx4 v[80:83], v2, s[4:7], s40 offen offset:0 sc1
    v_pk_add_f32 v[240:241], v[240:241], v[4:5] op_sel_hi:[1,0] neg_lo:[0,1] neg_hi:[0,1]
    v_cvt_pk_bf16_f32 v241, v240, v241
    v_lshlrev_b32 v240, 16, v241
    v_and_b32 v241, s44, v241
    v_pk_mul_f32 v[240:241], v[240:241], v[6:7] op_sel_hi:[1,0]
    v_cvt_pk_bf16_f32 v84, v240, v241
    v_pk_add_f32 v[242:243], v[242:243], v[4:5] op_sel_hi:[1,0] neg_lo:[0,1] neg_hi:[0,1]
    v_cvt_pk_bf16_f32 v243, v242, v243
    v_lshlrev_b32 v242, 16, v243
    v_and_b32 v243, s44, v243
    v_pk_mul_f32 v[242:243], v[242:243], v[6:7] op_sel_hi:[1,0]
    v_cvt_pk_bf16_f32 v85, v242, v243
    v_pk_add_f32 v[244:245], v[244:245], v[4:5] op_sel_hi:[1,0] neg_lo:[0,1] neg_hi:[0,1]
    v_cvt_pk_bf16_f32 v245, v244, v245
    v_lshlrev_b32 v244, 16, v245
    v_and_b32 v245, s44, v245
    v_pk_mul_f32 v[244:245], v[244:245], v[6:7] op_sel_hi:[1,0]
    v_cvt_pk_bf16_f32 v86, v244, v245
    v_pk_add_f32 v[246:247], v[246:247], v[4:5] op_sel_hi:[1,0] neg_lo:[0,1] neg_hi:[0,1]
    v_cvt_pk_bf16_f32 v247, v246, v247
    v_lshlrev_b32 v246, 16, v247
    v_and_b32 v247, s44, v247
    v_pk_mul_f32 v[246:247], v[246:247], v[6:7] op_sel_hi:[1,0]
    v_cvt_pk_bf16_f32 v87, v246, v247
    buffer_store_dwordx4 v[84:87], v2, s[4:7], s40 offen offset:2048 sc1
    s_add_u32 s40, s40, 4096
    s_waitcnt vmcnt(0)
    s_barrier
    s_cmp_lg_u32 s23, 0
    s_cbranch_scc1 L_LN2
    s_sub_u32 s40, s2, s26
    s_and_b32 s42, s40, 1
    s_bfe_u32 s41, s40, 0x10001
    s_lshl_b32 s41, s41, 9
    s_or_b32 s42, s42, s41
    s_bfe_u32 s41, s40, 0x10002
    s_lshl_b32 s41, s41, 18
    s_or_b32 s42, s42, s41
    s_add_u32 s43, 1, 128
    v_mov_b32 v4, 0
    v_mov_b32 v2, s43
    v_mov_b32 v3, s42
    s_mov_b64 exec, 1
    buffer_atomic_add_x2 v[2:3], v4, s[16:19], s28 offen sc0 sc1
    s_waitcnt vmcnt(0)
    v_readfirstlane_b32 s40, v2
    v_readfirstlane_b32 s41, v3
    s_add_u32 s40, s40, s43
    s_add_u32 s41, s41, s42
    s_and_b32 s42, s40, 127
    s_cmp_lg_u32 s42, 112
    s_cbranch_scc1 nla_73
    s_branch allc_76
all_74:
    buffer_load_dwordx2 v[2:3], v4, s[16:19], s28 offen sc1
    s_waitcnt vmcnt(0)
    v_readfirstlane_b32 s40, v2
    v_readfirstlane_b32 s41, v3
allc_76:
    s_bfe_u32 s42, s40, 0x90007
    s_cmp_eq_u32 s42, 256
    s_cbranch_scc1 alld_75
    s_sleep 8
    s_add_u32 s27, s27, 1
    s_cmp_lt_u32 s27, 131072
    s_cbranch_scc1 all_74
    s_branch L_abort
alld_75:
    s_and_b32 s41, s41, 66977535
    s_cselect_b32 s41, 0x80000000, 0
    s_or_b32 s40, s40, s41
    v_mov_b32 v2, s40
    buffer_store_dword v2, v4, s[16:19], s28 offen offset:128 sc1
nla_73:
    s_mov_b64 exec, -1
L_LN2:
ws_77:
    v_mov_b32 v30, 0
    buffer_load_dword v31, v30, s[16:19], s28 offen offset:128 sc1
    s_waitcnt vmcnt(0)
wsc_79:
    v_readfirstlane_b32 s40, v31
    s_nop 0
    s_cmp_lt_i32 s40, 0
    s_cbranch_scc1 L_restart
    s_cmp_lg_u32 s40, 0
    s_cbranch_scc1 wsd_78
    s_sleep 4
    s_add_u32 s27, s27, 1
    s_cmp_lt_u32 s27, 131072
    s_cbranch_scc1 ws_77
    s_branch L_abort
wsd_78:
    s_bfe_u32 s41, s40, 0x40010
    s_cmp_ge_u32 s41, 5
    s_cselect_b32 s28, 1, 0
    s_bfe_u32 s41, s40, 0x40018
    s_cmp_ge_u32 s41, 5
    s_cselect_b32 s41, 1, 0
    s_xor_b32 s3, s20, s41
    s_and_b32 s3, s3, 1
    s_lshl_b32 s3, s3, 14
    s_lshl_b32 s40, s23, 8
    s_add_u32 s3, s3, s40
    s_lshr_b32 s40, s20, 1
    s_lshl_b32 s40, s40, 7
    s_add_u32 s3, s3, s40
    s_add_u32 s3, s3, 327680
    s_cmp_ge_u32 s21, 29
    s_cbranch_scc1 L_CP
    v_mov_b32 v12, 0
    s_mov_b32 s26, s22
L_RF_loop:
    s_add_u32 s40, s26, 0
    s_lshr_b32 s41, s40, 2
    s_xor_b32 s41, s41, s40
    s_xor_b32 s41, s41, s28
    s_and_b32 s41, s41, 1
    s_lshl_b32 s41, s41, 13
    s_lshr_b32 s40, s40, 1
    s_lshl_b32 s40, s40, 20
    s_or_b32 s35, s40, s41
    s_add_u32 s35, s35, s3
    buffer_load_dword v20, v12, s[4:7], s35 offen sc1
    s_nop 15
    buffer_load_dword v21, v12, s[4:7], s35 offen sc1
    s_nop 15
    buffer_load_dword v22, v12, s[4:7], s35 offen sc1
    s_nop 15
    buffer_load_dword v23, v12, s[4:7], s35 offen sc1
.p2align 6
poll_80:
    s_waitcnt vmcnt(3)
    v_cmp_eq_u32 vcc, -1, v20
    s_cbranch_vccz pd_81
    buffer_load_dword v20, v12, s[4:7], s35 offen sc1
    s_waitcnt vmcnt(3)
    v_cmp_eq_u32 vcc, -1, v21
    s_cbranch_vccz pd_81
    buffer_load_dword v21, v12, s[4:7], s35 offen sc1
    s_waitcnt vmcnt(3)
    v_cmp_eq_u32 vcc, -1, v22
    s_cbranch_vccz pd_81
    buffer_load_dword v22, v12, s[4:7], s35 offen sc1
    s_waitcnt vmcnt(3)
    v_cmp_eq_u32 vcc, -1, v23
    s_cbranch_vccz pd_81
    buffer_load_dword v23, v12, s[4:7], s35 offen sc1
    s_add_u32 s27, s27, 1
    s_cmp_lt_u32 s27, 131072
    s_cbranch_scc1 poll_80
    s_branch L_abort
.p2align 6
pd_81:
    s_add_u32 s26, s26, 2
    s_cmp_lt_u32 s26, 64
    s_cbranch_scc1 L_RF_loop
    s_branch L_end
L_CP:
    s_cmp_lg_u32 s21, 29
    s_cbranch_scc1 L_end
    s_getpc_b64 s[8:9]
L_pc:
    s_sub_u32 s8, s8, L_pc-L_QK
    s_subb_u32 s9, s9, 0
    s_mov_b32 s10, L_hot_end-L_QK
    s_mov_b32 s11, 0x20000
    v_mov_b32 v12, 0
    v_lshlrev_b32 v2, 6, v1
    s_lshl_b32 s42, s23, 12
    s_mov_b32 s26, s22
    s_add_u32 s40, s26, 0
    s_lshr_b32 s41, s40, 2
    s_xor_b32 s41, s41, s40
    s_xor_b32 s41, s41, s28
    s_and_b32 s41, s41, 1
    s_lshl_b32 s41, s41, 13
    s_lshr_b32 s40, s40, 1
    s_lshl_b32 s40, s40, 20
    s_or_b32 s35, s40, s41
    s_add_u32 s35, s35, s3
    s_add_u32 s35, s35, 2048
L_CP_loop:
    s_add_u32 s43, s42, 0
    buffer_load_dword v4, v2, s[8:11], s43 offen sc1
    s_add_u32 s43, s42, 16384
    buffer_load_dword v5, v2, s[8:11], s43 offen sc1
    s_add_u32 s43, s42, 32768
    buffer_load_dword v6, v2, s[8:11], s43 offen sc1
    buffer_load_dword v8, v12, s[4:7], s35 offen sc1
    s_waitcnt vmcnt(0)
    v_cmp_eq_u32 vcc, -1, v8
    s_cbranch_vccz L_end
    s_sleep 24
    s_add_u32 s27, s27, 1
    s_cmp_lt_u32 s27, 131072
    s_cbranch_scc1 L_CP_loop
    s_branch L_abort
L_restart:
    s_waitcnt vmcnt(0) lgkmcnt(0)
    s_barrier
    s_mov_b32 s2, s26
    s_mov_b32 s28, 64
    s_branch L_dispatch
L_abort:
    v_mov_b32 v30, 8
    v_mov_b32 v31, 1
    s_mov_b64 exec, 1
    buffer_atomic_add v31, v30, s[16:19], 0 offen sc1
L_end:
    s_endpgm
.section .rodata,"a"
.p2align 6
.amdhsa_kernel parallel_sum__memory_aug_recurrent_mem_tr__dense_activation_silu__prompt_kernel
  .amdhsa_next_free_vgpr 512
  .amdhsa_next_free_sgpr 102
  .amdhsa_accum_offset 256
  .amdhsa_group_segment_fixed_size 0
  .amdhsa_kernarg_size 104
  .amdhsa_user_sgpr_count 2
  .amdhsa_user_sgpr_kernarg_segment_ptr 1
  .amdhsa_system_sgpr_workgroup_id_x 1
  .amdhsa_float_denorm_mode_32 3
  .amdhsa_float_denorm_mode_16_64 3
.end_amdhsa_kernel
.text
```
